```python
import torch

def _softmax(x, axis=-1):
    return torch.softmax(x, dim=axis)
def _gelu(x):
    return torch.nn.functional.gelu(x, approximate="tanh")
def _silu(x):
    return torch.nn.functional.silu(x)
def _sigmoid(x):
    return torch.sigmoid(x)
def _layernorm(x, axis=-1, eps=1e-5):
    m = x.mean(dim=axis, keepdim=True)
    v = x.var(dim=axis, keepdim=True, unbiased=False)
    return (x - m) / torch.sqrt(v + eps)
def _scatter_add(tgt, idx, src, axis=0):
    return tgt.clone().index_add_(axis, idx, src)
def _segment_sum(src, seg, n):
    out = torch.zeros((n,) + src.shape[1:], dtype=src.dtype)
    return out.index_add_(0, seg, src)
def _pad(x, pw):
    flat = tuple(v for pair in reversed(pw) for v in pair)
    return torch.nn.functional.pad(x, flat)

kernel_name = 'sequential_preLN__softmax_full_mha__glu_gated_glu__prompt'

def setup_inputs():

    _w = (lambda a: (lambda t: t.to(torch.bfloat16) if t.is_floating_point() else t)(torch.as_tensor(a)))
    def _A_setup():
        B, S, D = 1, 2048, 448
        return {
            "x": _w((lambda *s: torch.randn(*s, dtype=torch.bfloat16) * 0.05)(B, S, D)),
            "wqkv": _w((lambda *s: torch.randn(*s, dtype=torch.bfloat16) * 0.05)(D, 3 * D)),
            "wo": _w((lambda *s: torch.randn(*s, dtype=torch.bfloat16) * 0.05)(D, D)),
        }
    _A_in = _A_setup()

    def _B_setup():
        B, S, D, F = 1, 2048, 448, 1792
        return {
            "x": _w((lambda *s: torch.randn(*s, dtype=torch.bfloat16) * 0.05)(B, S, D)),
            "w_gate": _w((lambda *s: torch.randn(*s, dtype=torch.bfloat16) * 0.05)(D, F)),
            "w_up": _w((lambda *s: torch.randn(*s, dtype=torch.bfloat16) * 0.05)(D, F)),
            "w_down": _w((lambda *s: torch.randn(*s, dtype=torch.bfloat16) * 0.05)(F, D)),
        }
    _B_in = _B_setup()

    return {
        "A_x": _A_in["x"],
        "A_wqkv": _A_in["wqkv"],
        "A_wo": _A_in["wo"],
        "B_x": _B_in["x"],
        "B_w_gate": _B_in["w_gate"],
        "B_w_up": _B_in["w_up"],
        "B_w_down": _B_in["w_down"],
    }

def reference(A_x, A_wqkv, A_wo, B_x, B_w_gate, B_w_up, B_w_down):
    def _A_ref(x, wqkv, wo):
        B, S, D = x.shape
        H = 16; Dh = D // H
        qkv = (lambda x, *d: x.permute(*d))((x @ wqkv).reshape(B, S, 3, H, Dh), 2, 0, 3, 1, 4)
        q, k, v = qkv[0], qkv[1], qkv[2]
        scale = Dh ** -0.5
        scores = torch.einsum("bhqd,bhkd->bhqk", q, k) * scale
        p = _softmax(scores, axis=-1)
        o = torch.einsum("bhqk,bhkd->bhqd", p, v)
        return (lambda x, *d: x.permute(*d))(o, 0, 2, 1, 3).reshape(B, S, D) @ wo

    def _B_ref(x, w_gate, w_up, w_down):
        g = torch.einsum("bsd,df->bsf", x, w_gate)
        u = torch.einsum("bsd,df->bsf", x, w_up)
        h = _sigmoid(g) * u
        return torch.einsum("bsf,fd->bsd", h, w_down)

    x = A_x
    h = x + _A_ref(_layernorm(x, axis=-1), A_wqkv, A_wo)
    h2 = h + _B_ref(_layernorm(h, axis=-1), B_w_gate, B_w_up, B_w_down)
    return h2
```

```asm
; @launch grid=(256,1,1) block=(256,1,1) lds=163840
.amdgcn_target "amdgcn-amd-amdhsa--gfx950"
.text
.globl sequential_preLN__softmax_full_mha__glu_gated_glu__prompt_kernel
.p2align 8
.type sequential_preLN__softmax_full_mha__glu_gated_glu__prompt_kernel,@function
sequential_preLN__softmax_full_mha__glu_gated_glu__prompt_kernel:
    s_cmp_ge_u32 s2, 0x100
    s_cbranch_scc1 L_end
    s_load_dwordx16 s[64:79], s[0:1], 0
    s_load_dwordx2 s[12:13], s[0:1], 72
    s_getpc_b64 s[86:87]
    v_lshrrev_b32 v127, 4, v0
    s_lshr_b32 s50, s2, 3
    v_lshlrev_b32 v127, 5, v127
    v_add_u32 v127, s50, v127
    v_lshlrev_b32_e64 v127, 7, v127
    v_min_u32 v127, 45804, v127
    global_load_dword v204, v127, s[86:87]
    v_lshrrev_b32_e64 v2, 6, v0
    v_and_b32 v0, 63, v0
    s_and_b32 s37, s2, 7
    v_readfirstlane_b32 s36, v2
    s_lshl_b32 s37, s37, 1
    s_bfe_u32 s50, s2, 0x10003
    s_add_u32 s37, s37, s50
    s_lshr_b32 s38, s2, 4
    s_bfe_u32 s28, s2, 0x20001
    s_lshl_b32 s28, s28, 2
    s_bfe_u32 s50, s2, 0x20003
    s_add_u32 s28, s28, s50
    s_and_b32 s29, s2, 1
    s_lshl_b32 s29, s29, 3
    s_lshr_b32 s50, s2, 5
    s_add_u32 s29, s29, s50
    v_lshlrev_b32_e64 v1, 4, v0
    s_mov_b32 s40, 0x40000
    s_mov_b32 s41, 1065369472
    s_mov_b32 s42, 0
    v_mov_b32 v254, 0
    s_mov_b32 s88, s28
    s_and_b32 s89, s2, 1
    s_lshl_b32 s50, s50, 1
    s_add_u32 s89, s89, s50
    s_mov_b32 s37, s29
    s_mov_b32 s38, s28
    s_mul_i32 s50, s29, 112
    s_mul_i32 s52, s36, 43008
    s_add_u32 s50, s50, s52
    s_add_u32 s50, s50, 896
    v_lshrrev_b32 v14, 3, v0
    v_and_b32_e64 v15, 7, v0
    v_bfe_u32 v16, v0, 4, 1
    v_lshlrev_b32_e64 v16, 2, v16
    v_xor_b32 v16, v15, v16
    v_min_u32 v16, 6, v16
    v_mul_u32_u24 v17, 2688, v14
    v_lshlrev_b32_e64 v16, 4, v16
    v_add3_u32 v26, v17, v16, s50
    v_add_u32 v27, 21504, v26
    v_lshrrev_b32 v16, 4, v0
    v_xor_b32 v16, v15, v16
    v_mul_u32_u24 v17, 896, v14
    s_lshl_b32 s52, s28, 2
    s_add_u32 s52, s52, s36
    s_mul_i32 s52, s52, 28672
    v_lshlrev_b32_e64 v18, 4, v16
    v_add3_u32 v188, v17, v18, s52
    v_xor_b32_e64 v189, 64, v188
    v_add_u32 v189, 7168, v189
    v_add_u32 v190, 14336, v188
    v_add_u32 v191, 14336, v189
    s_lshl_b32 s49, s36, 14
    s_add_u32 s49, s49, 86016
    s_lshr_b32 s53, s2, 3
    s_mul_i32 s54, s53, 37
    s_lshr_b32 s54, s54, 8
    s_mul_i32 s54, s54, 7
    s_sub_u32 s53, s53, s54
    s_lshl_b32 s51, s36, 11
    s_mul_i32 s33, s53, 172032
    s_lshl_b32 s60, s53, 7
    s_mov_b32 s6, 1835008
    s_mov_b32 s7, 0x20000
    s_mov_b32 s10, 1204224
    s_mov_b32 s11, 0x20000
    s_mov_b32 s14, 28311552
    s_mov_b32 s15, 0x20000
    s_mov_b32 s18, 1835008
    s_mov_b32 s19, 0x20000
    s_mov_b32 s23, 0x20000
    s_mov_b32 s27, 0x20000
    s_mov_b32 s58, 25296896
    v_mov_b32 v16, 0
    s_waitcnt lgkmcnt(0)
    s_mov_b32 s4, s64
    s_mov_b32 s5, s65
    s_mov_b32 s8, s66
    s_mov_b32 s9, s67
    buffer_load_dword v203, v16, s[12:15], s58 offen sc1
    s_add_u32 m0, s51, 0
    s_nop 0
    buffer_load_dwordx4 v26, s[8:11], s33 offen lds
    s_add_u32 m0, s51, 1024
    s_nop 0
    buffer_load_dwordx4 v27, s[8:11], s33 offen lds
    s_add_u32 m0, s49, 0
    s_nop 0
    buffer_load_dwordx4 v188, s[4:7], s60 offen lds
    s_add_u32 m0, s49, 1024
    s_nop 0
    buffer_load_dwordx4 v189, s[4:7], s60 offen lds
    s_add_u32 m0, s49, 2048
    s_nop 0
    buffer_load_dwordx4 v190, s[4:7], s60 offen lds
    s_add_u32 m0, s49, 3072
    s_nop 0
    buffer_load_dwordx4 v191, s[4:7], s60 offen lds
    s_add_u32 s53, s53, 1
    s_cmp_eq_u32 s53, 7
    s_cselect_b32 s53, 0, s53
    s_mul_i32 s33, s53, 172032
    s_lshl_b32 s60, s53, 7
    s_mov_b32 s16, s78
    s_mov_b32 s17, s79
    s_lshl_b32 s43, s36, 8
    s_add_u32 s43, s43, s2
    s_cmp_ge_u32 s43, 392
    s_cbranch_scc1 L_u1
    s_mov_b32 s20, s72
    s_mov_b32 s21, s73
    s_mov_b32 s24, s74
    s_mov_b32 s25, s75
    s_mov_b32 s22, 1605632
    s_mul_i32 s58, s43, 4682
    s_lshr_b32 s58, s58, 16
    s_mul_i32 s59, s58, 14
    s_sub_u32 s59, s43, s59
    s_mul_i32 s46, s59, 114688
    s_lshl_b32 s61, s58, 7
    s_add_u32 s46, s46, s61
    s_mov_b32 s47, s46
    s_mov_b32 s48, 3584
    s_mul_i32 s44, s58, 114688
    s_lshl_b32 s61, s59, 11
    s_add_u32 s44, s44, s61
    s_add_u32 s44, s44, 17825792
    s_mov_b32 s30, 28672
    s_lshl_b32 s45, s43, 9
    s_add_u32 s45, s45, 24641536
    s_branch L_u3
L_u1:
    s_mov_b32 s48, 896
    s_mov_b32 s30, 2048
    s_mov_b32 s45, 1073741824
    s_cmp_ge_u32 s43, 588
    s_cbranch_scc1 L_u2
    s_mov_b32 s20, s76
    s_mov_b32 s21, s77
    s_mov_b32 s24, s76
    s_mov_b32 s25, s77
    s_mov_b32 s22, 1605632
    s_sub_u32 s61, s43, 392
    s_mul_i32 s58, s61, 2341
    s_lshr_b32 s58, s58, 16
    s_mul_i32 s59, s58, 28
    s_sub_u32 s59, s61, s59
    s_mul_i32 s46, s59, 57344
    s_lshl_b32 s58, s58, 7
    s_add_u32 s46, s46, s58
    s_add_u32 s47, s46, 28672
    s_lshl_b32 s44, s61, 13
    s_add_u32 s44, s44, 22020096
    s_branch L_u3
L_u2:
    s_mov_b32 s20, s68
    s_mov_b32 s21, s69
    s_mov_b32 s24, s68
    s_mov_b32 s25, s69
    s_cmp_lt_u32 s43, 644
    s_cselect_b32 s22, 401408, 0
    s_sub_u32 s61, s43, 588
    s_lshr_b32 s58, s61, 3
    s_and_b32 s59, s61, 7
    s_mul_i32 s46, s59, 50176
    s_lshl_b32 s58, s58, 7
    s_add_u32 s46, s46, s58
    s_add_u32 s47, s46, 25088
    s_lshl_b32 s44, s61, 13
    s_add_u32 s44, s44, 24117248
    s_cmp_lt_u32 s43, 644
    s_cselect_b32 s44, s44, 1073741824
L_u3:
    s_mov_b32 s26, s22
    s_lshl_b32 s31, s43, 7
    s_add_u32 s31, s31, 25329664
    s_cmp_lt_u32 s43, 644
    s_cselect_b32 s31, s31, 1073741824
    v_lshrrev_b32 v16, 3, v0
    v_and_b32_e64 v17, 7, v0
    v_mul_lo_u32 v16, v16, s48
    v_lshl_add_u32 v28, v17, 4, v16
    s_lshl_b32 s48, s48, 3
    s_lshl_b32 s58, s38, 2
    s_add_u32 s58, s58, s36
    s_lshl_b32 s58, s58, 4
    s_add_u32 s58, s58, s37
    s_lshl_b32 s58, s58, 11
    s_add_u32 s3, s58, 6291456
    s_and_b32 s58, s89, 1
    s_lshl_b32 s58, s58, 1
    s_lshl_b32 s59, s88, 2
    s_add_u32 s58, s58, s59
    s_and_b32 s59, s36, 1
    s_add_u32 s62, s58, s59
    s_lshr_b32 s59, s36, 1
    s_and_b32 s63, s89, 14
    s_add_u32 s63, s63, s59
    s_mul_i32 s58, s62, 14
    s_add_u32 s58, s58, s63
    s_lshl_b32 s100, s58, 8
    s_lshl_b32 s34, s58, 11
    s_add_u32 s34, s34, 8388608
    s_add_u32 s100, s100, 25690112
    s_cmp_ge_u32 s89, 14
    s_cselect_b32 s34, 1073741824, s34
    s_cselect_b32 s100, 1073741824, s100
    s_lshl_b32 s58, s28, 2
    s_add_u32 s58, s58, s36
    s_mul_i32 s101, s58, 114688
    s_mul_i32 s59, s29, 7168
    s_add_u32 s101, s101, s59
    s_add_u32 s101, s101, 10485760
    s_lshl_b32 s55, s36, 6
    s_lshr_b32 s56, s37, 1
    s_add_u32 s55, s55, s56
    v_and_b32 v2, 3, v0
    v_lshlrev_b32 v2, 4, v2
    v_bfe_u32 v3, v0, 2, 1
    v_lshl_add_u32 v2, v3, 3, v2
    v_bfe_u32 v3, v0, 3, 2
    v_lshl_add_u32 v2, v3, 8, v2
    v_add_u32 v2, s55, v2
    v_lshlrev_b32 v207, 7, v2
    v_and_b32 v2, 3, v0
    s_lshl_b32 s55, s88, 4
    s_lshl_b32 s56, s36, 2
    s_add_u32 s55, s55, s56
    v_add_u32 v2, s55, v2
    v_lshlrev_b32 v2, 7, v2
    s_mul_i32 s55, s29, 7
    s_lshr_b32 s55, s55, 2
    s_add_u32 s71, s55, s36
    s_mul_i32 s55, s55, 14
    s_lshr_b32 s56, s89, 1
    s_min_u32 s56, s56, 6
    s_mul_i32 s57, s56, 28
    s_mul_i32 s58, s36, 7
    s_add_u32 s57, s57, s58
    s_lshl_b32 s32, s57, 13
    s_add_u32 s32, s32, 22020096
    s_add_u32 s57, s57, 350
    s_lshl_b32 s56, s56, 3
    s_lshl_b32 s58, s36, 1
    s_add_u32 s56, s56, s58
    s_lshl_b32 s35, s56, 13
    s_add_u32 s35, s35, 24117248
    s_add_u32 s56, s56, 588
    s_cmp_ge_u32 s89, 14
    s_cselect_b32 s32, 1073741824, s32
    s_cselect_b32 s35, 1073741824, s35
    v_add_u32 v4, s55, v0
    v_min_u32 v4, 391, v4
    v_add_u32 v5, s57, v0
    v_and_b32 v3, 1, v0
    v_add_u32_e64 v3, s56, v3
    v_cmp_gt_u32 vcc, 49, v0
    s_nop 1
    v_cndmask_b32 v3, v3, v5, vcc
    v_cmp_gt_u32 vcc, 42, v0
    s_nop 1
    v_cndmask_b32 v3, v3, v4, vcc
    v_lshlrev_b32 v3, 7, v3
    s_xor_b32 s55, s36, 3
    s_mul_i32 s55, s55, 12288
    s_add_u32 s55, s55, 114688
    v_add_u32 v4, s55, v1
    s_xor_b32 s55, s36, 2
    s_mul_i32 s55, s55, 12288
    s_add_u32 s55, s55, 118784
    v_add_u32 v5, s55, v1
    s_xor_b32 s55, s36, 1
    s_mul_i32 s55, s55, 12288
    s_add_u32 s55, s55, 122880
    v_add_u32_e64 v6, s55, v1
    s_mul_i32 s55, s36, 12288
    s_add_u32 s55, s55, 114688
    v_add_u32_e64 v7, s55, v1
    v_add_u32 v208, 2097152, v1
    v_lshlrev_b32 v210, 2, v0
    s_lshr_b32 s55, s36, 1
    s_lshl_b32 s55, s55, 10
    v_add_u32 v253, s55, v1
    v_xor_b32 v252, 1024, v253
    v_and_b32 v254, 31, v0
    v_lshrrev_b32 v251, 5, v0
    v_lshlrev_b32_e64 v250, 4, v254
    v_lshl_add_u32 v250, v251, 3, v250
    v_mul_u32_u24 v254, 896, v254
    v_lshl_add_u32 v254, v251, 5, v254
    s_mul_i32 s55, s62, 28672
    s_lshl_b32 s56, s63, 6
    s_add_u32 s55, s55, s56
    s_cmp_ge_u32 s89, 14
    s_cselect_b32 s55, 1073741824, s55
    v_add_u32_e64 v254, s55, v254
    s_mul_i32 s55, s29, 200704
    s_add_u32 s55, s55, 17825792
    v_add_u32_e64 v251, s55, v1
    s_mul_i32 s54, s36, 28672
    v_accvgpr_write_b32 a220, -1
    v_accvgpr_write_b32 a221, -1
    v_accvgpr_write_b32 a222, -1
    v_accvgpr_write_b32 a223, -1
    s_mov_b32 s64, s3
    s_mov_b32 s65, s34
    s_mov_b32 s66, s100
    s_lshl_b32 s67, s38, 4
    s_add_u32 s67, s67, s37
    s_lshl_b32 s67, s67, 7
    s_add_u32 s67, s67, 25198592
    s_lshl_b32 s68, s88, 4
    s_add_u32 s68, s68, s89
    s_lshl_b32 s68, s68, 7
    s_add_u32 s68, s68, 25231360
    s_cmp_eq_u32 s36, 0
    s_cselect_b32 s67, s67, 1073741824
    s_cselect_b32 s68, s68, 1073741824
    s_lshl_b32 s55, s62, 4
    s_lshl_b32 s56, s36, 2
    s_add_u32 s55, s55, s56
    s_lshl_b32 s55, s55, 11
    s_add_u32 s70, s55, 6291456
    s_xor_b32 s69, s55, 0x8000
    s_add_u32 s69, s69, 6291456
    s_cmp_ge_u32 s89, 14
    s_cselect_b32 s69, 1073741824, s69
    s_cselect_b32 s70, 1073741824, s70
    s_min_u32 s71, s71, 27
    s_mul_i32 s71, s71, 7168
    s_add_u32 s71, s71, 24641536
    s_cmp_lt_u32 s36, 3
    s_cselect_b32 s71, s71, 1073741824
    s_lshl_b32 s55, s28, 2
    s_add_u32 s55, s55, s36
    s_mul_i32 s72, s55, 28672
    s_add_u32 s72, s72, 8388608
    s_mul_i32 s73, s55, 3584
    s_add_u32 s73, s73, 25690112
    s_lshl_b32 s76, s55, 4
    s_add_u32 s76, s76, s29
    s_lshl_b32 s76, s76, 7
    s_add_u32 s76, s76, 27262976
    s_add_u32 s56, s54, 10485760
    s_mul_i32 s75, s62, 114688
    s_add_u32 s75, s75, s56
    s_xor_b32 s74, s62, 1
    s_mul_i32 s74, s74, 114688
    s_add_u32 s74, s74, s56
    s_cmp_ge_u32 s89, 14
    s_cselect_b32 s74, 1073741824, s74
    s_cselect_b32 s75, 1073741824, s75
    s_add_u32 s78, s74, 0
    s_add_u32 s79, s74, 7168
    s_add_u32 s80, s74, 14336
    s_add_u32 s81, s74, 21504
    s_add_u32 s82, s75, 0
    s_add_u32 s83, s75, 7168
    s_add_u32 s84, s75, 14336
    s_add_u32 s85, s75, 21504
    v_bfe_u32 v16, v0, 2, 2
    v_lshrrev_b32 v17, 5, v0
    v_lshl_add_u32 v18, v17, 3, v16
    v_bfe_u32 v19, v0, 4, 1
    v_lshlrev_b32 v19, 5, v19
    v_and_b32 v20, 3, v0
    v_lshl_add_u32 v19, v20, 3, v19
    v_bfe_u32 v21, v0, 3, 1
    v_lshlrev_b32 v21, 6, v21
    v_xor_b32 v22, v19, v21
    v_add_u32 v23, 56, v19
    v_xor_b32 v23, v23, v21
    v_lshl_add_u32 v22, v18, 7, v22
    v_lshl_add_u32 v23, v18, 7, v23
    v_lshl_add_u32 v24, v18, 6, v19
    s_and_b32 s58, s29, 1
    s_lshl_b32 s58, s58, 3
    s_add_u32 s58, s58, 57344
    v_add_u32 v24, s58, v24
    v_and_b32 v25, 31, v0
    v_bfe_u32 v15, v0, 1, 3
    v_xor_b32 v15, v15, v17
    v_lshlrev_b32 v15, 4, v15
    v_lshl_add_u32 v15, v25, 7, v15
    v_add_u32 v15, s49, v15
    s_add_u32 s58, s36, 0
    s_and_b32 s58, s58, 3
    s_lshl_b32 s59, s58, 11
    v_add_u32 v176, s59, v22
    v_add_u32 v180, s59, v23
    s_lshl_b32 s59, s58, 10
    v_add_u32 v192, s59, v24
    s_lshl_b32 s58, s58, 5
    v_xor_b32 v184, s58, v15
    s_add_u32 s58, s36, 1
    s_and_b32 s58, s58, 3
    s_lshl_b32 s59, s58, 11
    v_add_u32 v177, s59, v22
    v_add_u32 v181, s59, v23
    s_lshl_b32 s59, s58, 10
    v_add_u32 v193, s59, v24
    s_lshl_b32 s58, s58, 5
    v_xor_b32 v185, s58, v15
    s_add_u32 s58, s36, 2
    s_and_b32 s58, s58, 3
    s_lshl_b32 s59, s58, 11
    v_add_u32 v178, s59, v22
    v_add_u32 v182, s59, v23
    s_lshl_b32 s59, s58, 10
    v_add_u32 v194, s59, v24
    s_lshl_b32 s58, s58, 5
    v_xor_b32 v186, s58, v15
    s_add_u32 s58, s36, 3
    s_and_b32 s58, s58, 3
    s_lshl_b32 s59, s58, 11
    v_add_u32 v179, s59, v22
    v_add_u32 v183, s59, v23
    s_lshl_b32 s59, s58, 10
    v_add_u32 v195, s59, v24
    s_lshl_b32 s58, s58, 5
    v_xor_b32 v187, s58, v15
    v_mov_b32 v134, s41
    v_mov_b32 v135, s41
    v_mov_b32 v139, 0
    v_mov_b32 v141, 0
    v_cmp_gt_u32 vcc, 28, v0
    s_nop 1
    v_cndmask_b32 v140, 0, v134, vcc
    v_cmp_eq_u32 vcc, 28, v25
    s_nop 1
    v_cndmask_b32 v142, 0, 1.0, vcc
    v_add_u32 v197, 147456, v1
    s_lshl_b32 s58, s36, 2
    v_add_u32 v196, s58, v197
    s_lshl_b32 s58, s36, 11
    s_add_u32 s58, s58, 122880
    v_add_u32 v198, s58, v1
    v_xor_b32 v199, 6144, v198
    v_xor_b32 v200, 4096, v198
    v_xor_b32 v201, 2048, v198
    v_lshrrev_b32_e64 v16, 2, v0
    v_mul_u32_u24 v16, 2688, v16
    v_lshl_add_u32 v16, v20, 4, v16
    s_mul_i32 s58, s29, 56
    s_andn2_b32 s58, s58, 15
    s_mul_i32 s59, s36, 43008
    s_add_u32 s58, s58, s59
    v_add_u32 v202, s58, v16
    s_lshl_b32 s52, s36, 10
    s_add_u32 s52, s52, 57344
    s_lshl_b32 s58, s28, 2
    s_add_u32 s58, s58, s36
    s_lshl_b32 s50, s58, 11
    s_lshl_b32 s59, s29, 18
    s_add_u32 s50, s50, s59
    s_add_u32 s50, s50, 2097152
    s_lshl_b32 s61, s58, 4
    s_add_u32 s61, s61, s29
    s_lshl_b32 s61, s61, 7
    s_add_u32 s61, s61, 27787264
    v_lshrrev_b32 v211, 3, v0
    v_lshl_add_u32 v211, v211, 26, v1
    s_add_u32 s56, s49, 12288
    s_cmp_eq_u32 s36, 0
    s_cselect_b32 s56, 118784, s56
    s_lshl_b32 s57, s36, 12
    s_add_u32 s57, s57, 151552
    s_cmp_eq_u32 s36, 3
    s_cselect_b32 s56, 139264, s56
    s_cselect_b32 s57, s56, s57
    v_bfe_u32 v20, v0, 2, 2
    v_lshrrev_b32_e64 v21, 5, v0
    v_bfe_u32 v22, v0, 4, 1
    v_and_b32_e64 v23, 3, v0
    s_cmp_ge_u32 s43, 392
    s_cbranch_scc1 L_p1
    v_lshl_add_u32 v20, v21, 4, v20
    v_lshlrev_b32 v20, 7, v20
    v_lshl_add_u32 v20, v23, 3, v20
    s_sub_u32 s58, s57, s56
    v_mul_u32_u24 v22, s58, v22
    v_add3_u32 v20, v20, v22, s56
    v_add_u32_e64 v216, 0, v20
    v_add_u32 v218, 512, v20
    v_add_u32 v220, 1024, v20
    v_add_u32 v222, 1536, v20
    v_add_u32_e64 v224, 32, v20
    v_add_u32 v226, 544, v20
    v_add_u32 v228, 1056, v20
    v_add_u32 v230, 1568, v20
    v_add_u32_e64 v232, 64, v20
    v_add_u32 v234, 576, v20
    v_add_u32 v236, 1088, v20
    v_add_u32 v238, 1600, v20
    v_add_u32 v240, 96, v20
    v_add_u32 v242, 608, v20
    v_add_u32 v244, 1120, v20
    v_add_u32 v246, 1632, v20
    s_branch L_p2
L_p1:
    v_lshl_add_u32 v20, v21, 2, v20
    v_lshlrev_b32 v20, 7, v20
    v_lshl_add_u32 v20, v22, 4, v20
    v_and_b32_e64 v21, 1, v23
    v_lshl_add_u32 v20, v21, 5, v20
    v_lshrrev_b32_e64 v21, 1, v23
    v_lshl_add_u32 v20, v21, 3, v20
    v_add_u32 v21, s57, v20
    v_add_u32 v20, s56, v20
    v_add_u32_e64 v216, 0, v20
    v_add_u32 v218, 1024, v20
    v_add_u32_e64 v220, 64, v20
    v_add_u32 v222, 1088, v20
    v_add_u32 v224, 2048, v20
    v_add_u32 v226, 3072, v20
    v_add_u32 v228, 2112, v20
    v_add_u32 v230, 3136, v20
    v_add_u32_e64 v232, 0, v21
    v_add_u32 v234, 1024, v21
    v_add_u32_e64 v236, 64, v21
    v_add_u32 v238, 1088, v21
    v_add_u32 v240, 2048, v21
    v_add_u32 v242, 3072, v21
    v_add_u32 v244, 2112, v21
    v_add_u32 v246, 3136, v21
L_p2:
    s_add_u32 m0, s51, 8192
    s_nop 0
    buffer_load_dwordx4 v26, s[8:11], s33 offen lds
    s_add_u32 m0, s51, 9216
    s_nop 0
    buffer_load_dwordx4 v27, s[8:11], s33 offen lds
    s_add_u32 m0, s49, 4096
    s_nop 0
    buffer_load_dwordx4 v188, s[4:7], s60 offen lds
    s_add_u32 m0, s49, 5120
    s_nop 0
    buffer_load_dwordx4 v189, s[4:7], s60 offen lds
    s_add_u32 m0, s49, 6144
    s_nop 0
    buffer_load_dwordx4 v190, s[4:7], s60 offen lds
    s_add_u32 m0, s49, 7168
    s_nop 0
    buffer_load_dwordx4 v191, s[4:7], s60 offen lds
    s_add_u32 s53, s53, 1
    s_cmp_eq_u32 s53, 7
    s_cselect_b32 s53, 0, s53
    s_mul_i32 s33, s53, 172032
    s_lshl_b32 s60, s53, 7
    s_lshr_b32 s58, s2, 3
    s_mul_i32 s58, s58, 37632
    s_and_b32 s59, s2, 1
    s_mul_i32 s59, s59, 3
    s_add_u32 s59, s59, s36
    s_lshl_b32 s59, s59, 7
    s_add_u32 s58, s58, s59
    v_min_u32 v16, 13, v0
    v_mul_u32_u24 v16, 2688, v16
    buffer_load_dword v204, v16, s[8:11], s58 offen
    v_and_b32 v16, 3, v0
    v_cmp_eq_u32 s[0:1], 1, v16
    v_cmp_eq_u32 s[86:87], 2, v16
    v_cmp_eq_u32 vcc, 3, v16
    s_cmp_ge_u32 s29, 8
    s_cbranch_scc1 L_v
    s_waitcnt vmcnt(7)
    s_barrier
    ds_read_b128 a[0:3], v184 offset:0
    ds_read_b128 a[4:7], v185 offset:0
    ds_read_b64_tr_b16 v[72:73], v176 offset:0
    ds_read_b64_tr_b16 v[74:75], v176 offset:512
    ds_read_b64_tr_b16 v[76:77], v180 offset:0
    ds_read_b64_tr_b16 v[78:79], v180 offset:512
    ds_read_b64_tr_b16 v[80:81], v177 offset:0
    ds_read_b64_tr_b16 v[82:83], v177 offset:512
    ds_read_b64_tr_b16 v[84:85], v181 offset:0
    ds_read_b64_tr_b16 v[86:87], v181 offset:512
    v_readfirstlane_b32 s39, v203
    s_add_u32 s39, s39, 0x9e3779b9
    s_nop 0
    v_mov_b32 v212, s39
    v_mov_b32 v213, s39
    v_mov_b32 v214, s39
    v_mov_b32 v215, s39
    s_waitcnt lgkmcnt(4)
    v_mfma_f32_4x4x4bf16_1k v[160:163], a[0:1], a[0:1], 0
    v_mfma_f32_4x4x4bf16_1k v[168:171], v[134:135], a[0:1], 0
    v_mfma_f32_4x4x4bf16_1k v[164:167], a[2:3], a[2:3], 0
    v_mfma_f32_4x4x4bf16_1k v[172:175], v[134:135], a[2:3], 0
    v_mfma_f32_4x4x4bf16_1k v[160:163], a[4:5], a[4:5], v[160:163]
    v_mfma_f32_4x4x4bf16_1k v[168:171], v[134:135], a[4:5], v[168:171]
    v_mfma_f32_4x4x4bf16_1k v[164:167], a[6:7], a[6:7], v[164:167]
    v_mfma_f32_4x4x4bf16_1k v[172:175], v[134:135], a[6:7], v[172:175]
    v_mfma_f32_4x4x4bf16_1k v[104:107], v[134:135], v[72:73], 0
    v_mfma_f32_4x4x4bf16_1k v[108:111], v[134:135], v[76:77], 0
    s_nop 0
    v_mfma_f32_4x4x4bf16_1k v[104:107], v[134:135], v[74:75], v[104:107]
    v_mfma_f32_4x4x4bf16_1k v[108:111], v[134:135], v[78:79], v[108:111]
    v_mfma_f32_32x32x16_bf16 v[40:55], v[72:75], a[0:3], 0
    ds_read_b128 a[8:11], v186 offset:0
    ds_read_b128 a[12:15], v187 offset:0
    ds_read_b64_tr_b16 v[88:89], v178 offset:0
    ds_read_b64_tr_b16 v[90:91], v178 offset:512
    s_add_u32 m0, s51, 16384
    v_mfma_f32_32x32x16_bf16 v[56:71], v[76:79], a[0:3], 0
    buffer_load_dwordx4 v26, s[8:11], s33 offen lds
    ds_read_b64_tr_b16 v[92:93], v182 offset:0
    ds_read_b64_tr_b16 v[94:95], v182 offset:512
    ds_read_b64_tr_b16 v[96:97], v179 offset:0
    s_waitcnt lgkmcnt(7)
    s_add_u32 m0, s51, 17408
    v_mfma_f32_32x32x16_bf16 v[40:55], v[80:83], a[4:7], v[40:55]
    buffer_load_dwordx4 v27, s[8:11], s33 offen lds
    ds_read_b64_tr_b16 v[98:99], v179 offset:512
    ds_read_b64_tr_b16 v[100:101], v183 offset:0
    ds_read_b64_tr_b16 v[102:103], v183 offset:512
    s_add_u32 m0, s49, 8192
    v_mfma_f32_32x32x16_bf16 v[56:71], v[84:87], a[4:7], v[56:71]
    buffer_load_dwordx4 v188, s[4:7], s60 offen lds
    s_waitcnt lgkmcnt(8)
    v_mfma_f32_4x4x4bf16_1k v[160:163], a[8:9], a[8:9], v[160:163]
    v_mfma_f32_4x4x4bf16_1k v[168:171], v[134:135], a[8:9], v[168:171]
    v_mfma_f32_4x4x4bf16_1k v[164:167], a[10:11], a[10:11], v[164:167]
    v_mfma_f32_4x4x4bf16_1k v[172:175], v[134:135], a[10:11], v[172:175]
    v_mfma_f32_4x4x4bf16_1k v[160:163], a[12:13], a[12:13], v[160:163]
    v_mfma_f32_4x4x4bf16_1k v[168:171], v[134:135], a[12:13], v[168:171]
    v_mfma_f32_4x4x4bf16_1k v[164:167], a[14:15], a[14:15], v[164:167]
    v_mfma_f32_4x4x4bf16_1k v[172:175], v[134:135], a[14:15], v[172:175]
    s_waitcnt lgkmcnt(4)
    v_mfma_f32_32x32x16_bf16 v[40:55], v[88:91], a[8:11], v[40:55]
    s_waitcnt vmcnt(4)
    s_barrier
    ds_read_b128 a[16:19], v184 offset:4096
    ds_read_b128 a[20:23], v185 offset:4096
    ds_read_b64_tr_b16 v[72:73], v176 offset:8192
    ds_read_b64_tr_b16 v[74:75], v176 offset:8704
    s_add_u32 m0, s49, 9216
    v_mfma_f32_32x32x16_bf16 v[56:71], v[92:95], a[8:11], v[56:71]
    buffer_load_dwordx4 v189, s[4:7], s60 offen lds
    ds_read_b64_tr_b16 v[76:77], v180 offset:8192
    ds_read_b64_tr_b16 v[78:79], v180 offset:8704
    ds_read_b64_tr_b16 v[80:81], v177 offset:8192
    s_waitcnt lgkmcnt(7)
    s_add_u32 m0, s49, 10240
    v_mfma_f32_32x32x16_bf16 v[40:55], v[96:99], a[12:15], v[40:55]
    buffer_load_dwordx4 v190, s[4:7], s60 offen lds
    ds_read_b64_tr_b16 v[82:83], v177 offset:8704
    ds_read_b64_tr_b16 v[84:85], v181 offset:8192
    ds_read_b64_tr_b16 v[86:87], v181 offset:8704
    s_add_u32 m0, s49, 11264
    v_mfma_f32_32x32x16_bf16 v[56:71], v[100:103], a[12:15], v[56:71]
    buffer_load_dwordx4 v191, s[4:7], s60 offen lds
    s_add_u32 s53, s53, 1
    s_cmp_eq_u32 s53, 7
    s_cselect_b32 s53, 0, s53
    s_mul_i32 s33, s53, 172032
    s_lshl_b32 s60, s53, 7
    s_waitcnt lgkmcnt(4)
    v_mfma_f32_4x4x4bf16_1k v[160:163], a[16:17], a[16:17], v[160:163]
    v_mfma_f32_4x4x4bf16_1k v[168:171], v[134:135], a[16:17], v[168:171]
    v_mfma_f32_4x4x4bf16_1k v[164:167], a[18:19], a[18:19], v[164:167]
    v_mfma_f32_4x4x4bf16_1k v[172:175], v[134:135], a[18:19], v[172:175]
    v_mfma_f32_4x4x4bf16_1k v[160:163], a[20:21], a[20:21], v[160:163]
    v_mfma_f32_4x4x4bf16_1k v[168:171], v[134:135], a[20:21], v[168:171]
    v_mfma_f32_4x4x4bf16_1k v[164:167], a[22:23], a[22:23], v[164:167]
    v_mfma_f32_4x4x4bf16_1k v[172:175], v[134:135], a[22:23], v[172:175]
    v_mfma_f32_4x4x4bf16_1k v[104:107], v[134:135], v[72:73], v[104:107]
    v_mfma_f32_4x4x4bf16_1k v[108:111], v[134:135], v[76:77], v[108:111]
    s_nop 0
    v_mfma_f32_4x4x4bf16_1k v[104:107], v[134:135], v[74:75], v[104:107]
    v_mfma_f32_4x4x4bf16_1k v[108:111], v[134:135], v[78:79], v[108:111]
    v_mfma_f32_32x32x16_bf16 v[40:55], v[72:75], a[16:19], v[40:55]
    ds_read_b128 a[24:27], v186 offset:4096
    ds_read_b128 a[28:31], v187 offset:4096
    ds_read_b64_tr_b16 v[88:89], v178 offset:8192
    ds_read_b64_tr_b16 v[90:91], v178 offset:8704
    s_add_u32 m0, s51, 24576
    v_mfma_f32_32x32x16_bf16 v[56:71], v[76:79], a[16:19], v[56:71]
    buffer_load_dwordx4 v26, s[8:11], s33 offen lds
    ds_read_b64_tr_b16 v[92:93], v182 offset:8192
    ds_read_b64_tr_b16 v[94:95], v182 offset:8704
    ds_read_b64_tr_b16 v[96:97], v179 offset:8192
    s_waitcnt lgkmcnt(7)
    s_add_u32 m0, s51, 25600
    v_mfma_f32_32x32x16_bf16 v[40:55], v[80:83], a[20:23], v[40:55]
    buffer_load_dwordx4 v27, s[8:11], s33 offen lds
    ds_read_b64_tr_b16 v[98:99], v179 offset:8704
    ds_read_b64_tr_b16 v[100:101], v183 offset:8192
    ds_read_b64_tr_b16 v[102:103], v183 offset:8704
    s_add_u32 m0, s49, 0
    v_mfma_f32_32x32x16_bf16 v[56:71], v[84:87], a[20:23], v[56:71]
    buffer_load_dwordx4 v188, s[4:7], s60 offen lds
    s_waitcnt lgkmcnt(8)
    v_mfma_f32_4x4x4bf16_1k v[160:163], a[24:25], a[24:25], v[160:163]
    v_mfma_f32_4x4x4bf16_1k v[168:171], v[134:135], a[24:25], v[168:171]
    v_mfma_f32_4x4x4bf16_1k v[164:167], a[26:27], a[26:27], v[164:167]
    v_mfma_f32_4x4x4bf16_1k v[172:175], v[134:135], a[26:27], v[172:175]
    v_mfma_f32_4x4x4bf16_1k v[160:163], a[28:29], a[28:29], v[160:163]
    v_mfma_f32_4x4x4bf16_1k v[168:171], v[134:135], a[28:29], v[168:171]
    v_mfma_f32_4x4x4bf16_1k v[164:167], a[30:31], a[30:31], v[164:167]
    v_mfma_f32_4x4x4bf16_1k v[172:175], v[134:135], a[30:31], v[172:175]
    s_waitcnt lgkmcnt(4)
    v_mfma_f32_32x32x16_bf16 v[40:55], v[88:91], a[24:27], v[40:55]
    s_waitcnt vmcnt(3)
    s_barrier
    ds_read_b128 a[32:35], v184 offset:8192
    ds_read_b128 a[36:39], v185 offset:8192
    ds_read_b64_tr_b16 v[72:73], v176 offset:16384
    ds_read_b64_tr_b16 v[74:75], v176 offset:16896
    s_add_u32 m0, s49, 1024
    v_mfma_f32_32x32x16_bf16 v[56:71], v[92:95], a[24:27], v[56:71]
    buffer_load_dwordx4 v189, s[4:7], s60 offen lds
    ds_read_b64_tr_b16 v[76:77], v180 offset:16384
    ds_read_b64_tr_b16 v[78:79], v180 offset:16896
    ds_read_b64_tr_b16 v[80:81], v177 offset:16384
    s_waitcnt lgkmcnt(7)
    s_add_u32 m0, s49, 2048
    v_mfma_f32_32x32x16_bf16 v[40:55], v[96:99], a[28:31], v[40:55]
    buffer_load_dwordx4 v190, s[4:7], s60 offen lds
    ds_read_b64_tr_b16 v[82:83], v177 offset:16896
    ds_read_b64_tr_b16 v[84:85], v181 offset:16384
    ds_read_b64_tr_b16 v[86:87], v181 offset:16896
    s_add_u32 m0, s49, 3072
    v_mfma_f32_32x32x16_bf16 v[56:71], v[100:103], a[28:31], v[56:71]
    buffer_load_dwordx4 v191, s[4:7], s60 offen lds
    s_add_u32 s53, s53, 1
    s_cmp_eq_u32 s53, 7
    s_cselect_b32 s53, 0, s53
    s_mul_i32 s33, s53, 172032
    s_lshl_b32 s60, s53, 7
    s_waitcnt lgkmcnt(4)
    v_mfma_f32_4x4x4bf16_1k v[160:163], a[32:33], a[32:33], v[160:163]
    v_mfma_f32_4x4x4bf16_1k v[168:171], v[134:135], a[32:33], v[168:171]
    v_mfma_f32_4x4x4bf16_1k v[164:167], a[34:35], a[34:35], v[164:167]
    v_mfma_f32_4x4x4bf16_1k v[172:175], v[134:135], a[34:35], v[172:175]
    v_mfma_f32_4x4x4bf16_1k v[160:163], a[36:37], a[36:37], v[160:163]
    v_mfma_f32_4x4x4bf16_1k v[168:171], v[134:135], a[36:37], v[168:171]
    v_mfma_f32_4x4x4bf16_1k v[164:167], a[38:39], a[38:39], v[164:167]
    v_mfma_f32_4x4x4bf16_1k v[172:175], v[134:135], a[38:39], v[172:175]
    v_mfma_f32_4x4x4bf16_1k v[104:107], v[134:135], v[72:73], v[104:107]
    v_mfma_f32_4x4x4bf16_1k v[108:111], v[134:135], v[76:77], v[108:111]
    s_nop 0
    v_mfma_f32_4x4x4bf16_1k v[104:107], v[134:135], v[74:75], v[104:107]
    v_mfma_f32_4x4x4bf16_1k v[108:111], v[134:135], v[78:79], v[108:111]
    v_mfma_f32_32x32x16_bf16 v[40:55], v[72:75], a[32:35], v[40:55]
    ds_read_b128 a[40:43], v186 offset:8192
    ds_read_b128 a[44:47], v187 offset:8192
    ds_read_b64_tr_b16 v[88:89], v178 offset:16384
    ds_read_b64_tr_b16 v[90:91], v178 offset:16896
    s_add_u32 m0, s51, 32768
    v_mfma_f32_32x32x16_bf16 v[56:71], v[76:79], a[32:35], v[56:71]
    buffer_load_dwordx4 v26, s[8:11], s33 offen lds
    ds_read_b64_tr_b16 v[92:93], v182 offset:16384
    ds_read_b64_tr_b16 v[94:95], v182 offset:16896
    ds_read_b64_tr_b16 v[96:97], v179 offset:16384
    s_waitcnt lgkmcnt(7)
    s_add_u32 m0, s51, 33792
    v_mfma_f32_32x32x16_bf16 v[40:55], v[80:83], a[36:39], v[40:55]
    buffer_load_dwordx4 v27, s[8:11], s33 offen lds
    ds_read_b64_tr_b16 v[98:99], v179 offset:16896
    ds_read_b64_tr_b16 v[100:101], v183 offset:16384
    ds_read_b64_tr_b16 v[102:103], v183 offset:16896
    s_add_u32 m0, s49, 4096
    v_mfma_f32_32x32x16_bf16 v[56:71], v[84:87], a[36:39], v[56:71]
    buffer_load_dwordx4 v188, s[4:7], s60 offen lds
    s_waitcnt lgkmcnt(8)
    v_mfma_f32_4x4x4bf16_1k v[160:163], a[40:41], a[40:41], v[160:163]
    v_mfma_f32_4x4x4bf16_1k v[168:171], v[134:135], a[40:41], v[168:171]
    v_mfma_f32_4x4x4bf16_1k v[164:167], a[42:43], a[42:43], v[164:167]
    v_mfma_f32_4x4x4bf16_1k v[172:175], v[134:135], a[42:43], v[172:175]
    v_mfma_f32_4x4x4bf16_1k v[160:163], a[44:45], a[44:45], v[160:163]
    v_mfma_f32_4x4x4bf16_1k v[168:171], v[134:135], a[44:45], v[168:171]
    v_mfma_f32_4x4x4bf16_1k v[164:167], a[46:47], a[46:47], v[164:167]
    v_mfma_f32_4x4x4bf16_1k v[172:175], v[134:135], a[46:47], v[172:175]
    s_waitcnt lgkmcnt(4)
    v_mfma_f32_32x32x16_bf16 v[40:55], v[88:91], a[40:43], v[40:55]
    s_waitcnt vmcnt(3)
    s_barrier
    ds_read_b128 a[48:51], v184 offset:0
    ds_read_b128 a[52:55], v185 offset:0
    ds_read_b64_tr_b16 v[72:73], v176 offset:24576
    ds_read_b64_tr_b16 v[74:75], v176 offset:25088
    s_add_u32 m0, s49, 5120
    v_mfma_f32_32x32x16_bf16 v[56:71], v[92:95], a[40:43], v[56:71]
    buffer_load_dwordx4 v189, s[4:7], s60 offen lds
    ds_read_b64_tr_b16 v[76:77], v180 offset:24576
    ds_read_b64_tr_b16 v[78:79], v180 offset:25088
    ds_read_b64_tr_b16 v[80:81], v177 offset:24576
    s_waitcnt lgkmcnt(7)
    s_add_u32 m0, s49, 6144
    v_mfma_f32_32x32x16_bf16 v[40:55], v[96:99], a[44:47], v[40:55]
    buffer_load_dwordx4 v190, s[4:7], s60 offen lds
    ds_read_b64_tr_b16 v[82:83], v177 offset:25088
    ds_read_b64_tr_b16 v[84:85], v181 offset:24576
    ds_read_b64_tr_b16 v[86:87], v181 offset:25088
    s_add_u32 m0, s49, 7168
    v_mfma_f32_32x32x16_bf16 v[56:71], v[100:103], a[44:47], v[56:71]
    buffer_load_dwordx4 v191, s[4:7], s60 offen lds
    s_add_u32 s53, s53, 1
    s_cmp_eq_u32 s53, 7
    s_cselect_b32 s53, 0, s53
    s_mul_i32 s33, s53, 172032
    s_lshl_b32 s60, s53, 7
    s_waitcnt lgkmcnt(4)
    v_mfma_f32_4x4x4bf16_1k v[160:163], a[48:49], a[48:49], v[160:163]
    v_mfma_f32_4x4x4bf16_1k v[168:171], v[134:135], a[48:49], v[168:171]
    v_mfma_f32_4x4x4bf16_1k v[164:167], a[50:51], a[50:51], v[164:167]
    v_mfma_f32_4x4x4bf16_1k v[172:175], v[134:135], a[50:51], v[172:175]
    v_mfma_f32_4x4x4bf16_1k v[160:163], a[52:53], a[52:53], v[160:163]
    v_mfma_f32_4x4x4bf16_1k v[168:171], v[134:135], a[52:53], v[168:171]
    v_mfma_f32_4x4x4bf16_1k v[164:167], a[54:55], a[54:55], v[164:167]
    v_mfma_f32_4x4x4bf16_1k v[172:175], v[134:135], a[54:55], v[172:175]
    v_mfma_f32_4x4x4bf16_1k v[104:107], v[134:135], v[72:73], v[104:107]
    v_mfma_f32_4x4x4bf16_1k v[108:111], v[134:135], v[76:77], v[108:111]
    s_nop 0
    v_mfma_f32_4x4x4bf16_1k v[104:107], v[134:135], v[74:75], v[104:107]
    v_mfma_f32_4x4x4bf16_1k v[108:111], v[134:135], v[78:79], v[108:111]
    v_mfma_f32_32x32x16_bf16 v[40:55], v[72:75], a[48:51], v[40:55]
    ds_read_b128 a[56:59], v186 offset:0
    ds_read_b128 a[60:63], v187 offset:0
    ds_read_b64_tr_b16 v[88:89], v178 offset:24576
    ds_read_b64_tr_b16 v[90:91], v178 offset:25088
    s_add_u32 m0, s51, 40960
    v_mfma_f32_32x32x16_bf16 v[56:71], v[76:79], a[48:51], v[56:71]
    buffer_load_dwordx4 v26, s[8:11], s33 offen lds
    ds_read_b64_tr_b16 v[92:93], v182 offset:24576
    ds_read_b64_tr_b16 v[94:95], v182 offset:25088
    ds_read_b64_tr_b16 v[96:97], v179 offset:24576
    s_waitcnt lgkmcnt(7)
    s_add_u32 m0, s51, 41984
    v_mfma_f32_32x32x16_bf16 v[40:55], v[80:83], a[52:55], v[40:55]
    buffer_load_dwordx4 v27, s[8:11], s33 offen lds
    ds_read_b64_tr_b16 v[98:99], v179 offset:25088
    ds_read_b64_tr_b16 v[100:101], v183 offset:24576
    ds_read_b64_tr_b16 v[102:103], v183 offset:25088
    s_add_u32 m0, s49, 8192
    v_mfma_f32_32x32x16_bf16 v[56:71], v[84:87], a[52:55], v[56:71]
    buffer_load_dwordx4 v188, s[4:7], s60 offen lds
    s_waitcnt lgkmcnt(8)
    v_mfma_f32_4x4x4bf16_1k v[160:163], a[56:57], a[56:57], v[160:163]
    v_mfma_f32_4x4x4bf16_1k v[168:171], v[134:135], a[56:57], v[168:171]
    v_mfma_f32_4x4x4bf16_1k v[164:167], a[58:59], a[58:59], v[164:167]
    v_mfma_f32_4x4x4bf16_1k v[172:175], v[134:135], a[58:59], v[172:175]
    v_mfma_f32_4x4x4bf16_1k v[160:163], a[60:61], a[60:61], v[160:163]
    v_mfma_f32_4x4x4bf16_1k v[168:171], v[134:135], a[60:61], v[168:171]
    v_mfma_f32_4x4x4bf16_1k v[164:167], a[62:63], a[62:63], v[164:167]
    v_mfma_f32_4x4x4bf16_1k v[172:175], v[134:135], a[62:63], v[172:175]
    s_waitcnt lgkmcnt(4)
    v_mfma_f32_32x32x16_bf16 v[40:55], v[88:91], a[56:59], v[40:55]
    s_waitcnt vmcnt(3)
    s_barrier
    ds_read_b128 a[64:67], v184 offset:4096
    ds_read_b128 a[68:71], v185 offset:4096
    ds_read_b64_tr_b16 v[72:73], v176 offset:32768
    ds_read_b64_tr_b16 v[74:75], v176 offset:33280
    s_add_u32 m0, s49, 9216
    v_mfma_f32_32x32x16_bf16 v[56:71], v[92:95], a[56:59], v[56:71]
    buffer_load_dwordx4 v189, s[4:7], s60 offen lds
    ds_read_b64_tr_b16 v[76:77], v180 offset:32768
    ds_read_b64_tr_b16 v[78:79], v180 offset:33280
    ds_read_b64_tr_b16 v[80:81], v177 offset:32768
    s_waitcnt lgkmcnt(7)
    s_add_u32 m0, s49, 10240
    v_mfma_f32_32x32x16_bf16 v[40:55], v[96:99], a[60:63], v[40:55]
    buffer_load_dwordx4 v190, s[4:7], s60 offen lds
    ds_read_b64_tr_b16 v[82:83], v177 offset:33280
    ds_read_b64_tr_b16 v[84:85], v181 offset:32768
    ds_read_b64_tr_b16 v[86:87], v181 offset:33280
    s_add_u32 m0, s49, 11264
    v_mfma_f32_32x32x16_bf16 v[56:71], v[100:103], a[60:63], v[56:71]
    buffer_load_dwordx4 v191, s[4:7], s60 offen lds
    s_add_u32 s53, s53, 1
    s_cmp_eq_u32 s53, 7
    s_cselect_b32 s53, 0, s53
    s_mul_i32 s33, s53, 172032
    s_lshl_b32 s60, s53, 7
    s_waitcnt lgkmcnt(4)
    v_mfma_f32_4x4x4bf16_1k v[160:163], a[64:65], a[64:65], v[160:163]
    v_mfma_f32_4x4x4bf16_1k v[168:171], v[134:135], a[64:65], v[168:171]
    v_mfma_f32_4x4x4bf16_1k v[164:167], a[66:67], a[66:67], v[164:167]
    v_mfma_f32_4x4x4bf16_1k v[172:175], v[134:135], a[66:67], v[172:175]
    v_mfma_f32_4x4x4bf16_1k v[160:163], a[68:69], a[68:69], v[160:163]
    v_mfma_f32_4x4x4bf16_1k v[168:171], v[134:135], a[68:69], v[168:171]
    v_mfma_f32_4x4x4bf16_1k v[164:167], a[70:71], a[70:71], v[164:167]
    v_mfma_f32_4x4x4bf16_1k v[172:175], v[134:135], a[70:71], v[172:175]
    v_mfma_f32_4x4x4bf16_1k v[104:107], v[134:135], v[72:73], v[104:107]
    v_mfma_f32_4x4x4bf16_1k v[108:111], v[134:135], v[76:77], v[108:111]
    s_nop 0
    v_mfma_f32_4x4x4bf16_1k v[104:107], v[134:135], v[74:75], v[104:107]
    v_mfma_f32_4x4x4bf16_1k v[108:111], v[134:135], v[78:79], v[108:111]
    v_mfma_f32_32x32x16_bf16 v[40:55], v[72:75], a[64:67], v[40:55]
    ds_read_b128 a[72:75], v186 offset:4096
    ds_read_b128 a[76:79], v187 offset:4096
    ds_read_b64_tr_b16 v[88:89], v178 offset:32768
    ds_read_b64_tr_b16 v[90:91], v178 offset:33280
    s_add_u32 m0, s51, 49152
    v_mfma_f32_32x32x16_bf16 v[56:71], v[76:79], a[64:67], v[56:71]
    buffer_load_dwordx4 v26, s[8:11], s33 offen lds
    ds_read_b64_tr_b16 v[92:93], v182 offset:32768
    ds_read_b64_tr_b16 v[94:95], v182 offset:33280
    ds_read_b64_tr_b16 v[96:97], v179 offset:32768
    s_waitcnt lgkmcnt(7)
    s_add_u32 m0, s51, 50176
    v_mfma_f32_32x32x16_bf16 v[40:55], v[80:83], a[68:71], v[40:55]
    buffer_load_dwordx4 v27, s[8:11], s33 offen lds
    ds_read_b64_tr_b16 v[98:99], v179 offset:33280
    ds_read_b64_tr_b16 v[100:101], v183 offset:32768
    ds_read_b64_tr_b16 v[102:103], v183 offset:33280
    s_add_u32 m0, s49, 0
    v_mfma_f32_32x32x16_bf16 v[56:71], v[84:87], a[68:71], v[56:71]
    buffer_load_dwordx4 v188, s[4:7], s60 offen lds
    s_waitcnt lgkmcnt(8)
    v_mfma_f32_4x4x4bf16_1k v[160:163], a[72:73], a[72:73], v[160:163]
    v_mfma_f32_4x4x4bf16_1k v[168:171], v[134:135], a[72:73], v[168:171]
    v_mfma_f32_4x4x4bf16_1k v[164:167], a[74:75], a[74:75], v[164:167]
    v_mfma_f32_4x4x4bf16_1k v[172:175], v[134:135], a[74:75], v[172:175]
    v_mfma_f32_4x4x4bf16_1k v[160:163], a[76:77], a[76:77], v[160:163]
    v_mfma_f32_4x4x4bf16_1k v[168:171], v[134:135], a[76:77], v[168:171]
    v_mfma_f32_4x4x4bf16_1k v[164:167], a[78:79], a[78:79], v[164:167]
    v_mfma_f32_4x4x4bf16_1k v[172:175], v[134:135], a[78:79], v[172:175]
    s_waitcnt lgkmcnt(4)
    v_mfma_f32_32x32x16_bf16 v[40:55], v[88:91], a[72:75], v[40:55]
    s_waitcnt vmcnt(3)
    s_barrier
    ds_read_b128 a[80:83], v184 offset:8192
    ds_read_b128 a[84:87], v185 offset:8192
    ds_read_b64_tr_b16 v[72:73], v176 offset:40960
    ds_read_b64_tr_b16 v[74:75], v176 offset:41472
    s_add_u32 m0, s49, 1024
    v_mfma_f32_32x32x16_bf16 v[56:71], v[92:95], a[72:75], v[56:71]
    buffer_load_dwordx4 v189, s[4:7], s60 offen lds
    ds_read_b64_tr_b16 v[76:77], v180 offset:40960
    ds_read_b64_tr_b16 v[78:79], v180 offset:41472
    ds_read_b64_tr_b16 v[80:81], v177 offset:40960
    s_waitcnt lgkmcnt(7)
    s_add_u32 m0, s49, 2048
    v_mfma_f32_32x32x16_bf16 v[40:55], v[96:99], a[76:79], v[40:55]
    buffer_load_dwordx4 v190, s[4:7], s60 offen lds
    ds_read_b64_tr_b16 v[82:83], v177 offset:41472
    ds_read_b64_tr_b16 v[84:85], v181 offset:40960
    ds_read_b64_tr_b16 v[86:87], v181 offset:41472
    s_add_u32 m0, s49, 3072
    v_mfma_f32_32x32x16_bf16 v[56:71], v[100:103], a[76:79], v[56:71]
    buffer_load_dwordx4 v191, s[4:7], s60 offen lds
    s_add_u32 s53, s53, 1
    s_cmp_eq_u32 s53, 7
    s_cselect_b32 s53, 0, s53
    s_mul_i32 s33, s53, 172032
    s_lshl_b32 s60, s53, 7
    s_waitcnt lgkmcnt(4)
    v_mfma_f32_4x4x4bf16_1k v[160:163], a[80:81], a[80:81], v[160:163]
    v_mfma_f32_4x4x4bf16_1k v[168:171], v[134:135], a[80:81], v[168:171]
    v_mfma_f32_4x4x4bf16_1k v[164:167], a[82:83], a[82:83], v[164:167]
    v_mfma_f32_4x4x4bf16_1k v[172:175], v[134:135], a[82:83], v[172:175]
    v_mfma_f32_4x4x4bf16_1k v[160:163], a[84:85], a[84:85], v[160:163]
    v_mfma_f32_4x4x4bf16_1k v[168:171], v[134:135], a[84:85], v[168:171]
    v_mfma_f32_4x4x4bf16_1k v[164:167], a[86:87], a[86:87], v[164:167]
    v_mfma_f32_4x4x4bf16_1k v[172:175], v[134:135], a[86:87], v[172:175]
    v_mfma_f32_4x4x4bf16_1k v[104:107], v[134:135], v[72:73], v[104:107]
    v_mfma_f32_4x4x4bf16_1k v[108:111], v[134:135], v[76:77], v[108:111]
    s_nop 0
    v_mfma_f32_4x4x4bf16_1k v[104:107], v[134:135], v[74:75], v[104:107]
    v_mfma_f32_4x4x4bf16_1k v[108:111], v[134:135], v[78:79], v[108:111]
    v_mfma_f32_32x32x16_bf16 v[40:55], v[72:75], a[80:83], v[40:55]
    ds_read_b128 a[88:91], v186 offset:8192
    ds_read_b128 a[92:95], v187 offset:8192
    ds_read_b64_tr_b16 v[88:89], v178 offset:40960
    ds_read_b64_tr_b16 v[90:91], v178 offset:41472
    s_add_u32 m0, s52, 0
    v_mfma_f32_32x32x16_bf16 v[56:71], v[76:79], a[80:83], v[56:71]
    buffer_load_dwordx4 v202, s[8:11], s33 offen lds
    s_add_u32 s53, s53, 1
    s_cmp_eq_u32 s53, 7
    s_cselect_b32 s53, 0, s53
    s_mul_i32 s33, s53, 172032
    s_add_u32 m0, s52, 4096
    s_nop 0
    buffer_load_dwordx4 v202, s[8:11], s33 offen lds
    s_add_u32 s53, s53, 1
    s_cmp_eq_u32 s53, 7
    s_cselect_b32 s53, 0, s53
    s_mul_i32 s33, s53, 172032
    ds_read_b64_tr_b16 v[92:93], v182 offset:40960
    ds_read_b64_tr_b16 v[94:95], v182 offset:41472
    ds_read_b64_tr_b16 v[96:97], v179 offset:40960
    s_waitcnt lgkmcnt(7)
    s_add_u32 m0, s52, 8192
    v_mfma_f32_32x32x16_bf16 v[40:55], v[80:83], a[84:87], v[40:55]
    buffer_load_dwordx4 v202, s[8:11], s33 offen lds
    s_add_u32 s53, s53, 1
    s_cmp_eq_u32 s53, 7
    s_cselect_b32 s53, 0, s53
    s_mul_i32 s33, s53, 172032
    s_add_u32 m0, s52, 12288
    s_nop 0
    buffer_load_dwordx4 v202, s[8:11], s33 offen lds
    s_add_u32 s53, s53, 1
    s_cmp_eq_u32 s53, 7
    s_cselect_b32 s53, 0, s53
    s_mul_i32 s33, s53, 172032
    ds_read_b64_tr_b16 v[98:99], v179 offset:41472
    ds_read_b64_tr_b16 v[100:101], v183 offset:40960
    ds_read_b64_tr_b16 v[102:103], v183 offset:41472
    s_add_u32 m0, s52, 16384
    v_mfma_f32_32x32x16_bf16 v[56:71], v[84:87], a[84:87], v[56:71]
    buffer_load_dwordx4 v202, s[8:11], s33 offen lds
    s_add_u32 s53, s53, 1
    s_cmp_eq_u32 s53, 7
    s_cselect_b32 s53, 0, s53
    s_mul_i32 s33, s53, 172032
    s_add_u32 m0, s52, 20480
    s_nop 0
    buffer_load_dwordx4 v202, s[8:11], s33 offen lds
    s_add_u32 s53, s53, 1
    s_cmp_eq_u32 s53, 7
    s_cselect_b32 s53, 0, s53
    s_mul_i32 s33, s53, 172032
    s_waitcnt lgkmcnt(8)
    v_mfma_f32_4x4x4bf16_1k v[160:163], a[88:89], a[88:89], v[160:163]
    v_mfma_f32_4x4x4bf16_1k v[168:171], v[134:135], a[88:89], v[168:171]
    v_mfma_f32_4x4x4bf16_1k v[164:167], a[90:91], a[90:91], v[164:167]
    v_mfma_f32_4x4x4bf16_1k v[172:175], v[134:135], a[90:91], v[172:175]
    v_mfma_f32_4x4x4bf16_1k v[160:163], a[92:93], a[92:93], v[160:163]
    v_mfma_f32_4x4x4bf16_1k v[168:171], v[134:135], a[92:93], v[168:171]
    v_mfma_f32_4x4x4bf16_1k v[164:167], a[94:95], a[94:95], v[164:167]
    v_mfma_f32_4x4x4bf16_1k v[172:175], v[134:135], a[94:95], v[172:175]
    s_waitcnt lgkmcnt(4)
    v_mfma_f32_32x32x16_bf16 v[40:55], v[88:91], a[88:91], v[40:55]
    s_waitcnt vmcnt(6)
    s_barrier
    ds_read_b64_tr_b16 v[72:73], v176 offset:49152
    ds_read_b64_tr_b16 v[74:75], v176 offset:49664
    ds_read_b64_tr_b16 v[76:77], v180 offset:49152
    ds_read_b64_tr_b16 v[78:79], v180 offset:49664
    s_add_u32 m0, s52, 24576
    v_mfma_f32_32x32x16_bf16 v[56:71], v[92:95], a[88:91], v[56:71]
    buffer_load_dwordx4 v202, s[8:11], s33 offen lds
    s_add_u32 s53, s53, 1
    s_cmp_eq_u32 s53, 7
    s_cselect_b32 s53, 0, s53
    s_mul_i32 s33, s53, 172032
    ds_read_b128 a[96:99], v184 offset:0
    ds_read_b128 a[100:103], v185 offset:0
    ds_read_b64_tr_b16 v[80:81], v177 offset:49152
    s_waitcnt lgkmcnt(7)
    v_mfma_f32_32x32x16_bf16 v[40:55], v[96:99], a[92:95], v[40:55]
    ds_read_b64_tr_b16 v[82:83], v177 offset:49664
    ds_read_b64_tr_b16 v[84:85], v181 offset:49152
    ds_read_b64_tr_b16 v[86:87], v181 offset:49664
    v_mfma_f32_32x32x16_bf16 v[56:71], v[100:103], a[92:95], v[56:71]
    ds_read_b128 a[104:107], v186 offset:0
    ds_read_b128 a[108:111], v187 offset:0
    s_waitcnt lgkmcnt(8)
    v_mfma_f32_4x4x4bf16_1k v[104:107], v[134:135], v[72:73], v[104:107]
    v_mfma_f32_4x4x4bf16_1k v[108:111], v[134:135], v[76:77], v[108:111]
    s_nop 0
    v_mfma_f32_4x4x4bf16_1k v[104:107], v[134:135], v[74:75], v[104:107]
    v_mfma_f32_4x4x4bf16_1k v[108:111], v[134:135], v[78:79], v[108:111]
    s_waitcnt lgkmcnt(6)
    v_mfma_f32_4x4x4bf16_1k v[160:163], a[96:97], a[96:97], v[160:163]
    v_mfma_f32_4x4x4bf16_1k v[168:171], v[134:135], a[96:97], v[168:171]
    v_mfma_f32_4x4x4bf16_1k v[164:167], a[98:99], a[98:99], v[164:167]
    v_mfma_f32_4x4x4bf16_1k v[172:175], v[134:135], a[98:99], v[172:175]
    ds_write_b32 v196, v104 offset:0
    ds_write_b32 v196, v108 offset:1024
    ds_read_b64_tr_b16 v[88:89], v178 offset:49152
    ds_read_b64_tr_b16 v[90:91], v178 offset:49664
    ds_read_b64_tr_b16 v[92:93], v182 offset:49152
    ds_read_b64_tr_b16 v[94:95], v182 offset:49664
    v_mfma_f32_4x4x4bf16_1k v[160:163], a[100:101], a[100:101], v[160:163]
    v_mfma_f32_4x4x4bf16_1k v[168:171], v[134:135], a[100:101], v[168:171]
    v_mfma_f32_4x4x4bf16_1k v[164:167], a[102:103], a[102:103], v[164:167]
    v_mfma_f32_4x4x4bf16_1k v[172:175], v[134:135], a[102:103], v[172:175]
    ds_read_b64_tr_b16 v[96:97], v179 offset:49152
    ds_read_b64_tr_b16 v[98:99], v179 offset:49664
    ds_read_b64_tr_b16 v[100:101], v183 offset:49152
    ds_read_b64_tr_b16 v[102:103], v183 offset:49664
    s_waitcnt lgkmcnt(10)
    v_mfma_f32_4x4x4bf16_1k v[160:163], a[104:105], a[104:105], v[160:163]
    v_mfma_f32_4x4x4bf16_1k v[168:171], v[134:135], a[104:105], v[168:171]
    v_mfma_f32_4x4x4bf16_1k v[164:167], a[106:107], a[106:107], v[164:167]
    v_mfma_f32_4x4x4bf16_1k v[172:175], v[134:135], a[106:107], v[172:175]
    s_waitcnt lgkmcnt(8)
    s_barrier
    ds_read_b128 v[116:119], v197 offset:0
    ds_read_b128 v[120:123], v197 offset:1024
    v_mfma_f32_4x4x4bf16_1k v[160:163], a[108:109], a[108:109], v[160:163]
    v_mfma_f32_4x4x4bf16_1k v[168:171], v[134:135], a[108:109], v[168:171]
    v_mfma_f32_4x4x4bf16_1k v[164:167], a[110:111], a[110:111], v[164:167]
    v_mfma_f32_4x4x4bf16_1k v[172:175], v[134:135], a[110:111], v[172:175]
    v_mfma_f32_32x32x16_bf16 v[40:55], v[72:75], a[96:99], v[40:55]
    v_mfma_f32_32x32x16_bf16 v[40:55], v[80:83], a[100:103], v[40:55]
    s_nop 1
    v_add_f32 v160, v160, v164
    v_add_f32 v161, v161, v165
    v_add_f32 v162, v162, v166
    v_add_f32 v163, v163, v167
    v_add_f32 v168, v168, v172
    v_cndmask_b32 v160, v160, v161, s[0:1]
    s_waitcnt lgkmcnt(6)
    v_mfma_f32_32x32x16_bf16 v[40:55], v[88:91], a[104:107], v[40:55]
    s_waitcnt lgkmcnt(0)
    v_cndmask_b32 v160, v160, v162, s[86:87]
    v_add_f32 v116, v116, v117
    v_cndmask_b32 v160, v160, v163, vcc
    v_add_f32 v120, v120, v121
    s_nop 0
    v_permlane32_swap_b32 v168, v160
    v_add_f32 v116, v116, v118
    v_mfma_f32_32x32x16_bf16 v[40:55], v[96:99], a[108:111], v[40:55]
    v_add_f32 v168, v168, v160
    v_add_f32 v120, v120, v122
    v_mov_b32 v160, v168
    v_add_f32 v116, v116, v119
    s_nop 0
    v_permlane32_swap_b32 v168, v160
    v_add_f32_e64 v120, v120, v123
    v_mfma_f32_32x32x16_bf16 v[56:71], v[76:79], a[96:99], v[56:71]
    v_mul_f32 v168, 0xbb124925, v168
    v_cvt_pk_bf16_f32 v124, v116, v116
    v_mul_f32 v160, 0x3b124925, v160
    v_cvt_pk_bf16_f32 v126, v120, v120
    v_cvt_pk_bf16_f32 v136, v168, v168
    v_and_b32 v125, 0xffff0000, v124
    v_mfma_f32_32x32x16_bf16 v[56:71], v[84:87], a[100:103], v[56:71]
    v_fma_f32 v160, -v168, v168, v160
    v_and_b32 v127, 0xffff0000, v126
    v_and_b32 v136, 0xffff0000, v136
    v_sub_f32 v125, v116, v125
    v_max_f32 v160, 0, v160
    v_sub_f32_e64 v127, v120, v127
    v_mfma_f32_32x32x16_bf16 v[56:71], v[92:95], a[104:107], v[56:71]
    v_sub_f32_e64 v136, v168, v136
    v_cvt_pk_bf16_f32 v125, v125, v125
    v_add_f32 v132, 0x3727c5ac, v160
    v_cvt_pk_bf16_f32 v127, v127, v127
    v_cvt_pk_bf16_f32 v130, v168, v136
    v_cvt_pk_bf16_f32 v131, v168, v136
    v_mfma_f32_32x32x16_bf16 v[56:71], v[100:103], a[108:111], v[56:71]
    v_rsq_f32_e64 v132, v132
    v_mfma_f32_32x32x8bf16_1k v[40:55], v[124:125], v[130:131], v[40:55]
    v_mfma_f32_32x32x8bf16_1k v[56:71], v[126:127], v[130:131], v[56:71]
    s_add_u32 s57, s50, 131072
    s_nop 9
    v_pk_mul_f32 v[40:41], v[40:41], v[132:133] op_sel_hi:[1,0]
    v_pk_mul_f32 v[42:43], v[42:43], v[132:133] op_sel_hi:[1,0]
    v_pk_mul_f32 v[44:45], v[44:45], v[132:133] op_sel_hi:[1,0]
    v_pk_mul_f32 v[46:47], v[46:47], v[132:133] op_sel_hi:[1,0]
    v_cvt_pk_bf16_f32 v144, v40, v41
    v_cvt_pk_bf16_f32 v145, v42, v43
    v_cvt_pk_bf16_f32 v146, v44, v45
    v_cvt_pk_bf16_f32 v147, v46, v47
    buffer_store_dwordx4 v[144:147], v1, s[12:15], s50 offen offset:0 sc1
    v_pk_mul_f32 v[48:49], v[48:49], v[132:133] op_sel_hi:[1,0]
    v_pk_mul_f32 v[50:51], v[50:51], v[132:133] op_sel_hi:[1,0]
    v_pk_mul_f32 v[52:53], v[52:53], v[132:133] op_sel_hi:[1,0]
    v_pk_mul_f32 v[54:55], v[54:55], v[132:133] op_sel_hi:[1,0]
    v_cvt_pk_bf16_f32 v148, v48, v49
    v_cvt_pk_bf16_f32 v149, v50, v51
    v_cvt_pk_bf16_f32 v150, v52, v53
    v_cvt_pk_bf16_f32 v151, v54, v55
    s_mov_b32 exec_lo, 0
    v_mov_b32_e64 v150, s41
    v_mov_b32 v151, 0x3f80
    s_mov_b32 exec_lo, -1
    buffer_store_dwordx4 v[148:151], v1, s[12:15], s50 offen offset:1024 sc1
    v_pk_mul_f32 v[56:57], v[56:57], v[132:133] op_sel_hi:[1,0]
    v_pk_mul_f32 v[58:59], v[58:59], v[132:133] op_sel_hi:[1,0]
    v_pk_mul_f32 v[60:61], v[60:61], v[132:133] op_sel_hi:[1,0]
    v_pk_mul_f32 v[62:63], v[62:63], v[132:133] op_sel_hi:[1,0]
    v_cvt_pk_bf16_f32 v152, v56, v57
    v_cvt_pk_bf16_f32 v153, v58, v59
    v_cvt_pk_bf16_f32 v154, v60, v61
    v_cvt_pk_bf16_f32 v155, v62, v63
    buffer_store_dwordx4 v[152:155], v1, s[12:15], s57 offen offset:0 sc1
    v_pk_mul_f32 v[64:65], v[64:65], v[132:133] op_sel_hi:[1,0]
    v_pk_mul_f32 v[66:67], v[66:67], v[132:133] op_sel_hi:[1,0]
    v_pk_mul_f32 v[68:69], v[68:69], v[132:133] op_sel_hi:[1,0]
    v_pk_mul_f32 v[70:71], v[70:71], v[132:133] op_sel_hi:[1,0]
    v_cvt_pk_bf16_f32 v156, v64, v65
    v_cvt_pk_bf16_f32 v157, v66, v67
    v_cvt_pk_bf16_f32 v158, v68, v69
    v_cvt_pk_bf16_f32 v159, v70, v71
    s_mov_b32 exec_lo, 0
    v_mov_b32_e64 v158, s41
    v_mov_b32 v159, 0x3f80
    s_mov_b32 exec_lo, -1
    buffer_store_dwordx4 v[156:159], v1, s[12:15], s57 offen offset:1024 sc1
    s_branch L_q
L_v:
    s_waitcnt vmcnt(7)
    s_barrier
    ds_read_b128 a[0:3], v184 offset:0
    ds_read_b128 a[4:7], v185 offset:0
    ds_read_b64_tr_b16 v[72:73], v176 offset:0
    ds_read_b64_tr_b16 v[74:75], v176 offset:512
    ds_read_b64_tr_b16 v[76:77], v180 offset:0
    ds_read_b64_tr_b16 v[78:79], v180 offset:512
    ds_read_b64_tr_b16 v[80:81], v177 offset:0
    ds_read_b64_tr_b16 v[82:83], v177 offset:512
    ds_read_b64_tr_b16 v[84:85], v181 offset:0
    ds_read_b64_tr_b16 v[86:87], v181 offset:512
    v_readfirstlane_b32 s39, v203
    s_add_u32 s39, s39, 0x9e3779b9
    s_nop 0
    v_mov_b32 v212, s39
    v_mov_b32 v213, s39
    v_mov_b32_e64 v214, s39
    v_mov_b32 v215, s39
    s_waitcnt lgkmcnt(4)
    v_mfma_f32_4x4x4bf16_1k v[160:163], a[0:1], a[0:1], 0
    v_mfma_f32_4x4x4bf16_1k v[168:171], v[134:135], a[0:1], 0
    v_mfma_f32_4x4x4bf16_1k v[164:167], a[2:3], a[2:3], 0
    v_mfma_f32_4x4x4bf16_1k v[172:175], v[134:135], a[2:3], 0
    v_mfma_f32_4x4x4bf16_1k v[160:163], a[4:5], a[4:5], v[160:163]
    v_mfma_f32_4x4x4bf16_1k v[168:171], v[134:135], a[4:5], v[168:171]
    v_mfma_f32_4x4x4bf16_1k v[164:167], a[6:7], a[6:7], v[164:167]
    v_mfma_f32_4x4x4bf16_1k v[172:175], v[134:135], a[6:7], v[172:175]
    v_mfma_f32_4x4x4bf16_1k v[104:107], v[134:135], v[72:73], 0
    v_mfma_f32_4x4x4bf16_1k v[108:111], v[134:135], v[76:77], 0
    s_nop 0
    v_mfma_f32_4x4x4bf16_1k v[104:107], v[134:135], v[74:75], v[104:107]
    v_mfma_f32_4x4x4bf16_1k v[108:111], v[134:135], v[78:79], v[108:111]
    v_mfma_f32_32x32x16_bf16 v[40:55], a[0:3], v[72:75], 0
    ds_read_b128 a[8:11], v186 offset:0
    ds_read_b128 a[12:15], v187 offset:0
    ds_read_b64_tr_b16 v[88:89], v178 offset:0
    ds_read_b64_tr_b16 v[90:91], v178 offset:512
    s_add_u32 m0, s51, 16384
    v_mfma_f32_32x32x16_bf16 v[56:71], a[0:3], v[76:79], 0
    buffer_load_dwordx4 v26, s[8:11], s33 offen lds
    ds_read_b64_tr_b16 v[92:93], v182 offset:0
    ds_read_b64_tr_b16 v[94:95], v182 offset:512
    ds_read_b64_tr_b16 v[96:97], v179 offset:0
    s_waitcnt lgkmcnt(7)
    s_add_u32 m0, s51, 17408
    v_mfma_f32_32x32x16_bf16 v[40:55], a[4:7], v[80:83], v[40:55]
    buffer_load_dwordx4 v27, s[8:11], s33 offen lds
    ds_read_b64_tr_b16 v[98:99], v179 offset:512
    ds_read_b64_tr_b16 v[100:101], v183 offset:0
    ds_read_b64_tr_b16 v[102:103], v183 offset:512
    s_add_u32 m0, s49, 8192
    v_mfma_f32_32x32x16_bf16 v[56:71], a[4:7], v[84:87], v[56:71]
    buffer_load_dwordx4 v188, s[4:7], s60 offen lds
    s_waitcnt lgkmcnt(8)
    v_mfma_f32_4x4x4bf16_1k v[160:163], a[8:9], a[8:9], v[160:163]
    v_mfma_f32_4x4x4bf16_1k v[168:171], v[134:135], a[8:9], v[168:171]
    v_mfma_f32_4x4x4bf16_1k v[164:167], a[10:11], a[10:11], v[164:167]
    v_mfma_f32_4x4x4bf16_1k v[172:175], v[134:135], a[10:11], v[172:175]
    v_mfma_f32_4x4x4bf16_1k v[160:163], a[12:13], a[12:13], v[160:163]
    v_mfma_f32_4x4x4bf16_1k v[168:171], v[134:135], a[12:13], v[168:171]
    v_mfma_f32_4x4x4bf16_1k v[164:167], a[14:15], a[14:15], v[164:167]
    v_mfma_f32_4x4x4bf16_1k v[172:175], v[134:135], a[14:15], v[172:175]
    s_waitcnt lgkmcnt(4)
    v_mfma_f32_32x32x16_bf16 v[40:55], a[8:11], v[88:91], v[40:55]
    s_waitcnt vmcnt(4)
    s_barrier
    ds_read_b128 a[16:19], v184 offset:4096
    ds_read_b128 a[20:23], v185 offset:4096
    ds_read_b64_tr_b16 v[72:73], v176 offset:8192
    ds_read_b64_tr_b16 v[74:75], v176 offset:8704
    s_add_u32 m0, s49, 9216
    v_mfma_f32_32x32x16_bf16 v[56:71], a[8:11], v[92:95], v[56:71]
    buffer_load_dwordx4 v189, s[4:7], s60 offen lds
    ds_read_b64_tr_b16 v[76:77], v180 offset:8192
    ds_read_b64_tr_b16 v[78:79], v180 offset:8704
    ds_read_b64_tr_b16 v[80:81], v177 offset:8192
    s_waitcnt lgkmcnt(7)
    s_add_u32 m0, s49, 10240
    v_mfma_f32_32x32x16_bf16 v[40:55], a[12:15], v[96:99], v[40:55]
    buffer_load_dwordx4 v190, s[4:7], s60 offen lds
    ds_read_b64_tr_b16 v[82:83], v177 offset:8704
    ds_read_b64_tr_b16 v[84:85], v181 offset:8192
    ds_read_b64_tr_b16 v[86:87], v181 offset:8704
    s_add_u32 m0, s49, 11264
    v_mfma_f32_32x32x16_bf16 v[56:71], a[12:15], v[100:103], v[56:71]
    buffer_load_dwordx4 v191, s[4:7], s60 offen lds
    s_add_u32 s53, s53, 1
    s_cmp_eq_u32 s53, 7
    s_cselect_b32 s53, 0, s53
    s_mul_i32 s33, s53, 172032
    s_lshl_b32 s60, s53, 7
    s_waitcnt lgkmcnt(4)
    v_mfma_f32_4x4x4bf16_1k v[160:163], a[16:17], a[16:17], v[160:163]
    v_mfma_f32_4x4x4bf16_1k v[168:171], v[134:135], a[16:17], v[168:171]
    v_mfma_f32_4x4x4bf16_1k v[164:167], a[18:19], a[18:19], v[164:167]
    v_mfma_f32_4x4x4bf16_1k v[172:175], v[134:135], a[18:19], v[172:175]
    v_mfma_f32_4x4x4bf16_1k v[160:163], a[20:21], a[20:21], v[160:163]
    v_mfma_f32_4x4x4bf16_1k v[168:171], v[134:135], a[20:21], v[168:171]
    v_mfma_f32_4x4x4bf16_1k v[164:167], a[22:23], a[22:23], v[164:167]
    v_mfma_f32_4x4x4bf16_1k v[172:175], v[134:135], a[22:23], v[172:175]
    v_mfma_f32_4x4x4bf16_1k v[104:107], v[134:135], v[72:73], v[104:107]
    v_mfma_f32_4x4x4bf16_1k v[108:111], v[134:135], v[76:77], v[108:111]
    s_nop 0
    v_mfma_f32_4x4x4bf16_1k v[104:107], v[134:135], v[74:75], v[104:107]
    v_mfma_f32_4x4x4bf16_1k v[108:111], v[134:135], v[78:79], v[108:111]
    v_mfma_f32_32x32x16_bf16 v[40:55], a[16:19], v[72:75], v[40:55]
    ds_read_b128 a[24:27], v186 offset:4096
    ds_read_b128 a[28:31], v187 offset:4096
    ds_read_b64_tr_b16 v[88:89], v178 offset:8192
    ds_read_b64_tr_b16 v[90:91], v178 offset:8704
    s_add_u32 m0, s51, 24576
    v_mfma_f32_32x32x16_bf16 v[56:71], a[16:19], v[76:79], v[56:71]
    buffer_load_dwordx4 v26, s[8:11], s33 offen lds
    ds_read_b64_tr_b16 v[92:93], v182 offset:8192
    ds_read_b64_tr_b16 v[94:95], v182 offset:8704
    ds_read_b64_tr_b16 v[96:97], v179 offset:8192
    s_waitcnt lgkmcnt(7)
    s_add_u32 m0, s51, 25600
    v_mfma_f32_32x32x16_bf16 v[40:55], a[20:23], v[80:83], v[40:55]
    buffer_load_dwordx4 v27, s[8:11], s33 offen lds
    ds_read_b64_tr_b16 v[98:99], v179 offset:8704
    ds_read_b64_tr_b16 v[100:101], v183 offset:8192
    ds_read_b64_tr_b16 v[102:103], v183 offset:8704
    s_add_u32 m0, s49, 0
    v_mfma_f32_32x32x16_bf16 v[56:71], a[20:23], v[84:87], v[56:71]
    buffer_load_dwordx4 v188, s[4:7], s60 offen lds
    s_waitcnt lgkmcnt(8)
    v_mfma_f32_4x4x4bf16_1k v[160:163], a[24:25], a[24:25], v[160:163]
    v_mfma_f32_4x4x4bf16_1k v[168:171], v[134:135], a[24:25], v[168:171]
    v_mfma_f32_4x4x4bf16_1k v[164:167], a[26:27], a[26:27], v[164:167]
    v_mfma_f32_4x4x4bf16_1k v[172:175], v[134:135], a[26:27], v[172:175]
    v_mfma_f32_4x4x4bf16_1k v[160:163], a[28:29], a[28:29], v[160:163]
    v_mfma_f32_4x4x4bf16_1k v[168:171], v[134:135], a[28:29], v[168:171]
    v_mfma_f32_4x4x4bf16_1k v[164:167], a[30:31], a[30:31], v[164:167]
    v_mfma_f32_4x4x4bf16_1k v[172:175], v[134:135], a[30:31], v[172:175]
    s_waitcnt lgkmcnt(4)
    v_mfma_f32_32x32x16_bf16 v[40:55], a[24:27], v[88:91], v[40:55]
    s_waitcnt vmcnt(3)
    s_barrier
    ds_read_b128 a[32:35], v184 offset:8192
    ds_read_b128 a[36:39], v185 offset:8192
    ds_read_b64_tr_b16 v[72:73], v176 offset:16384
    ds_read_b64_tr_b16 v[74:75], v176 offset:16896
    s_add_u32 m0, s49, 1024
    v_mfma_f32_32x32x16_bf16 v[56:71], a[24:27], v[92:95], v[56:71]
    buffer_load_dwordx4 v189, s[4:7], s60 offen lds
    ds_read_b64_tr_b16 v[76:77], v180 offset:16384
    ds_read_b64_tr_b16 v[78:79], v180 offset:16896
    ds_read_b64_tr_b16 v[80:81], v177 offset:16384
    s_waitcnt lgkmcnt(7)
    s_add_u32 m0, s49, 2048
    v_mfma_f32_32x32x16_bf16 v[40:55], a[28:31], v[96:99], v[40:55]
    buffer_load_dwordx4 v190, s[4:7], s60 offen lds
    ds_read_b64_tr_b16 v[82:83], v177 offset:16896
    ds_read_b64_tr_b16 v[84:85], v181 offset:16384
    ds_read_b64_tr_b16 v[86:87], v181 offset:16896
    s_add_u32 m0, s49, 3072
    v_mfma_f32_32x32x16_bf16 v[56:71], a[28:31], v[100:103], v[56:71]
    buffer_load_dwordx4 v191, s[4:7], s60 offen lds
    s_add_u32 s53, s53, 1
    s_cmp_eq_u32 s53, 7
    s_cselect_b32 s53, 0, s53
    s_mul_i32 s33, s53, 172032
    s_lshl_b32 s60, s53, 7
    s_waitcnt lgkmcnt(4)
    v_mfma_f32_4x4x4bf16_1k v[160:163], a[32:33], a[32:33], v[160:163]
    v_mfma_f32_4x4x4bf16_1k v[168:171], v[134:135], a[32:33], v[168:171]
    v_mfma_f32_4x4x4bf16_1k v[164:167], a[34:35], a[34:35], v[164:167]
    v_mfma_f32_4x4x4bf16_1k v[172:175], v[134:135], a[34:35], v[172:175]
    v_mfma_f32_4x4x4bf16_1k v[160:163], a[36:37], a[36:37], v[160:163]
    v_mfma_f32_4x4x4bf16_1k v[168:171], v[134:135], a[36:37], v[168:171]
    v_mfma_f32_4x4x4bf16_1k v[164:167], a[38:39], a[38:39], v[164:167]
    v_mfma_f32_4x4x4bf16_1k v[172:175], v[134:135], a[38:39], v[172:175]
    v_mfma_f32_4x4x4bf16_1k v[104:107], v[134:135], v[72:73], v[104:107]
    v_mfma_f32_4x4x4bf16_1k v[108:111], v[134:135], v[76:77], v[108:111]
    s_nop 0
    v_mfma_f32_4x4x4bf16_1k v[104:107], v[134:135], v[74:75], v[104:107]
    v_mfma_f32_4x4x4bf16_1k v[108:111], v[134:135], v[78:79], v[108:111]
    v_mfma_f32_32x32x16_bf16 v[40:55], a[32:35], v[72:75], v[40:55]
    ds_read_b128 a[40:43], v186 offset:8192
    ds_read_b128 a[44:47], v187 offset:8192
    ds_read_b64_tr_b16 v[88:89], v178 offset:16384
    ds_read_b64_tr_b16 v[90:91], v178 offset:16896
    s_add_u32 m0, s51, 32768
    v_mfma_f32_32x32x16_bf16 v[56:71], a[32:35], v[76:79], v[56:71]
    buffer_load_dwordx4 v26, s[8:11], s33 offen lds
    ds_read_b64_tr_b16 v[92:93], v182 offset:16384
    ds_read_b64_tr_b16 v[94:95], v182 offset:16896
    ds_read_b64_tr_b16 v[96:97], v179 offset:16384
    s_waitcnt lgkmcnt(7)
    s_add_u32 m0, s51, 33792
    v_mfma_f32_32x32x16_bf16 v[40:55], a[36:39], v[80:83], v[40:55]
    buffer_load_dwordx4 v27, s[8:11], s33 offen lds
    ds_read_b64_tr_b16 v[98:99], v179 offset:16896
    ds_read_b64_tr_b16 v[100:101], v183 offset:16384
    ds_read_b64_tr_b16 v[102:103], v183 offset:16896
    s_add_u32 m0, s49, 4096
    v_mfma_f32_32x32x16_bf16 v[56:71], a[36:39], v[84:87], v[56:71]
    buffer_load_dwordx4 v188, s[4:7], s60 offen lds
    s_waitcnt lgkmcnt(8)
    v_mfma_f32_4x4x4bf16_1k v[160:163], a[40:41], a[40:41], v[160:163]
    v_mfma_f32_4x4x4bf16_1k v[168:171], v[134:135], a[40:41], v[168:171]
    v_mfma_f32_4x4x4bf16_1k v[164:167], a[42:43], a[42:43], v[164:167]
    v_mfma_f32_4x4x4bf16_1k v[172:175], v[134:135], a[42:43], v[172:175]
    v_mfma_f32_4x4x4bf16_1k v[160:163], a[44:45], a[44:45], v[160:163]
    v_mfma_f32_4x4x4bf16_1k v[168:171], v[134:135], a[44:45], v[168:171]
    v_mfma_f32_4x4x4bf16_1k v[164:167], a[46:47], a[46:47], v[164:167]
    v_mfma_f32_4x4x4bf16_1k v[172:175], v[134:135], a[46:47], v[172:175]
    s_waitcnt lgkmcnt(4)
    v_mfma_f32_32x32x16_bf16 v[40:55], a[40:43], v[88:91], v[40:55]
    s_waitcnt vmcnt(3)
    s_barrier
    ds_read_b128 a[48:51], v184 offset:0
    ds_read_b128 a[52:55], v185 offset:0
    ds_read_b64_tr_b16 v[72:73], v176 offset:24576
    ds_read_b64_tr_b16 v[74:75], v176 offset:25088
    s_add_u32 m0, s49, 5120
    v_mfma_f32_32x32x16_bf16 v[56:71], a[40:43], v[92:95], v[56:71]
    buffer_load_dwordx4 v189, s[4:7], s60 offen lds
    ds_read_b64_tr_b16 v[76:77], v180 offset:24576
    ds_read_b64_tr_b16 v[78:79], v180 offset:25088
    ds_read_b64_tr_b16 v[80:81], v177 offset:24576
    s_waitcnt lgkmcnt(7)
    s_add_u32 m0, s49, 6144
    v_mfma_f32_32x32x16_bf16 v[40:55], a[44:47], v[96:99], v[40:55]
    buffer_load_dwordx4 v190, s[4:7], s60 offen lds
    ds_read_b64_tr_b16 v[82:83], v177 offset:25088
    ds_read_b64_tr_b16 v[84:85], v181 offset:24576
    ds_read_b64_tr_b16 v[86:87], v181 offset:25088
    s_add_u32 m0, s49, 7168
    v_mfma_f32_32x32x16_bf16 v[56:71], a[44:47], v[100:103], v[56:71]
    buffer_load_dwordx4 v191, s[4:7], s60 offen lds
    s_add_u32 s53, s53, 1
    s_cmp_eq_u32 s53, 7
    s_cselect_b32 s53, 0, s53
    s_mul_i32 s33, s53, 172032
    s_lshl_b32 s60, s53, 7
    s_waitcnt lgkmcnt(4)
    v_mfma_f32_4x4x4bf16_1k v[160:163], a[48:49], a[48:49], v[160:163]
    v_mfma_f32_4x4x4bf16_1k v[168:171], v[134:135], a[48:49], v[168:171]
    v_mfma_f32_4x4x4bf16_1k v[164:167], a[50:51], a[50:51], v[164:167]
    v_mfma_f32_4x4x4bf16_1k v[172:175], v[134:135], a[50:51], v[172:175]
    v_mfma_f32_4x4x4bf16_1k v[160:163], a[52:53], a[52:53], v[160:163]
    v_mfma_f32_4x4x4bf16_1k v[168:171], v[134:135], a[52:53], v[168:171]
    v_mfma_f32_4x4x4bf16_1k v[164:167], a[54:55], a[54:55], v[164:167]
    v_mfma_f32_4x4x4bf16_1k v[172:175], v[134:135], a[54:55], v[172:175]
    v_mfma_f32_4x4x4bf16_1k v[104:107], v[134:135], v[72:73], v[104:107]
    v_mfma_f32_4x4x4bf16_1k v[108:111], v[134:135], v[76:77], v[108:111]
    s_nop 0
    v_mfma_f32_4x4x4bf16_1k v[104:107], v[134:135], v[74:75], v[104:107]
    v_mfma_f32_4x4x4bf16_1k v[108:111], v[134:135], v[78:79], v[108:111]
    v_mfma_f32_32x32x16_bf16 v[40:55], a[48:51], v[72:75], v[40:55]
    ds_read_b128 a[56:59], v186 offset:0
    ds_read_b128 a[60:63], v187 offset:0
    ds_read_b64_tr_b16 v[88:89], v178 offset:24576
    ds_read_b64_tr_b16 v[90:91], v178 offset:25088
    s_add_u32 m0, s51, 40960
    v_mfma_f32_32x32x16_bf16 v[56:71], a[48:51], v[76:79], v[56:71]
    buffer_load_dwordx4 v26, s[8:11], s33 offen lds
    ds_read_b64_tr_b16 v[92:93], v182 offset:24576
    ds_read_b64_tr_b16 v[94:95], v182 offset:25088
    ds_read_b64_tr_b16 v[96:97], v179 offset:24576
    s_waitcnt lgkmcnt(7)
    s_add_u32 m0, s51, 41984
    v_mfma_f32_32x32x16_bf16 v[40:55], a[52:55], v[80:83], v[40:55]
    buffer_load_dwordx4 v27, s[8:11], s33 offen lds
    ds_read_b64_tr_b16 v[98:99], v179 offset:25088
    ds_read_b64_tr_b16 v[100:101], v183 offset:24576
    ds_read_b64_tr_b16 v[102:103], v183 offset:25088
    s_add_u32 m0, s49, 8192
    v_mfma_f32_32x32x16_bf16 v[56:71], a[52:55], v[84:87], v[56:71]
    buffer_load_dwordx4 v188, s[4:7], s60 offen lds
    s_waitcnt lgkmcnt(8)
    v_mfma_f32_4x4x4bf16_1k v[160:163], a[56:57], a[56:57], v[160:163]
    v_mfma_f32_4x4x4bf16_1k v[168:171], v[134:135], a[56:57], v[168:171]
    v_mfma_f32_4x4x4bf16_1k v[164:167], a[58:59], a[58:59], v[164:167]
    v_mfma_f32_4x4x4bf16_1k v[172:175], v[134:135], a[58:59], v[172:175]
    v_mfma_f32_4x4x4bf16_1k v[160:163], a[60:61], a[60:61], v[160:163]
    v_mfma_f32_4x4x4bf16_1k v[168:171], v[134:135], a[60:61], v[168:171]
    v_mfma_f32_4x4x4bf16_1k v[164:167], a[62:63], a[62:63], v[164:167]
    v_mfma_f32_4x4x4bf16_1k v[172:175], v[134:135], a[62:63], v[172:175]
    s_waitcnt lgkmcnt(4)
    v_mfma_f32_32x32x16_bf16 v[40:55], a[56:59], v[88:91], v[40:55]
    s_waitcnt vmcnt(3)
    s_barrier
    ds_read_b128 a[64:67], v184 offset:4096
    ds_read_b128 a[68:71], v185 offset:4096
    ds_read_b64_tr_b16 v[72:73], v176 offset:32768
    ds_read_b64_tr_b16 v[74:75], v176 offset:33280
    s_add_u32 m0, s49, 9216
    v_mfma_f32_32x32x16_bf16 v[56:71], a[56:59], v[92:95], v[56:71]
    buffer_load_dwordx4 v189, s[4:7], s60 offen lds
    ds_read_b64_tr_b16 v[76:77], v180 offset:32768
    ds_read_b64_tr_b16 v[78:79], v180 offset:33280
    ds_read_b64_tr_b16 v[80:81], v177 offset:32768
    s_waitcnt lgkmcnt(7)
    s_add_u32 m0, s49, 10240
    v_mfma_f32_32x32x16_bf16 v[40:55], a[60:63], v[96:99], v[40:55]
    buffer_load_dwordx4 v190, s[4:7], s60 offen lds
    ds_read_b64_tr_b16 v[82:83], v177 offset:33280
    ds_read_b64_tr_b16 v[84:85], v181 offset:32768
    ds_read_b64_tr_b16 v[86:87], v181 offset:33280
    s_add_u32 m0, s49, 11264
    v_mfma_f32_32x32x16_bf16 v[56:71], a[60:63], v[100:103], v[56:71]
    buffer_load_dwordx4 v191, s[4:7], s60 offen lds
    s_add_u32 s53, s53, 1
    s_cmp_eq_u32 s53, 7
    s_cselect_b32 s53, 0, s53
    s_mul_i32 s33, s53, 172032
    s_lshl_b32 s60, s53, 7
    s_waitcnt lgkmcnt(4)
    v_mfma_f32_4x4x4bf16_1k v[160:163], a[64:65], a[64:65], v[160:163]
    v_mfma_f32_4x4x4bf16_1k v[168:171], v[134:135], a[64:65], v[168:171]
    v_mfma_f32_4x4x4bf16_1k v[164:167], a[66:67], a[66:67], v[164:167]
    v_mfma_f32_4x4x4bf16_1k v[172:175], v[134:135], a[66:67], v[172:175]
    v_mfma_f32_4x4x4bf16_1k v[160:163], a[68:69], a[68:69], v[160:163]
    v_mfma_f32_4x4x4bf16_1k v[168:171], v[134:135], a[68:69], v[168:171]
    v_mfma_f32_4x4x4bf16_1k v[164:167], a[70:71], a[70:71], v[164:167]
    v_mfma_f32_4x4x4bf16_1k v[172:175], v[134:135], a[70:71], v[172:175]
    v_mfma_f32_4x4x4bf16_1k v[104:107], v[134:135], v[72:73], v[104:107]
    v_mfma_f32_4x4x4bf16_1k v[108:111], v[134:135], v[76:77], v[108:111]
    s_nop 0
    v_mfma_f32_4x4x4bf16_1k v[104:107], v[134:135], v[74:75], v[104:107]
    v_mfma_f32_4x4x4bf16_1k v[108:111], v[134:135], v[78:79], v[108:111]
    v_mfma_f32_32x32x16_bf16 v[40:55], a[64:67], v[72:75], v[40:55]
    ds_read_b128 a[72:75], v186 offset:4096
    ds_read_b128 a[76:79], v187 offset:4096
    ds_read_b64_tr_b16 v[88:89], v178 offset:32768
    ds_read_b64_tr_b16 v[90:91], v178 offset:33280
    s_add_u32 m0, s51, 49152
    v_mfma_f32_32x32x16_bf16 v[56:71], a[64:67], v[76:79], v[56:71]
    buffer_load_dwordx4 v26, s[8:11], s33 offen lds
    ds_read_b64_tr_b16 v[92:93], v182 offset:32768
    ds_read_b64_tr_b16 v[94:95], v182 offset:33280
    ds_read_b64_tr_b16 v[96:97], v179 offset:32768
    s_waitcnt lgkmcnt(7)
    s_add_u32 m0, s51, 50176
    v_mfma_f32_32x32x16_bf16 v[40:55], a[68:71], v[80:83], v[40:55]
    buffer_load_dwordx4 v27, s[8:11], s33 offen lds
    ds_read_b64_tr_b16 v[98:99], v179 offset:33280
    ds_read_b64_tr_b16 v[100:101], v183 offset:32768
    ds_read_b64_tr_b16 v[102:103], v183 offset:33280
    s_add_u32 m0, s49, 0
    v_mfma_f32_32x32x16_bf16 v[56:71], a[68:71], v[84:87], v[56:71]
    buffer_load_dwordx4 v188, s[4:7], s60 offen lds
    s_waitcnt lgkmcnt(8)
    v_mfma_f32_4x4x4bf16_1k v[160:163], a[72:73], a[72:73], v[160:163]
    v_mfma_f32_4x4x4bf16_1k v[168:171], v[134:135], a[72:73], v[168:171]
    v_mfma_f32_4x4x4bf16_1k v[164:167], a[74:75], a[74:75], v[164:167]
    v_mfma_f32_4x4x4bf16_1k v[172:175], v[134:135], a[74:75], v[172:175]
    v_mfma_f32_4x4x4bf16_1k v[160:163], a[76:77], a[76:77], v[160:163]
    v_mfma_f32_4x4x4bf16_1k v[168:171], v[134:135], a[76:77], v[168:171]
    v_mfma_f32_4x4x4bf16_1k v[164:167], a[78:79], a[78:79], v[164:167]
    v_mfma_f32_4x4x4bf16_1k v[172:175], v[134:135], a[78:79], v[172:175]
    s_waitcnt lgkmcnt(4)
    v_mfma_f32_32x32x16_bf16 v[40:55], a[72:75], v[88:91], v[40:55]
    s_waitcnt vmcnt(3)
    s_barrier
    ds_read_b128 a[80:83], v184 offset:8192
    ds_read_b128 a[84:87], v185 offset:8192
    ds_read_b64_tr_b16 v[72:73], v176 offset:40960
    ds_read_b64_tr_b16 v[74:75], v176 offset:41472
    s_add_u32 m0, s49, 1024
    v_mfma_f32_32x32x16_bf16 v[56:71], a[72:75], v[92:95], v[56:71]
    buffer_load_dwordx4 v189, s[4:7], s60 offen lds
    ds_read_b64_tr_b16 v[76:77], v180 offset:40960
    ds_read_b64_tr_b16 v[78:79], v180 offset:41472
    ds_read_b64_tr_b16 v[80:81], v177 offset:40960
    s_waitcnt lgkmcnt(7)
    s_add_u32 m0, s49, 2048
    v_mfma_f32_32x32x16_bf16 v[40:55], a[76:79], v[96:99], v[40:55]
    buffer_load_dwordx4 v190, s[4:7], s60 offen lds
    ds_read_b64_tr_b16 v[82:83], v177 offset:41472
    ds_read_b64_tr_b16 v[84:85], v181 offset:40960
    ds_read_b64_tr_b16 v[86:87], v181 offset:41472
    s_add_u32 m0, s49, 3072
    v_mfma_f32_32x32x16_bf16 v[56:71], a[76:79], v[100:103], v[56:71]
    buffer_load_dwordx4 v191, s[4:7], s60 offen lds
    s_add_u32 s53, s53, 1
    s_cmp_eq_u32 s53, 7
    s_cselect_b32 s53, 0, s53
    s_mul_i32 s33, s53, 172032
    s_lshl_b32 s60, s53, 7
    s_waitcnt lgkmcnt(4)
    v_mfma_f32_4x4x4bf16_1k v[160:163], a[80:81], a[80:81], v[160:163]
    v_mfma_f32_4x4x4bf16_1k v[168:171], v[134:135], a[80:81], v[168:171]
    v_mfma_f32_4x4x4bf16_1k v[164:167], a[82:83], a[82:83], v[164:167]
    v_mfma_f32_4x4x4bf16_1k v[172:175], v[134:135], a[82:83], v[172:175]
    v_mfma_f32_4x4x4bf16_1k v[160:163], a[84:85], a[84:85], v[160:163]
    v_mfma_f32_4x4x4bf16_1k v[168:171], v[134:135], a[84:85], v[168:171]
    v_mfma_f32_4x4x4bf16_1k v[164:167], a[86:87], a[86:87], v[164:167]
    v_mfma_f32_4x4x4bf16_1k v[172:175], v[134:135], a[86:87], v[172:175]
    v_mfma_f32_4x4x4bf16_1k v[104:107], v[134:135], v[72:73], v[104:107]
    v_mfma_f32_4x4x4bf16_1k v[108:111], v[134:135], v[76:77], v[108:111]
    s_nop 0
    v_mfma_f32_4x4x4bf16_1k v[104:107], v[134:135], v[74:75], v[104:107]
    v_mfma_f32_4x4x4bf16_1k v[108:111], v[134:135], v[78:79], v[108:111]
    v_mfma_f32_32x32x16_bf16 v[40:55], a[80:83], v[72:75], v[40:55]
    ds_read_b128 a[88:91], v186 offset:8192
    ds_read_b128 a[92:95], v187 offset:8192
    ds_read_b64_tr_b16 v[88:89], v178 offset:40960
    ds_read_b64_tr_b16 v[90:91], v178 offset:41472
    s_add_u32 m0, s52, 0
    v_mfma_f32_32x32x16_bf16 v[56:71], a[80:83], v[76:79], v[56:71]
    buffer_load_dwordx4 v202, s[8:11], s33 offen lds
    s_add_u32 s53, s53, 1
    s_cmp_eq_u32 s53, 7
    s_cselect_b32 s53, 0, s53
    s_mul_i32 s33, s53, 172032
    s_add_u32 m0, s52, 4096
    s_nop 0
    buffer_load_dwordx4 v202, s[8:11], s33 offen lds
    s_add_u32 s53, s53, 1
    s_cmp_eq_u32 s53, 7
    s_cselect_b32 s53, 0, s53
    s_mul_i32 s33, s53, 172032
    ds_read_b64_tr_b16 v[92:93], v182 offset:40960
    ds_read_b64_tr_b16 v[94:95], v182 offset:41472
    ds_read_b64_tr_b16 v[96:97], v179 offset:40960
    s_waitcnt lgkmcnt(7)
    s_add_u32 m0, s52, 8192
    v_mfma_f32_32x32x16_bf16 v[40:55], a[84:87], v[80:83], v[40:55]
    buffer_load_dwordx4 v202, s[8:11], s33 offen lds
    s_add_u32 s53, s53, 1
    s_cmp_eq_u32 s53, 7
    s_cselect_b32 s53, 0, s53
    s_mul_i32 s33, s53, 172032
    s_add_u32 m0, s52, 12288
    s_nop 0
    buffer_load_dwordx4 v202, s[8:11], s33 offen lds
    s_add_u32 s53, s53, 1
    s_cmp_eq_u32 s53, 7
    s_cselect_b32 s53, 0, s53
    s_mul_i32 s33, s53, 172032
    ds_read_b64_tr_b16 v[98:99], v179 offset:41472
    ds_read_b64_tr_b16 v[100:101], v183 offset:40960
    ds_read_b64_tr_b16 v[102:103], v183 offset:41472
    s_add_u32 m0, s52, 16384
    v_mfma_f32_32x32x16_bf16 v[56:71], a[84:87], v[84:87], v[56:71]
    buffer_load_dwordx4 v202, s[8:11], s33 offen lds
    s_add_u32 s53, s53, 1
    s_cmp_eq_u32 s53, 7
    s_cselect_b32 s53, 0, s53
    s_mul_i32 s33, s53, 172032
    s_add_u32 m0, s52, 20480
    s_nop 0
    buffer_load_dwordx4 v202, s[8:11], s33 offen lds
    s_add_u32 s53, s53, 1
    s_cmp_eq_u32 s53, 7
    s_cselect_b32 s53, 0, s53
    s_mul_i32 s33, s53, 172032
    s_waitcnt lgkmcnt(8)
    v_mfma_f32_4x4x4bf16_1k v[160:163], a[88:89], a[88:89], v[160:163]
    v_mfma_f32_4x4x4bf16_1k v[168:171], v[134:135], a[88:89], v[168:171]
    v_mfma_f32_4x4x4bf16_1k v[164:167], a[90:91], a[90:91], v[164:167]
    v_mfma_f32_4x4x4bf16_1k v[172:175], v[134:135], a[90:91], v[172:175]
    v_mfma_f32_4x4x4bf16_1k v[160:163], a[92:93], a[92:93], v[160:163]
    v_mfma_f32_4x4x4bf16_1k v[168:171], v[134:135], a[92:93], v[168:171]
    v_mfma_f32_4x4x4bf16_1k v[164:167], a[94:95], a[94:95], v[164:167]
    v_mfma_f32_4x4x4bf16_1k v[172:175], v[134:135], a[94:95], v[172:175]
    s_waitcnt lgkmcnt(4)
    v_mfma_f32_32x32x16_bf16 v[40:55], a[88:91], v[88:91], v[40:55]
    s_waitcnt vmcnt(6)
    s_barrier
    ds_read_b64_tr_b16 v[72:73], v176 offset:49152
    ds_read_b64_tr_b16 v[74:75], v176 offset:49664
    ds_read_b64_tr_b16 v[76:77], v180 offset:49152
    ds_read_b64_tr_b16 v[78:79], v180 offset:49664
    s_add_u32 m0, s52, 24576
    v_mfma_f32_32x32x16_bf16 v[56:71], a[88:91], v[92:95], v[56:71]
    buffer_load_dwordx4 v202, s[8:11], s33 offen lds
    s_add_u32 s53, s53, 1
    s_cmp_eq_u32 s53, 7
    s_cselect_b32 s53, 0, s53
    s_mul_i32 s33, s53, 172032
    ds_read_b128 a[96:99], v184 offset:0
    ds_read_b128 a[100:103], v185 offset:0
    ds_read_b64_tr_b16 v[80:81], v177 offset:49152
    s_waitcnt lgkmcnt(7)
    v_mfma_f32_32x32x16_bf16 v[40:55], a[92:95], v[96:99], v[40:55]
    ds_read_b64_tr_b16 v[82:83], v177 offset:49664
    ds_read_b64_tr_b16 v[84:85], v181 offset:49152
    ds_read_b64_tr_b16 v[86:87], v181 offset:49664
    v_mfma_f32_32x32x16_bf16 v[56:71], a[92:95], v[100:103], v[56:71]
    ds_read_b128 a[104:107], v186 offset:0
    ds_read_b128 a[108:111], v187 offset:0
    s_waitcnt lgkmcnt(8)
    v_mfma_f32_4x4x4bf16_1k v[104:107], v[134:135], v[72:73], v[104:107]
    v_mfma_f32_4x4x4bf16_1k v[108:111], v[134:135], v[76:77], v[108:111]
    s_nop 0
    v_mfma_f32_4x4x4bf16_1k v[104:107], v[134:135], v[74:75], v[104:107]
    v_mfma_f32_4x4x4bf16_1k v[108:111], v[134:135], v[78:79], v[108:111]
    s_waitcnt lgkmcnt(6)
    v_mfma_f32_4x4x4bf16_1k v[160:163], a[96:97], a[96:97], v[160:163]
    v_mfma_f32_4x4x4bf16_1k v[168:171], v[134:135], a[96:97], v[168:171]
    v_mfma_f32_4x4x4bf16_1k v[164:167], a[98:99], a[98:99], v[164:167]
    v_mfma_f32_4x4x4bf16_1k v[172:175], v[134:135], a[98:99], v[172:175]
    ds_write_b32 v196, v104 offset:0
    ds_write_b32 v196, v108 offset:1024
    ds_read_b64_tr_b16 v[88:89], v178 offset:49152
    ds_read_b64_tr_b16 v[90:91], v178 offset:49664
    ds_read_b64_tr_b16 v[92:93], v182 offset:49152
    ds_read_b64_tr_b16 v[94:95], v182 offset:49664
    v_mfma_f32_4x4x4bf16_1k v[160:163], a[100:101], a[100:101], v[160:163]
    v_mfma_f32_4x4x4bf16_1k v[168:171], v[134:135], a[100:101], v[168:171]
    v_mfma_f32_4x4x4bf16_1k v[164:167], a[102:103], a[102:103], v[164:167]
    v_mfma_f32_4x4x4bf16_1k v[172:175], v[134:135], a[102:103], v[172:175]
    ds_read_b64_tr_b16 v[96:97], v179 offset:49152
    ds_read_b64_tr_b16 v[98:99], v179 offset:49664
    ds_read_b64_tr_b16 v[100:101], v183 offset:49152
    ds_read_b64_tr_b16 v[102:103], v183 offset:49664
    s_waitcnt lgkmcnt(10)
    v_mfma_f32_4x4x4bf16_1k v[160:163], a[104:105], a[104:105], v[160:163]
    v_mfma_f32_4x4x4bf16_1k v[168:171], v[134:135], a[104:105], v[168:171]
    v_mfma_f32_4x4x4bf16_1k v[164:167], a[106:107], a[106:107], v[164:167]
    v_mfma_f32_4x4x4bf16_1k v[172:175], v[134:135], a[106:107], v[172:175]
    s_waitcnt lgkmcnt(8)
    s_barrier
    ds_read_b128 v[116:119], v197 offset:0
    ds_read_b128 v[120:123], v197 offset:1024
    v_mfma_f32_4x4x4bf16_1k v[160:163], a[108:109], a[108:109], v[160:163]
    v_mfma_f32_4x4x4bf16_1k v[168:171], v[134:135], a[108:109], v[168:171]
    v_mfma_f32_4x4x4bf16_1k v[164:167], a[110:111], a[110:111], v[164:167]
    v_mfma_f32_4x4x4bf16_1k v[172:175], v[134:135], a[110:111], v[172:175]
    v_mfma_f32_32x32x16_bf16 v[40:55], a[96:99], v[72:75], v[40:55]
    v_mfma_f32_32x32x16_bf16 v[40:55], a[100:103], v[80:83], v[40:55]
    s_nop 1
    v_add_f32 v160, v160, v164
    v_add_f32 v161, v161, v165
    v_add_f32 v162, v162, v166
    v_add_f32 v163, v163, v167
    v_add_f32 v168, v168, v172
    v_cndmask_b32 v160, v160, v161, s[0:1]
    s_waitcnt lgkmcnt(6)
    v_mfma_f32_32x32x16_bf16 v[40:55], a[104:107], v[88:91], v[40:55]
    s_waitcnt lgkmcnt(0)
    v_cndmask_b32 v160, v160, v162, s[86:87]
    v_add_f32 v116, v116, v117
    v_cndmask_b32 v160, v160, v163, vcc
    v_add_f32 v120, v120, v121
    s_nop 0
    v_permlane32_swap_b32 v168, v160
    v_add_f32 v116, v116, v118
    v_mfma_f32_32x32x16_bf16 v[40:55], a[108:111], v[96:99], v[40:55]
    v_add_f32 v168, v168, v160
    v_add_f32 v120, v120, v122
    v_mov_b32 v160, v168
    v_add_f32 v116, v116, v119
    s_nop 0
    v_permlane32_swap_b32 v168, v160
    v_add_f32_e64 v120, v120, v123
    v_mfma_f32_32x32x16_bf16 v[56:71], a[96:99], v[76:79], v[56:71]
    v_mul_f32 v168, 0xbb124925, v168
    v_cvt_pk_bf16_f32 v124, v116, v116
    v_mul_f32 v160, 0x3b124925, v160
    v_cvt_pk_bf16_f32 v126, v120, v120
    v_cvt_pk_bf16_f32 v136, v168, v168
    v_and_b32 v125, 0xffff0000, v124
    v_mfma_f32_32x32x16_bf16 v[56:71], a[100:103], v[84:87], v[56:71]
    v_fma_f32 v160, -v168, v168, v160
    v_and_b32 v127, 0xffff0000, v126
    v_and_b32 v136, 0xffff0000, v136
    v_sub_f32 v125, v116, v125
    v_max_f32 v160, 0, v160
    v_sub_f32_e64 v127, v120, v127
    v_mfma_f32_32x32x16_bf16 v[56:71], a[104:107], v[92:95], v[56:71]
    v_sub_f32_e64 v136, v168, v136
    v_cvt_pk_bf16_f32 v125, v125, v125
    v_add_f32 v132, 0x3727c5ac, v160
    v_cvt_pk_bf16_f32 v127, v127, v127
    v_cvt_pk_bf16_f32 v130, v168, v136
    v_cvt_pk_bf16_f32 v131, v168, v136
    v_mfma_f32_32x32x16_bf16 v[56:71], a[108:111], v[100:103], v[56:71]
    v_rsq_f32 v132, v132
    s_nop 0
    v_and_b32 v136, 0xffff0000, v132
    v_sub_f32_e64 v137, v132, v136
    v_cvt_pk_bf16_f32 v138, v136, v137
    s_nop 1
    v_mfma_f32_32x32x8bf16_1k v[8:23], v[138:139], v[140:141], 0
    v_mfma_f32_32x32x8bf16_1k v[40:55], v[130:131], v[124:125], v[40:55]
    v_mfma_f32_32x32x8bf16_1k v[56:71], v[130:131], v[126:127], v[56:71]
    s_add_u32 s57, s50, 131072
    s_nop 9
    v_pk_fma_f32 v[40:41], v[40:41], v[8:9], v[142:143] op_sel_hi:[1,1,0]
    v_pk_fma_f32 v[42:43], v[42:43], v[10:11], v[142:143] op_sel_hi:[1,1,0]
    v_pk_fma_f32 v[44:45], v[44:45], v[12:13], v[142:143] op_sel_hi:[1,1,0]
    v_pk_fma_f32 v[46:47], v[46:47], v[14:15], v[142:143] op_sel_hi:[1,1,0]
    v_cvt_pk_bf16_f32 v144, v40, v41
    v_cvt_pk_bf16_f32 v145, v42, v43
    v_cvt_pk_bf16_f32 v146, v44, v45
    v_cvt_pk_bf16_f32 v147, v46, v47
    buffer_store_dwordx4 v[144:147], v1, s[12:15], s50 offen offset:0 sc1
    v_pk_fma_f32 v[48:49], v[48:49], v[16:17], v[142:143] op_sel_hi:[1,1,0]
    v_pk_fma_f32 v[50:51], v[50:51], v[18:19], v[142:143] op_sel_hi:[1,1,0]
    v_pk_fma_f32 v[52:53], v[52:53], v[20:21], v[142:143] op_sel_hi:[1,1,0]
    v_pk_fma_f32 v[54:55], v[54:55], v[22:23], v[142:143] op_sel_hi:[1,1,0]
    v_cvt_pk_bf16_f32 v148, v48, v49
    v_cvt_pk_bf16_f32 v149, v50, v51
    v_cvt_pk_bf16_f32 v150, v52, v53
    v_cvt_pk_bf16_f32 v151, v54, v55
    buffer_store_dwordx4 v[148:151], v1, s[12:15], s50 offen offset:1024 sc1
    v_pk_fma_f32 v[56:57], v[56:57], v[8:9], v[142:143] op_sel_hi:[1,1,0]
    v_pk_fma_f32 v[58:59], v[58:59], v[10:11], v[142:143] op_sel_hi:[1,1,0]
    v_pk_fma_f32 v[60:61], v[60:61], v[12:13], v[142:143] op_sel_hi:[1,1,0]
    v_pk_fma_f32 v[62:63], v[62:63], v[14:15], v[142:143] op_sel_hi:[1,1,0]
    v_cvt_pk_bf16_f32 v152, v56, v57
    v_cvt_pk_bf16_f32 v153, v58, v59
    v_cvt_pk_bf16_f32 v154, v60, v61
    v_cvt_pk_bf16_f32 v155, v62, v63
    buffer_store_dwordx4 v[152:155], v1, s[12:15], s57 offen offset:0 sc1
    v_pk_fma_f32 v[64:65], v[64:65], v[16:17], v[142:143] op_sel_hi:[1,1,0]
    v_pk_fma_f32 v[66:67], v[66:67], v[18:19], v[142:143] op_sel_hi:[1,1,0]
    v_pk_fma_f32 v[68:69], v[68:69], v[20:21], v[142:143] op_sel_hi:[1,1,0]
    v_pk_fma_f32 v[70:71], v[70:71], v[22:23], v[142:143] op_sel_hi:[1,1,0]
    v_cvt_pk_bf16_f32 v156, v64, v65
    v_cvt_pk_bf16_f32 v157, v66, v67
    v_cvt_pk_bf16_f32 v158, v68, v69
    v_cvt_pk_bf16_f32 v159, v70, v71
    buffer_store_dwordx4 v[156:159], v1, s[12:15], s57 offen offset:1024 sc1
L_q:
    v_mul_f32 v132, 0x3e8b97f6, v132
    s_waitcnt vmcnt(4)
    s_barrier
    ds_read_b64_tr_b16 v[72:73], v192 offset:0
    ds_read_b64_tr_b16 v[74:75], v192 offset:256
    ds_read_b64_tr_b16 v[76:77], v193 offset:0
    ds_read_b64_tr_b16 v[78:79], v193 offset:256
    ds_read_b64_tr_b16 v[80:81], v194 offset:0
    ds_read_b64_tr_b16 v[82:83], v194 offset:256
    ds_read_b64_tr_b16 v[84:85], v195 offset:0
    ds_read_b64_tr_b16 v[86:87], v195 offset:256
    ds_read_b64_tr_b16 v[88:89], v192 offset:4096
    ds_read_b64_tr_b16 v[90:91], v192 offset:4352
    s_waitcnt lgkmcnt(8)
    v_mfma_f32_4x4x4bf16_1k v[112:115], v[134:135], v[72:73], 0
    v_mfma_f32_32x32x16_bf16 v[8:23], v[72:75], a[0:3], 0
    s_nop 0
    v_mfma_f32_4x4x4bf16_1k v[112:115], v[134:135], v[74:75], v[112:115]
    ds_read_b64_tr_b16 v[92:93], v193 offset:4096
    ds_read_b64_tr_b16 v[94:95], v193 offset:4352
    s_waitcnt lgkmcnt(8)
    v_mfma_f32_32x32x16_bf16 v[8:23], v[76:79], a[4:7], v[8:23]
    ds_read_b64_tr_b16 v[96:97], v194 offset:4096
    ds_read_b64_tr_b16 v[98:99], v194 offset:4352
    s_waitcnt lgkmcnt(8)
    v_mfma_f32_32x32x16_bf16 v[8:23], v[80:83], a[8:11], v[8:23]
    ds_read_b64_tr_b16 v[100:101], v195 offset:4096
    ds_read_b64_tr_b16 v[102:103], v195 offset:4352
    s_waitcnt lgkmcnt(8)
    v_mfma_f32_32x32x16_bf16 v[8:23], v[84:87], a[12:15], v[8:23]
    ds_read_b64_tr_b16 v[72:73], v192 offset:8192
    ds_read_b64_tr_b16 v[74:75], v192 offset:8448
    s_waitcnt lgkmcnt(8)
    v_mfma_f32_4x4x4bf16_1k v[112:115], v[134:135], v[88:89], v[112:115]
    v_mfma_f32_32x32x16_bf16 v[8:23], v[88:91], a[16:19], v[8:23]
    s_nop 0
    v_mfma_f32_4x4x4bf16_1k v[112:115], v[134:135], v[90:91], v[112:115]
    ds_read_b64_tr_b16 v[76:77], v193 offset:8192
    ds_read_b64_tr_b16 v[78:79], v193 offset:8448
    s_waitcnt lgkmcnt(8)
    v_mfma_f32_32x32x16_bf16 v[8:23], v[92:95], a[20:23], v[8:23]
    ds_read_b64_tr_b16 v[80:81], v194 offset:8192
    ds_read_b64_tr_b16 v[82:83], v194 offset:8448
    s_waitcnt lgkmcnt(8)
    v_mfma_f32_32x32x16_bf16 v[8:23], v[96:99], a[24:27], v[8:23]
    ds_read_b64_tr_b16 v[84:85], v195 offset:8192
    ds_read_b64_tr_b16 v[86:87], v195 offset:8448
    s_waitcnt lgkmcnt(8)
    v_mfma_f32_32x32x16_bf16 v[8:23], v[100:103], a[28:31], v[8:23]
    ds_read_b64_tr_b16 v[88:89], v192 offset:12288
    ds_read_b64_tr_b16 v[90:91], v192 offset:12544
    s_waitcnt lgkmcnt(8)
    v_mfma_f32_4x4x4bf16_1k v[112:115], v[134:135], v[72:73], v[112:115]
    v_mfma_f32_32x32x16_bf16 v[8:23], v[72:75], a[32:35], v[8:23]
    s_nop 0
    v_mfma_f32_4x4x4bf16_1k v[112:115], v[134:135], v[74:75], v[112:115]
    ds_read_b64_tr_b16 v[92:93], v193 offset:12288
    ds_read_b64_tr_b16 v[94:95], v193 offset:12544
    s_waitcnt lgkmcnt(8)
    v_mfma_f32_32x32x16_bf16 v[8:23], v[76:79], a[36:39], v[8:23]
    ds_read_b64_tr_b16 v[96:97], v194 offset:12288
    ds_read_b64_tr_b16 v[98:99], v194 offset:12544
    s_waitcnt lgkmcnt(8)
    v_mfma_f32_32x32x16_bf16 v[8:23], v[80:83], a[40:43], v[8:23]
    ds_read_b64_tr_b16 v[100:101], v195 offset:12288
    ds_read_b64_tr_b16 v[102:103], v195 offset:12544
    s_waitcnt lgkmcnt(8)
    v_mfma_f32_32x32x16_bf16 v[8:23], v[84:87], a[44:47], v[8:23]
    ds_read_b64_tr_b16 v[72:73], v192 offset:16384
    ds_read_b64_tr_b16 v[74:75], v192 offset:16640
    s_waitcnt lgkmcnt(8)
    v_mfma_f32_4x4x4bf16_1k v[112:115], v[134:135], v[88:89], v[112:115]
    v_mfma_f32_32x32x16_bf16 v[8:23], v[88:91], a[48:51], v[8:23]
    s_nop 0
    v_mfma_f32_4x4x4bf16_1k v[112:115], v[134:135], v[90:91], v[112:115]
    ds_read_b64_tr_b16 v[76:77], v193 offset:16384
    ds_read_b64_tr_b16 v[78:79], v193 offset:16640
    s_waitcnt lgkmcnt(8)
    v_mfma_f32_32x32x16_bf16 v[8:23], v[92:95], a[52:55], v[8:23]
    ds_read_b64_tr_b16 v[80:81], v194 offset:16384
    ds_read_b64_tr_b16 v[82:83], v194 offset:16640
    s_waitcnt lgkmcnt(8)
    v_mfma_f32_32x32x16_bf16 v[8:23], v[96:99], a[56:59], v[8:23]
    ds_read_b64_tr_b16 v[84:85], v195 offset:16384
    ds_read_b64_tr_b16 v[86:87], v195 offset:16640
    s_waitcnt lgkmcnt(8)
    v_mfma_f32_32x32x16_bf16 v[8:23], v[100:103], a[60:63], v[8:23]
    ds_read_b64_tr_b16 v[88:89], v192 offset:20480
    ds_read_b64_tr_b16 v[90:91], v192 offset:20736
    s_waitcnt lgkmcnt(8)
    v_mfma_f32_4x4x4bf16_1k v[112:115], v[134:135], v[72:73], v[112:115]
    v_mfma_f32_32x32x16_bf16 v[8:23], v[72:75], a[64:67], v[8:23]
    s_nop 0
    v_mfma_f32_4x4x4bf16_1k v[112:115], v[134:135], v[74:75], v[112:115]
    ds_read_b64_tr_b16 v[92:93], v193 offset:20480
    ds_read_b64_tr_b16 v[94:95], v193 offset:20736
    s_waitcnt vmcnt(0)
    buffer_store_dwordx4 v[212:215], v211, s[12:15], s61 offen sc1
    s_add_u32 s56, s49, 12288
    s_cmp_eq_u32 s36, 0
    s_cselect_b32 s56, 118784, s56
    s_lshl_b32 s57, s36, 12
    s_add_u32 s57, s57, 151552
    s_cmp_eq_u32 s36, 3
    s_cselect_b32 s56, 139264, s56
    s_cselect_b32 s57, s56, s57
    s_add_u32 m0, s56, 0
    s_nop 0
    buffer_load_dwordx4 v28, s[20:23], s46 offen nt lds
    s_add_u32 s46, s46, s48
    s_add_u32 m0, s56, 1024
    s_nop 0
    buffer_load_dwordx4 v28, s[20:23], s46 offen nt lds
    s_add_u32 s46, s46, s48
    s_add_u32 m0, s56, 2048
    s_nop 0
    buffer_load_dwordx4 v28, s[20:23], s46 offen nt lds
    s_add_u32 s46, s46, s48
    s_add_u32 m0, s56, 3072
    s_nop 0
    buffer_load_dwordx4 v28, s[20:23], s46 offen nt lds
    s_add_u32 s46, s46, s48
    s_add_u32 m0, s57, 0
    s_nop 0
    buffer_load_dwordx4 v28, s[24:27], s47 offen nt lds
    s_add_u32 s47, s47, s48
    s_add_u32 m0, s57, 1024
    s_nop 0
    buffer_load_dwordx4 v28, s[24:27], s47 offen nt lds
    s_add_u32 s47, s47, s48
    s_add_u32 m0, s57, 2048
    s_nop 0
    buffer_load_dwordx4 v28, s[24:27], s47 offen nt lds
    s_add_u32 s47, s47, s48
    s_add_u32 m0, s57, 3072
    s_nop 0
    buffer_load_dwordx4 v28, s[24:27], s47 offen nt lds
    s_add_u32 s47, s47, s48
    s_waitcnt lgkmcnt(8)
    v_mfma_f32_32x32x16_bf16 v[8:23], v[76:79], a[68:71], v[8:23]
    ds_read_b64_tr_b16 v[96:97], v194 offset:20480
    ds_read_b64_tr_b16 v[98:99], v194 offset:20736
    s_waitcnt lgkmcnt(8)
    v_mfma_f32_32x32x16_bf16 v[8:23], v[80:83], a[72:75], v[8:23]
    ds_read_b64_tr_b16 v[100:101], v195 offset:20480
    ds_read_b64_tr_b16 v[102:103], v195 offset:20736
    s_waitcnt lgkmcnt(8)
    v_mfma_f32_32x32x16_bf16 v[8:23], v[84:87], a[76:79], v[8:23]
    ds_read_b64_tr_b16 v[72:73], v192 offset:24576
    ds_read_b64_tr_b16 v[74:75], v192 offset:24832
    s_waitcnt lgkmcnt(8)
    v_mfma_f32_4x4x4bf16_1k v[112:115], v[134:135], v[88:89], v[112:115]
    v_mfma_f32_32x32x16_bf16 v[8:23], v[88:91], a[80:83], v[8:23]
    s_nop 0
    v_mfma_f32_4x4x4bf16_1k v[112:115], v[134:135], v[90:91], v[112:115]
    ds_read_b64_tr_b16 v[76:77], v193 offset:24576
    ds_read_b64_tr_b16 v[78:79], v193 offset:24832
    s_waitcnt lgkmcnt(8)
    v_mfma_f32_32x32x16_bf16 v[8:23], v[92:95], a[84:87], v[8:23]
    ds_read_b64_tr_b16 v[80:81], v194 offset:24576
    ds_read_b64_tr_b16 v[82:83], v194 offset:24832
    s_waitcnt lgkmcnt(8)
    v_mfma_f32_32x32x16_bf16 v[8:23], v[96:99], a[88:91], v[8:23]
    ds_read_b64_tr_b16 v[84:85], v195 offset:24576
    ds_read_b64_tr_b16 v[86:87], v195 offset:24832
    s_waitcnt lgkmcnt(8)
    v_mfma_f32_32x32x16_bf16 v[8:23], v[100:103], a[92:95], v[8:23]
    s_waitcnt lgkmcnt(6)
    v_mfma_f32_4x4x4bf16_1k v[112:115], v[134:135], v[72:73], v[112:115]
    v_mfma_f32_32x32x16_bf16 v[8:23], v[72:75], a[96:99], v[8:23]
    s_nop 0
    v_mfma_f32_4x4x4bf16_1k v[112:115], v[134:135], v[74:75], v[112:115]
    s_waitcnt lgkmcnt(4)
    v_mfma_f32_32x32x16_bf16 v[8:23], v[76:79], a[100:103], v[8:23]
    s_nop 2
    ds_write_b32 v196, v112 offset:2048
    s_waitcnt lgkmcnt(3)
    v_mfma_f32_32x32x16_bf16 v[8:23], v[80:83], a[104:107], v[8:23]
    s_waitcnt lgkmcnt(0)
    s_barrier
    ds_read_b128 v[116:119], v197 offset:2048
    v_mfma_f32_32x32x16_bf16 v[8:23], v[84:87], a[108:111], v[8:23]
    s_waitcnt lgkmcnt(0)
    v_add_f32 v116, v116, v117
    v_add_f32 v116, v116, v118
    v_add_f32 v116, v116, v119
    v_cvt_pk_bf16_f32 v124, v116, v116
    v_and_b32 v125, 0xffff0000, v124
    v_sub_f32_e64 v125, v116, v125
    v_cvt_pk_bf16_f32 v125, v125, v125
    s_nop 1
    v_mfma_f32_32x32x8bf16_1k v[8:23], v[124:125], v[130:131], v[8:23]
    s_nop 11
    v_pk_mul_f32 v[8:9], v[8:9], v[132:133] op_sel_hi:[1,0]
    v_pk_mul_f32 v[10:11], v[10:11], v[132:133] op_sel_hi:[1,0]
    v_pk_mul_f32 v[12:13], v[12:13], v[132:133] op_sel_hi:[1,0]
    v_pk_mul_f32 v[14:15], v[14:15], v[132:133] op_sel_hi:[1,0]
    v_cvt_pk_bf16_f32 v32, v8, v9
    v_cvt_pk_bf16_f32 v33, v10, v11
    v_cvt_pk_bf16_f32 v34, v12, v13
    v_cvt_pk_bf16_f32 v35, v14, v15
    ds_write_b128 v198, v[32:35] offset:0
    v_pk_mul_f32 v[16:17], v[16:17], v[132:133] op_sel_hi:[1,0]
    v_pk_mul_f32 v[18:19], v[18:19], v[132:133] op_sel_hi:[1,0]
    v_pk_mul_f32 v[20:21], v[20:21], v[132:133] op_sel_hi:[1,0]
    v_pk_mul_f32 v[22:23], v[22:23], v[132:133] op_sel_hi:[1,0]
    v_cvt_pk_bf16_f32 v36, v16, v17
    v_cvt_pk_bf16_f32 v37, v18, v19
    v_cvt_pk_bf16_f32 v38, v20, v21
    v_cvt_pk_bf16_f32 v39, v22, v23
    s_mov_b32 exec_lo, 0
    v_mov_b32 v38, 0
    v_mov_b32 v39, 0
    s_mov_b32 exec_lo, -1
    ds_write_b128 v198, v[36:39] offset:1024
    s_mov_b32 s60, 27787264
    s_mov_b64 exec, 0xff
    buffer_load_dword v209, v207, s[12:15], s60 offen sc1
    s_mov_b64 exec, -1
    s_waitcnt lgkmcnt(0)
    s_barrier
    ds_read_b128 v[8:11], v199 offset:0
    ds_read_b128 v[12:15], v199 offset:1024
    ds_read_b128 v[16:19], v200 offset:0
    ds_read_b128 v[20:23], v200 offset:1024
    ds_read_b128 v[24:27], v201 offset:0
    ds_read_b128 v[28:31], v201 offset:1024
    s_waitcnt vmcnt(1)
    ds_read_b64_tr_b16 v[216:217], v216
    ds_read_b64_tr_b16 v[218:219], v218
    ds_read_b64_tr_b16 v[220:221], v220
    ds_read_b64_tr_b16 v[222:223], v222
    ds_read_b64_tr_b16 v[224:225], v224
    ds_read_b64_tr_b16 v[226:227], v226
    ds_read_b64_tr_b16 v[228:229], v228
    ds_read_b64_tr_b16 v[230:231], v230
    ds_read_b64_tr_b16 v[232:233], v232
    ds_read_b64_tr_b16 v[234:235], v234
    ds_read_b64_tr_b16 v[236:237], v236
    ds_read_b64_tr_b16 v[238:239], v238
    ds_read_b64_tr_b16 v[240:241], v240
    ds_read_b64_tr_b16 v[242:243], v242
    ds_read_b64_tr_b16 v[244:245], v244
    ds_read_b64_tr_b16 v[246:247], v246
    s_lshl_b32 s50, s37, 4
    s_add_u32 s50, s50, s36
    s_add_u32 s50, s50, 256
    s_lshl_b32 s50, s50, 13
    s_mov_b32 s51, 0
    s_lshl_b32 s55, s51, 15
    s_or_b32 s50, s50, s55
    s_lshl_b32 s51, s51, 3
    s_or_b32 s51, s51, 0x80000
    s_waitcnt vmcnt(0)
    v_cmp_ne_u32 vcc, s39, v209
    s_bfe_u32 s55, vcc_lo, s51
    s_cmp_eq_u32 s55, 0
    s_cbranch_scc0 L_fw_1
L_fok_2:
    buffer_load_dwordx4 v[144:147], v1, s[12:15], s50 offen offset:0 sc1
    buffer_load_dwordx4 v[148:151], v1, s[12:15], s50 offen offset:1024 sc1
    buffer_load_dwordx4 v[152:155], v208, s[12:15], s50 offen offset:0 sc1
    buffer_load_dwordx4 v[156:159], v208, s[12:15], s50 offen offset:1024 sc1
    buffer_load_dwordx4 v[160:163], v1, s[12:15], s50 offen offset:2048 sc1
    buffer_load_dwordx4 v[164:167], v1, s[12:15], s50 offen offset:3072 sc1
    buffer_load_dwordx4 v[168:171], v208, s[12:15], s50 offen offset:2048 sc1
    buffer_load_dwordx4 v[172:175], v208, s[12:15], s50 offen offset:3072 sc1
    s_xor_b32 s50, s50, 4096
    v_mov_b32 v248, 0
    v_mov_b32 v249, 0
    v_mov_b32 v140, 0
    v_mov_b32 v141, 0
    s_waitcnt lgkmcnt(12)
    v_dot2c_f32_bf16 v248, s41, v216
    v_dot2c_f32_bf16 v248, s41, v217
    v_dot2c_f32_bf16 v248, s41, v218
    v_dot2c_f32_bf16 v248, s41, v219
    v_dot2c_f32_bf16 v248, s41, v220
    v_dot2c_f32_bf16 v248, s41, v221
    v_dot2c_f32_bf16 v248, s41, v222
    v_dot2c_f32_bf16 v248, s41, v223
    s_waitcnt lgkmcnt(8)
    v_dot2c_f32_bf16 v249, s41, v224
    v_dot2c_f32_bf16 v249, s41, v225
    v_dot2c_f32_bf16 v249, s41, v226
    v_dot2c_f32_bf16 v249, s41, v227
    v_dot2c_f32_bf16 v249, s41, v228
    v_dot2c_f32_bf16 v249, s41, v229
    v_dot2c_f32_bf16 v249, s41, v230
    v_dot2c_f32_bf16 v249, s41, v231
    s_waitcnt lgkmcnt(4)
    v_dot2c_f32_bf16 v140, s41, v232
    v_dot2c_f32_bf16 v140, s41, v233
    v_dot2c_f32_bf16 v140, s41, v234
    v_dot2c_f32_bf16 v140, s41, v235
    v_dot2c_f32_bf16 v140, s41, v236
    v_dot2c_f32_bf16 v140, s41, v237
    v_dot2c_f32_bf16 v140, s41, v238
    v_dot2c_f32_bf16 v140, s41, v239
    s_waitcnt lgkmcnt(0)
    v_dot2c_f32_bf16 v141, s41, v240
    v_dot2c_f32_bf16 v141, s41, v241
    v_dot2c_f32_bf16 v141, s41, v242
    v_dot2c_f32_bf16 v141, s41, v243
    v_dot2c_f32_bf16 v141, s41, v244
    v_dot2c_f32_bf16 v141, s41, v245
    v_dot2c_f32_bf16 v141, s41, v246
    v_dot2c_f32_bf16 v141, s41, v247
    v_permlane32_swap_b32 v248, v140
    s_nop 1
    v_permlane32_swap_b32 v249, v141
    v_add_f32 v248, v248, v140
    v_add_f32_e64 v249, v249, v141
L_attn:
    s_mov_b32 s33, s32
    s_mov_b32 s59, s35
    s_add_u32 s58, s101, 4096
    s_waitcnt vmcnt(6)
    v_mfma_f32_32x32x16_bf16 v[104:119], v[144:147], v[8:11], 0
    v_mfma_f32_32x32x16_bf16 v[104:119], v[148:151], v[12:15], v[104:119]
    s_nop 11
    v_exp_f32 v104, v104
    v_exp_f32 v105, v105
    v_exp_f32 v106, v106
    v_exp_f32 v107, v107
    v_cvt_pk_bf16_f32 v136, v104, v105
    v_exp_f32 v108, v108
    v_exp_f32 v109, v109
    v_cvt_pk_bf16_f32 v137, v106, v107
    v_mfma_f32_32x32x16_bf16 v[120:135], v[144:147], v[16:19], 0
    buffer_load_dwordx4 v[176:179], v1, s[12:15], s50 offen offset:0 sc1
    v_exp_f32 v110, v110
    v_exp_f32 v111, v111
    v_cvt_pk_bf16_f32 v138, v108, v109
    v_exp_f32 v112, v112
    v_exp_f32 v113, v113
    v_cvt_pk_bf16_f32 v139, v110, v111
    v_mfma_f32_32x32x16_bf16 v[120:135], v[148:151], v[20:23], v[120:135]
    s_waitcnt vmcnt(5)
    v_exp_f32 v114, v114
    v_exp_f32_e64 v115, v115
    v_cvt_pk_bf16_f32 v140, v112, v113
    v_exp_f32 v116, v116
    v_exp_f32 v117, v117
    v_cvt_pk_bf16_f32 v141, v114, v115
    v_mfma_f32_32x32x16_bf16 v[40:55], v[152:155], v[136:139], 0
    buffer_load_dwordx4 v[180:183], v1, s[12:15], s50 offen offset:1024 sc1
    v_exp_f32 v118, v118
    v_exp_f32 v119, v119
    v_cvt_pk_bf16_f32 v142, v116, v117
    v_cvt_pk_bf16_f32 v143, v118, v119
    v_exp_f32 v120, v120
    v_exp_f32 v121, v121
    v_mfma_f32_32x32x16_bf16 v[40:55], v[156:159], v[140:143], v[40:55]
    buffer_load_dwordx4 v[184:187], v208, s[12:15], s50 offen offset:0 sc1
    v_exp_f32 v122, v122
    v_exp_f32 v123, v123
    v_cvt_pk_bf16_f32 v136, v120, v121
    v_exp_f32 v124, v124
    v_exp_f32 v125, v125
    v_cvt_pk_bf16_f32 v137, v122, v123
    v_mfma_f32_32x32x16_bf16 v[104:119], v[144:147], v[24:27], 0
    buffer_load_dwordx4 v[188:191], v208, s[12:15], s50 offen offset:1024 sc1
    v_exp_f32 v126, v126
    v_exp_f32 v127, v127
    v_cvt_pk_bf16_f32 v138, v124, v125
    v_exp_f32 v128, v128
    v_exp_f32 v129, v129
    v_cvt_pk_bf16_f32 v139, v126, v127
    v_mfma_f32_32x32x16_bf16 v[104:119], v[148:151], v[28:31], v[104:119]
    buffer_load_dwordx4 a[192:195], v1, s[12:15], s50 offen offset:2048 sc1
    v_exp_f32 v130, v130
    v_exp_f32 v131, v131
    v_cvt_pk_bf16_f32 v140, v128, v129
    v_exp_f32 v132, v132
    v_exp_f32 v133, v133
    v_cvt_pk_bf16_f32 v141, v130, v131
    v_mfma_f32_32x32x16_bf16 v[56:71], v[152:155], v[136:139], 0
    v_exp_f32 v134, v134
    v_exp_f32 v135, v135
    v_cvt_pk_bf16_f32 v142, v132, v133
    v_cvt_pk_bf16_f32 v143, v134, v135
    v_exp_f32 v104, v104
    v_exp_f32 v105, v105
    v_mfma_f32_32x32x16_bf16 v[56:71], v[156:159], v[140:143], v[56:71]
    buffer_load_dwordx4 a[196:199], v1, s[12:15], s50 offen offset:3072 sc1
    v_exp_f32 v106, v106
    v_exp_f32 v107, v107
    v_cvt_pk_bf16_f32 v136, v104, v105
    v_exp_f32 v108, v108
    v_exp_f32 v109, v109
    v_cvt_pk_bf16_f32 v137, v106, v107
    v_mfma_f32_32x32x16_bf16 v[120:135], v[144:147], v[32:35], 0
    buffer_load_dwordx4 a[200:203], v208, s[12:15], s50 offen offset:2048 sc1
    v_exp_f32 v110, v110
    v_exp_f32 v111, v111
    v_cvt_pk_bf16_f32 v138, v108, v109
    v_exp_f32 v112, v112
    v_exp_f32 v113, v113
    v_cvt_pk_bf16_f32 v139, v110, v111
    v_mfma_f32_32x32x16_bf16 v[120:135], v[148:151], v[36:39], v[120:135]
    buffer_load_dwordx4 a[204:207], v208, s[12:15], s50 offen offset:3072 sc1
    v_exp_f32 v114, v114
    v_exp_f32 v115, v115
    v_cvt_pk_bf16_f32 v140, v112, v113
    v_exp_f32 v116, v116
    v_exp_f32 v117, v117
    v_cvt_pk_bf16_f32 v141, v114, v115
    v_mfma_f32_32x32x16_bf16 v[72:87], v[152:155], v[136:139], 0
    s_xor_b32 s50, s50, 36864
    v_exp_f32 v118, v118
    v_exp_f32 v119, v119
    v_cvt_pk_bf16_f32 v142, v116, v117
    v_cvt_pk_bf16_f32 v143, v118, v119
    v_exp_f32 v120, v120
    v_exp_f32 v121, v121
    v_mfma_f32_32x32x16_bf16 v[72:87], v[156:159], v[140:143], v[72:87]
    s_waitcnt vmcnt(8)
    v_exp_f32 v122, v122
    v_exp_f32_e64 v123, v123
    v_cvt_pk_bf16_f32 v136, v120, v121
    v_exp_f32 v124, v124
    v_exp_f32 v125, v125
    v_cvt_pk_bf16_f32 v137, v122, v123
    v_mfma_f32_32x32x16_bf16 v[104:119], v[160:163], v[8:11], 0
    buffer_load_dword v209, v207, s[12:15], s60 offen sc1
    v_exp_f32 v126, v126
    v_exp_f32 v127, v127
    v_cvt_pk_bf16_f32 v138, v124, v125
    v_exp_f32 v128, v128
    v_exp_f32 v129, v129
    v_cvt_pk_bf16_f32 v139, v126, v127
    v_mfma_f32_32x32x16_bf16 v[104:119], v[164:167], v[12:15], v[104:119]
    buffer_store_dwordx4 v[216:219], v1, s[12:15], s44 offen offset:0 sc1
    v_exp_f32 v130, v130
    v_exp_f32 v131, v131
    v_cvt_pk_bf16_f32 v140, v128, v129
    v_exp_f32 v132, v132
    v_exp_f32 v133, v133
    v_cvt_pk_bf16_f32 v141, v130, v131
    v_mfma_f32_32x32x16_bf16 v[88:103], v[152:155], v[136:139], 0
    buffer_store_dwordx4 v[220:223], v1, s[12:15], s44 offen offset:1024 sc1
    v_exp_f32 v134, v134
    v_exp_f32 v135, v135
    v_cvt_pk_bf16_f32 v142, v132, v133
    v_cvt_pk_bf16_f32 v143, v134, v135
    v_exp_f32 v104, v104
    v_exp_f32 v105, v105
    v_mfma_f32_32x32x16_bf16 v[88:103], v[156:159], v[140:143], v[88:103]
    s_add_u32 s44, s44, s30
    v_exp_f32 v106, v106
    v_exp_f32_e64 v107, v107
    v_cvt_pk_bf16_f32 v136, v104, v105
    v_exp_f32 v108, v108
    v_exp_f32 v109, v109
    v_cvt_pk_bf16_f32 v137, v106, v107
    v_mfma_f32_32x32x16_bf16 v[120:135], v[160:163], v[16:19], 0
    buffer_store_dwordx4 v[224:227], v1, s[12:15], s44 offen offset:0 sc1
    v_exp_f32 v110, v110
    v_exp_f32 v111, v111
    v_cvt_pk_bf16_f32 v138, v108, v109
    v_exp_f32 v112, v112
    v_exp_f32 v113, v113
    v_cvt_pk_bf16_f32 v139, v110, v111
    v_mfma_f32_32x32x16_bf16 v[120:135], v[164:167], v[20:23], v[120:135]
    buffer_store_dwordx4 v[228:231], v1, s[12:15], s44 offen offset:1024 sc1
    v_exp_f32 v114, v114
    v_exp_f32 v115, v115
    v_cvt_pk_bf16_f32 v140, v112, v113
    v_exp_f32 v116, v116
    v_exp_f32 v117, v117
    v_cvt_pk_bf16_f32 v141, v114, v115
    v_mfma_f32_32x32x16_bf16 v[40:55], v[168:171], v[136:139], v[40:55]
    s_add_u32 s44, s44, s30
    v_exp_f32 v118, v118
    v_exp_f32_e64 v119, v119
    v_cvt_pk_bf16_f32 v142, v116, v117
    v_cvt_pk_bf16_f32 v143, v118, v119
    v_exp_f32 v120, v120
    v_exp_f32 v121, v121
    v_mfma_f32_32x32x16_bf16 v[40:55], v[172:175], v[140:143], v[40:55]
    buffer_store_dwordx4 v[232:235], v1, s[12:15], s44 offen offset:0 sc1
    v_exp_f32 v122, v122
    v_exp_f32 v123, v123
    v_cvt_pk_bf16_f32 v136, v120, v121
    v_exp_f32 v124, v124
    v_exp_f32 v125, v125
    v_cvt_pk_bf16_f32 v137, v122, v123
    v_mfma_f32_32x32x16_bf16 v[104:119], v[160:163], v[24:27], 0
    buffer_store_dwordx4 v[236:239], v1, s[12:15], s44 offen offset:1024 sc1
    v_exp_f32 v126, v126
    v_exp_f32 v127, v127
    v_cvt_pk_bf16_f32 v138, v124, v125
    v_exp_f32 v128, v128
    v_exp_f32 v129, v129
    v_cvt_pk_bf16_f32 v139, v126, v127
    v_mfma_f32_32x32x16_bf16 v[104:119], v[164:167], v[28:31], v[104:119]
    s_add_u32 s44, s44, s30
    v_exp_f32 v130, v130
    v_exp_f32_e64 v131, v131
    v_cvt_pk_bf16_f32 v140, v128, v129
    v_exp_f32 v132, v132
    v_exp_f32 v133, v133
    v_cvt_pk_bf16_f32 v141, v130, v131
    v_mfma_f32_32x32x16_bf16 v[56:71], v[168:171], v[136:139], v[56:71]
    buffer_store_dwordx4 v[240:243], v1, s[12:15], s44 offen offset:0 sc1
    v_exp_f32 v134, v134
    v_exp_f32 v135, v135
    v_cvt_pk_bf16_f32 v142, v132, v133
    v_cvt_pk_bf16_f32 v143, v134, v135
    v_exp_f32 v104, v104
    v_exp_f32 v105, v105
    v_mfma_f32_32x32x16_bf16 v[56:71], v[172:175], v[140:143], v[56:71]
    buffer_store_dwordx4 v[244:247], v1, s[12:15], s44 offen offset:1024 sc1
    v_exp_f32 v106, v106
    v_exp_f32 v107, v107
    v_cvt_pk_bf16_f32 v136, v104, v105
    v_exp_f32 v108, v108
    v_exp_f32 v109, v109
    v_cvt_pk_bf16_f32 v137, v106, v107
    v_mfma_f32_32x32x16_bf16 v[120:135], v[160:163], v[32:35], 0
    buffer_store_dwordx2 v[248:249], v250, s[12:15], s45 offen sc1
    v_exp_f32 v110, v110
    v_exp_f32 v111, v111
    v_cvt_pk_bf16_f32 v138, v108, v109
    v_exp_f32 v112, v112
    v_exp_f32 v113, v113
    v_cvt_pk_bf16_f32 v139, v110, v111
    v_mfma_f32_32x32x16_bf16 v[120:135], v[164:167], v[36:39], v[120:135]
    v_exp_f32 v114, v114
    v_exp_f32 v115, v115
    v_cvt_pk_bf16_f32 v140, v112, v113
    v_exp_f32 v116, v116
    v_exp_f32 v117, v117
    v_cvt_pk_bf16_f32 v141, v114, v115
    v_mfma_f32_32x32x16_bf16 v[72:87], v[168:171], v[136:139], v[72:87]
    v_exp_f32 v118, v118
    v_exp_f32 v119, v119
    v_cvt_pk_bf16_f32 v142, v116, v117
    v_cvt_pk_bf16_f32 v143, v118, v119
    s_nop 0
    v_exp_f32 v120, v120
    v_exp_f32_e64 v121, v121
    v_mfma_f32_32x32x16_bf16 v[72:87], v[172:175], v[140:143], v[72:87]
    s_waitcnt vmcnt(14)
    v_exp_f32 v122, v122
    v_exp_f32_e64 v123, v123
    v_cvt_pk_bf16_f32 v136, v120, v121
    v_exp_f32 v124, v124
    v_exp_f32 v125, v125
    v_cvt_pk_bf16_f32 v137, v122, v123
    v_mfma_f32_32x32x16_bf16 v[104:119], v[176:179], v[8:11], 0
    v_exp_f32 v126, v126
    v_exp_f32 v127, v127
    v_cvt_pk_bf16_f32 v138, v124, v125
    v_exp_f32 v128, v128
    v_exp_f32 v129, v129
    v_cvt_pk_bf16_f32 v139, v126, v127
    v_mfma_f32_32x32x16_bf16 v[104:119], v[180:183], v[12:15], v[104:119]
    v_exp_f32 v130, v130
    v_exp_f32 v131, v131
    v_cvt_pk_bf16_f32 v140, v128, v129
    v_exp_f32 v132, v132
    v_exp_f32 v133, v133
    v_cvt_pk_bf16_f32 v141, v130, v131
    v_mfma_f32_32x32x16_bf16 v[88:103], v[168:171], v[136:139], v[88:103]
    v_exp_f32 v134, v134
    v_exp_f32 v135, v135
    v_cvt_pk_bf16_f32 v142, v132, v133
    v_cvt_pk_bf16_f32 v143, v134, v135
    s_nop 0
    v_exp_f32 v104, v104
    v_exp_f32_e64 v105, v105
    v_mfma_f32_32x32x16_bf16 v[88:103], v[172:175], v[140:143], v[88:103]
    s_waitcnt vmcnt(9)
    v_cmp_ne_u32 vcc, s39, v209
    s_cbranch_vccnz L_fw_3
L_fok_4:
    v_exp_f32 v106, v106
    v_exp_f32_e64 v107, v107
    v_cvt_pk_bf16_f32 v136, v104, v105
    v_exp_f32 v108, v108
    v_exp_f32 v109, v109
    v_cvt_pk_bf16_f32 v137, v106, v107
    v_mfma_f32_32x32x16_bf16 v[120:135], v[176:179], v[16:19], 0
    buffer_load_dwordx4 a[0:3], v1, s[12:15], s50 offen offset:0 sc1
    v_exp_f32 v110, v110
    v_exp_f32 v111, v111
    v_cvt_pk_bf16_f32 v138, v108, v109
    v_exp_f32 v112, v112
    v_exp_f32 v113, v113
    v_cvt_pk_bf16_f32 v139, v110, v111
    v_mfma_f32_32x32x16_bf16 v[120:135], v[180:183], v[20:23], v[120:135]
    buffer_load_dwordx4 a[4:7], v1, s[12:15], s50 offen offset:1024 sc1
    v_exp_f32 v114, v114
    v_exp_f32 v115, v115
    v_cvt_pk_bf16_f32 v140, v112, v113
    v_exp_f32 v116, v116
    v_exp_f32 v117, v117
    v_cvt_pk_bf16_f32 v141, v114, v115
    v_mfma_f32_32x32x16_bf16 v[40:55], v[184:187], v[136:139], v[40:55]
    buffer_load_dwordx4 a[8:11], v208, s[12:15], s50 offen offset:0 sc1
    v_exp_f32 v118, v118
    v_exp_f32 v119, v119
    v_cvt_pk_bf16_f32 v142, v116, v117
    v_cvt_pk_bf16_f32 v143, v118, v119
    v_exp_f32 v120, v120
    v_exp_f32 v121, v121
    v_mfma_f32_32x32x16_bf16 v[40:55], v[188:191], v[140:143], v[40:55]
    buffer_load_dwordx4 a[12:15], v208, s[12:15], s50 offen offset:1024 sc1
    v_exp_f32 v122, v122
    v_exp_f32 v123, v123
    v_cvt_pk_bf16_f32 v136, v120, v121
    v_exp_f32 v124, v124
    v_exp_f32 v125, v125
    v_cvt_pk_bf16_f32 v137, v122, v123
    v_mfma_f32_32x32x16_bf16 v[104:119], v[176:179], v[24:27], 0
    buffer_load_dwordx4 a[16:19], v1, s[12:15], s50 offen offset:2048 sc1
    v_exp_f32 v126, v126
    v_exp_f32 v127, v127
    v_cvt_pk_bf16_f32 v138, v124, v125
    v_exp_f32 v128, v128
    v_exp_f32 v129, v129
    v_cvt_pk_bf16_f32 v139, v126, v127
    v_mfma_f32_32x32x16_bf16 v[104:119], v[180:183], v[28:31], v[104:119]
    buffer_load_dwordx4 a[20:23], v1, s[12:15], s50 offen offset:3072 sc1
    v_exp_f32 v130, v130
    v_exp_f32 v131, v131
    v_cvt_pk_bf16_f32 v140, v128, v129
    v_exp_f32 v132, v132
    v_exp_f32 v133, v133
    v_cvt_pk_bf16_f32 v141, v130, v131
    v_mfma_f32_32x32x16_bf16 v[56:71], v[184:187], v[136:139], v[56:71]
    v_exp_f32 v134, v134
    v_exp_f32 v135, v135
    v_cvt_pk_bf16_f32 v142, v132, v133
    v_cvt_pk_bf16_f32 v143, v134, v135
    v_exp_f32 v104, v104
    v_exp_f32 v105, v105
    v_mfma_f32_32x32x16_bf16 v[56:71], v[188:191], v[140:143], v[56:71]
    buffer_load_dwordx4 a[24:27], v208, s[12:15], s50 offen offset:2048 sc1
    v_exp_f32 v106, v106
    v_exp_f32 v107, v107
    v_cvt_pk_bf16_f32 v136, v104, v105
    v_exp_f32 v108, v108
    v_exp_f32 v109, v109
    v_cvt_pk_bf16_f32 v137, v106, v107
    v_mfma_f32_32x32x16_bf16 v[120:135], v[176:179], v[32:35], 0
    buffer_load_dwordx4 a[28:31], v208, s[12:15], s50 offen offset:3072 sc1
    v_exp_f32 v110, v110
    v_exp_f32 v111, v111
    v_cvt_pk_bf16_f32 v138, v108, v109
    v_exp_f32 v112, v112
    v_exp_f32 v113, v113
    v_cvt_pk_bf16_f32 v139, v110, v111
    v_mfma_f32_32x32x16_bf16 v[120:135], v[180:183], v[36:39], v[120:135]
    s_xor_b32 s50, s50, 4096
    v_exp_f32 v114, v114
    v_exp_f32 v115, v115
    v_cvt_pk_bf16_f32 v140, v112, v113
    v_exp_f32 v116, v116
    v_exp_f32 v117, v117
    v_cvt_pk_bf16_f32 v141, v114, v115
    v_mfma_f32_32x32x16_bf16 v[72:87], v[184:187], v[136:139], v[72:87]
    buffer_load_dwordx4 a[32:35], v1, s[12:15], s50 offen offset:0 sc1
    v_exp_f32 v118, v118
    v_exp_f32 v119, v119
    v_cvt_pk_bf16_f32 v142, v116, v117
    v_cvt_pk_bf16_f32 v143, v118, v119
    v_exp_f32 v120, v120
    v_exp_f32 v121, v121
    v_mfma_f32_32x32x16_bf16 v[72:87], v[188:191], v[140:143], v[72:87]
    s_waitcnt vmcnt(9)
    v_exp_f32 v122, v122
    v_exp_f32_e64 v123, v123
    v_cvt_pk_bf16_f32 v136, v120, v121
    v_exp_f32 v124, v124
    v_exp_f32 v125, v125
    v_cvt_pk_bf16_f32 v137, v122, v123
    v_mfma_f32_32x32x16_bf16 v[104:119], a[192:195], v[8:11], 0
    buffer_store_dwordx4 v[212:215], v211, s[12:15], s31 offen sc1
    v_exp_f32 v126, v126
    v_exp_f32 v127, v127
    v_cvt_pk_bf16_f32 v138, v124, v125
    v_exp_f32 v128, v128
    v_exp_f32 v129, v129
    v_cvt_pk_bf16_f32 v139, v126, v127
    v_mfma_f32_32x32x16_bf16 v[104:119], a[196:199], v[12:15], v[104:119]
    buffer_load_dwordx4 a[36:39], v1, s[12:15], s50 offen offset:1024 sc1
    v_exp_f32 v130, v130
    v_exp_f32 v131, v131
    v_cvt_pk_bf16_f32 v140, v128, v129
    v_exp_f32 v132, v132
    v_exp_f32 v133, v133
    v_cvt_pk_bf16_f32 v141, v130, v131
    v_mfma_f32_32x32x16_bf16 v[88:103], v[184:187], v[136:139], v[88:103]
    v_exp_f32 v134, v134
    v_exp_f32 v135, v135
    v_cvt_pk_bf16_f32 v142, v132, v133
    v_cvt_pk_bf16_f32 v143, v134, v135
    v_exp_f32 v104, v104
    v_exp_f32 v105, v105
    v_mfma_f32_32x32x16_bf16 v[88:103], v[188:191], v[140:143], v[88:103]
    buffer_load_dwordx4 a[40:43], v208, s[12:15], s50 offen offset:0 sc1
    v_exp_f32 v106, v106
    v_exp_f32 v107, v107
    v_cvt_pk_bf16_f32 v136, v104, v105
    v_exp_f32 v108, v108
    v_exp_f32 v109, v109
    v_cvt_pk_bf16_f32 v137, v106, v107
    v_mfma_f32_32x32x16_bf16 v[120:135], a[192:195], v[16:19], 0
    buffer_load_dwordx4 a[44:47], v208, s[12:15], s50 offen offset:1024 sc1
    v_exp_f32 v110, v110
    v_exp_f32 v111, v111
    v_cvt_pk_bf16_f32 v138, v108, v109
    v_exp_f32 v112, v112
    v_exp_f32 v113, v113
    v_cvt_pk_bf16_f32 v139, v110, v111
    v_mfma_f32_32x32x16_bf16 v[120:135], a[196:199], v[20:23], v[120:135]
    buffer_load_dwordx4 a[48:51], v1, s[12:15], s50 offen offset:2048 sc1
    v_exp_f32 v114, v114
    v_exp_f32 v115, v115
    v_cvt_pk_bf16_f32 v140, v112, v113
    v_exp_f32 v116, v116
    v_exp_f32 v117, v117
    v_cvt_pk_bf16_f32 v141, v114, v115
    v_mfma_f32_32x32x16_bf16 v[40:55], a[200:203], v[136:139], v[40:55]
    v_exp_f32 v118, v118
    v_exp_f32 v119, v119
    v_cvt_pk_bf16_f32 v142, v116, v117
    v_cvt_pk_bf16_f32 v143, v118, v119
    v_exp_f32 v120, v120
    v_exp_f32 v121, v121
    v_mfma_f32_32x32x16_bf16 v[40:55], a[204:207], v[140:143], v[40:55]
    buffer_load_dwordx4 a[52:55], v1, s[12:15], s50 offen offset:3072 sc1
    v_exp_f32 v122, v122
    v_exp_f32 v123, v123
    v_cvt_pk_bf16_f32 v136, v120, v121
    v_exp_f32 v124, v124
    v_exp_f32 v125, v125
    v_cvt_pk_bf16_f32 v137, v122, v123
    v_mfma_f32_32x32x16_bf16 v[104:119], a[192:195], v[24:27], 0
    buffer_load_dwordx4 a[56:59], v208, s[12:15], s50 offen offset:2048 sc1
    v_exp_f32 v126, v126
    v_exp_f32 v127, v127
    v_cvt_pk_bf16_f32 v138, v124, v125
    v_exp_f32 v128, v128
    v_exp_f32 v129, v129
    v_cvt_pk_bf16_f32 v139, v126, v127
    v_mfma_f32_32x32x16_bf16 v[104:119], a[196:199], v[28:31], v[104:119]
    buffer_load_dwordx4 a[60:63], v208, s[12:15], s50 offen offset:3072 sc1
    v_exp_f32 v130, v130
    v_exp_f32 v131, v131
    v_cvt_pk_bf16_f32 v140, v128, v129
    v_exp_f32 v132, v132
    v_exp_f32 v133, v133
    v_cvt_pk_bf16_f32 v141, v130, v131
    v_mfma_f32_32x32x16_bf16 v[56:71], a[200:203], v[136:139], v[56:71]
    s_xor_b32 s50, s50, 102400
    v_exp_f32 v134, v134
    v_exp_f32 v135, v135
    v_cvt_pk_bf16_f32 v142, v132, v133
    v_cvt_pk_bf16_f32 v143, v134, v135
    v_exp_f32 v104, v104
    v_exp_f32 v105, v105
    v_mfma_f32_32x32x16_bf16 v[56:71], a[204:207], v[140:143], v[56:71]
    buffer_store_dwordx4 a[220:223], v211, s[12:15], s67 offen sc1
    v_exp_f32 v106, v106
    v_exp_f32 v107, v107
    v_cvt_pk_bf16_f32 v136, v104, v105
    v_exp_f32 v108, v108
    v_exp_f32 v109, v109
    v_cvt_pk_bf16_f32 v137, v106, v107
    v_mfma_f32_32x32x16_bf16 v[120:135], a[192:195], v[32:35], 0
    buffer_store_dwordx4 a[220:223], v211, s[12:15], s68 offen sc1
    v_exp_f32 v110, v110
    v_exp_f32 v111, v111
    v_cvt_pk_bf16_f32 v138, v108, v109
    v_exp_f32 v112, v112
    v_exp_f32 v113, v113
    v_cvt_pk_bf16_f32 v139, v110, v111
    v_mfma_f32_32x32x16_bf16 v[120:135], a[196:199], v[36:39], v[120:135]
    v_exp_f32 v114, v114
    v_exp_f32 v115, v115
    v_cvt_pk_bf16_f32 v140, v112, v113
    v_exp_f32 v116, v116
    v_exp_f32 v117, v117
    v_cvt_pk_bf16_f32 v141, v114, v115
    v_mfma_f32_32x32x16_bf16 v[72:87], a[200:203], v[136:139], v[72:87]
    v_exp_f32 v118, v118
    v_exp_f32 v119, v119
    v_cvt_pk_bf16_f32 v142, v116, v117
    v_cvt_pk_bf16_f32 v143, v118, v119
    s_nop 0
    v_exp_f32 v120, v120
    v_exp_f32_e64 v121, v121
    v_mfma_f32_32x32x16_bf16 v[72:87], a[204:207], v[140:143], v[72:87]
    s_waitcnt vmcnt(15)
    v_exp_f32 v122, v122
    v_exp_f32_e64 v123, v123
    v_cvt_pk_bf16_f32 v136, v120, v121
    v_exp_f32 v124, v124
    v_exp_f32 v125, v125
    v_cvt_pk_bf16_f32 v137, v122, v123
    v_mfma_f32_32x32x16_bf16 v[104:119], a[0:3], v[8:11], 0
    buffer_load_dwordx4 a[64:67], v1, s[12:15], s50 offen offset:0 sc1
    v_exp_f32 v126, v126
    v_exp_f32 v127, v127
    v_cvt_pk_bf16_f32 v138, v124, v125
    v_exp_f32 v128, v128
    v_exp_f32 v129, v129
    v_cvt_pk_bf16_f32 v139, v126, v127
    v_mfma_f32_32x32x16_bf16 v[104:119], a[4:7], v[12:15], v[104:119]
    buffer_load_dwordx4 a[68:71], v1, s[12:15], s50 offen offset:1024 sc1
    v_exp_f32 v130, v130
    v_exp_f32 v131, v131
    v_cvt_pk_bf16_f32 v140, v128, v129
    v_exp_f32 v132, v132
    v_exp_f32 v133, v133
    v_cvt_pk_bf16_f32 v141, v130, v131
    v_mfma_f32_32x32x16_bf16 v[88:103], a[200:203], v[136:139], v[88:103]
    buffer_load_dwordx4 a[72:75], v208, s[12:15], s50 offen offset:0 sc1
    v_exp_f32 v134, v134
    v_exp_f32 v135, v135
    v_cvt_pk_bf16_f32 v142, v132, v133
    v_cvt_pk_bf16_f32 v143, v134, v135
    v_exp_f32 v104, v104
    v_exp_f32 v105, v105
    v_mfma_f32_32x32x16_bf16 v[88:103], a[204:207], v[140:143], v[88:103]
    buffer_load_dwordx4 a[76:79], v208, s[12:15], s50 offen offset:1024 sc1
    v_exp_f32 v106, v106
    v_exp_f32 v107, v107
    v_cvt_pk_bf16_f32 v136, v104, v105
    v_exp_f32 v108, v108
    v_exp_f32 v109, v109
    v_cvt_pk_bf16_f32 v137, v106, v107
    v_mfma_f32_32x32x16_bf16 v[120:135], a[0:3], v[16:19], 0
    buffer_load_dwordx4 a[80:83], v1, s[12:15], s50 offen offset:2048 sc1
    v_exp_f32 v110, v110
    v_exp_f32 v111, v111
    v_cvt_pk_bf16_f32 v138, v108, v109
    v_exp_f32 v112, v112
    v_exp_f32 v113, v113
    v_cvt_pk_bf16_f32 v139, v110, v111
    v_mfma_f32_32x32x16_bf16 v[120:135], a[4:7], v[20:23], v[120:135]
    buffer_load_dwordx4 a[84:87], v1, s[12:15], s50 offen offset:3072 sc1
    v_exp_f32 v114, v114
    v_exp_f32 v115, v115
    v_cvt_pk_bf16_f32 v140, v112, v113
    v_exp_f32 v116, v116
    v_exp_f32 v117, v117
    v_cvt_pk_bf16_f32 v141, v114, v115
    v_mfma_f32_32x32x16_bf16 v[40:55], a[8:11], v[136:139], v[40:55]
    v_exp_f32 v118, v118
    v_exp_f32 v119, v119
    v_cvt_pk_bf16_f32 v142, v116, v117
    v_cvt_pk_bf16_f32 v143, v118, v119
    v_exp_f32 v120, v120
    v_exp_f32 v121, v121
    v_mfma_f32_32x32x16_bf16 v[40:55], a[12:15], v[140:143], v[40:55]
    buffer_load_dwordx4 a[88:91], v208, s[12:15], s50 offen offset:2048 sc1
    v_exp_f32 v122, v122
    v_exp_f32 v123, v123
    v_cvt_pk_bf16_f32 v136, v120, v121
    v_exp_f32 v124, v124
    v_exp_f32 v125, v125
    v_cvt_pk_bf16_f32 v137, v122, v123
    v_mfma_f32_32x32x16_bf16 v[104:119], a[0:3], v[24:27], 0
    buffer_load_dwordx4 a[92:95], v208, s[12:15], s50 offen offset:3072 sc1
    v_exp_f32 v126, v126
    v_exp_f32 v127, v127
    v_cvt_pk_bf16_f32 v138, v124, v125
    v_exp_f32 v128, v128
    v_exp_f32 v129, v129
    v_cvt_pk_bf16_f32 v139, v126, v127
    v_mfma_f32_32x32x16_bf16 v[104:119], a[4:7], v[28:31], v[104:119]
    s_xor_b32 s50, s50, 4096
    v_exp_f32 v130, v130
    v_exp_f32 v131, v131
    v_cvt_pk_bf16_f32 v140, v128, v129
    v_exp_f32 v132, v132
    v_exp_f32 v133, v133
    v_cvt_pk_bf16_f32 v141, v130, v131
    v_mfma_f32_32x32x16_bf16 v[56:71], a[8:11], v[136:139], v[56:71]
    buffer_load_dwordx4 v[192:195], v1, s[12:15], s50 offen offset:0 sc1
    v_exp_f32 v134, v134
    v_exp_f32 v135, v135
    v_cvt_pk_bf16_f32 v142, v132, v133
    v_cvt_pk_bf16_f32 v143, v134, v135
    v_exp_f32 v104, v104
    v_exp_f32 v105, v105
    v_mfma_f32_32x32x16_bf16 v[56:71], a[12:15], v[140:143], v[56:71]
    buffer_store_dwordx4 a[220:223], v1, s[12:15], s64 offen offset:0 sc1
    v_exp_f32 v106, v106
    v_exp_f32 v107, v107
    v_cvt_pk_bf16_f32 v136, v104, v105
    v_exp_f32 v108, v108
    v_exp_f32 v109, v109
    v_cvt_pk_bf16_f32 v137, v106, v107
    v_mfma_f32_32x32x16_bf16 v[120:135], a[0:3], v[32:35], 0
    buffer_load_dwordx4 v[196:199], v1, s[12:15], s50 offen offset:1024 sc1
    v_exp_f32 v110, v110
    v_exp_f32 v111, v111
    v_cvt_pk_bf16_f32 v138, v108, v109
    v_exp_f32 v112, v112
    v_exp_f32 v113, v113
    v_cvt_pk_bf16_f32 v139, v110, v111
    v_mfma_f32_32x32x16_bf16 v[120:135], a[4:7], v[36:39], v[120:135]
    v_exp_f32 v114, v114
    v_exp_f32 v115, v115
    v_cvt_pk_bf16_f32 v140, v112, v113
    v_exp_f32 v116, v116
    v_exp_f32 v117, v117
    v_cvt_pk_bf16_f32 v141, v114, v115
    v_mfma_f32_32x32x16_bf16 v[72:87], a[8:11], v[136:139], v[72:87]
    v_exp_f32 v118, v118
    v_exp_f32 v119, v119
    v_cvt_pk_bf16_f32 v142, v116, v117
    v_cvt_pk_bf16_f32 v143, v118, v119
    s_nop 0
    v_exp_f32 v120, v120
    v_exp_f32_e64 v121, v121
    v_mfma_f32_32x32x16_bf16 v[72:87], a[12:15], v[140:143], v[72:87]
    s_waitcnt vmcnt(22)
    v_exp_f32 v122, v122
    v_exp_f32_e64 v123, v123
    v_cvt_pk_bf16_f32 v136, v120, v121
    v_exp_f32 v124, v124
    v_exp_f32 v125, v125
    v_cvt_pk_bf16_f32 v137, v122, v123
    v_mfma_f32_32x32x16_bf16 v[104:119], a[16:19], v[8:11], 0
    buffer_load_dwordx4 v[200:203], v208, s[12:15], s50 offen offset:0 sc1
    v_exp_f32 v126, v126
    v_exp_f32 v127, v127
    v_cvt_pk_bf16_f32 v138, v124, v125
    v_exp_f32 v128, v128
    v_exp_f32 v129, v129
    v_cvt_pk_bf16_f32 v139, v126, v127
    v_mfma_f32_32x32x16_bf16 v[104:119], a[20:23], v[12:15], v[104:119]
    buffer_load_dwordx4 v[204:207], v208, s[12:15], s50 offen offset:1024 sc1
    v_exp_f32 v130, v130
    v_exp_f32 v131, v131
    v_cvt_pk_bf16_f32 v140, v128, v129
    v_exp_f32 v132, v132
    v_exp_f32 v133, v133
    v_cvt_pk_bf16_f32 v141, v130, v131
    v_mfma_f32_32x32x16_bf16 v[88:103], a[8:11], v[136:139], v[88:103]
    v_exp_f32 v134, v134
    v_exp_f32 v135, v135
    v_cvt_pk_bf16_f32 v142, v132, v133
    v_cvt_pk_bf16_f32 v143, v134, v135
    v_exp_f32 v104, v104
    v_exp_f32 v105, v105
    v_mfma_f32_32x32x16_bf16 v[88:103], a[12:15], v[140:143], v[88:103]
    buffer_load_dwordx4 v[144:147], v1, s[12:15], s50 offen offset:2048 sc1
    v_exp_f32 v106, v106
    v_exp_f32 v107, v107
    v_cvt_pk_bf16_f32 v136, v104, v105
    v_exp_f32 v108, v108
    v_exp_f32 v109, v109
    v_cvt_pk_bf16_f32 v137, v106, v107
    v_mfma_f32_32x32x16_bf16 v[120:135], a[16:19], v[16:19], 0
    buffer_load_dwordx4 v[148:151], v1, s[12:15], s50 offen offset:3072 sc1
    v_exp_f32 v110, v110
    v_exp_f32 v111, v111
    v_cvt_pk_bf16_f32 v138, v108, v109
    v_exp_f32 v112, v112
    v_exp_f32 v113, v113
    v_cvt_pk_bf16_f32 v139, v110, v111
    v_mfma_f32_32x32x16_bf16 v[120:135], a[20:23], v[20:23], v[120:135]
    buffer_load_dwordx4 v[152:155], v208, s[12:15], s50 offen offset:2048 sc1
    v_exp_f32 v114, v114
    v_exp_f32 v115, v115
    v_cvt_pk_bf16_f32 v140, v112, v113
    v_exp_f32 v116, v116
    v_exp_f32 v117, v117
    v_cvt_pk_bf16_f32 v141, v114, v115
    v_mfma_f32_32x32x16_bf16 v[40:55], a[24:27], v[136:139], v[40:55]
    v_exp_f32 v118, v118
    v_exp_f32 v119, v119
    v_cvt_pk_bf16_f32 v142, v116, v117
    v_cvt_pk_bf16_f32 v143, v118, v119
    v_exp_f32 v120, v120
    v_exp_f32 v121, v121
    v_mfma_f32_32x32x16_bf16 v[40:55], a[28:31], v[140:143], v[40:55]
    buffer_load_dwordx4 v[156:159], v208, s[12:15], s50 offen offset:3072 sc1
    v_exp_f32 v122, v122
    v_exp_f32 v123, v123
    v_cvt_pk_bf16_f32 v136, v120, v121
    v_exp_f32 v124, v124
    v_exp_f32 v125, v125
    v_cvt_pk_bf16_f32 v137, v122, v123
    v_mfma_f32_32x32x16_bf16 v[104:119], a[16:19], v[24:27], 0
    s_xor_b32 s50, s50, 36864
    v_exp_f32 v126, v126
    v_exp_f32 v127, v127
    v_cvt_pk_bf16_f32 v138, v124, v125
    v_exp_f32 v128, v128
    v_exp_f32 v129, v129
    v_cvt_pk_bf16_f32 v139, v126, v127
    v_mfma_f32_32x32x16_bf16 v[104:119], a[20:23], v[28:31], v[104:119]
    buffer_load_dwordx4 v[160:163], v1, s[12:15], s50 offen offset:0 sc1
    v_exp_f32 v130, v130
    v_exp_f32 v131, v131
    v_cvt_pk_bf16_f32 v140, v128, v129
    v_exp_f32 v132, v132
    v_exp_f32 v133, v133
    v_cvt_pk_bf16_f32 v141, v130, v131
    v_mfma_f32_32x32x16_bf16 v[56:71], a[24:27], v[136:139], v[56:71]
    buffer_load_dwordx4 v[164:167], v1, s[12:15], s50 offen offset:1024 sc1
    v_exp_f32 v134, v134
    v_exp_f32 v135, v135
    v_cvt_pk_bf16_f32 v142, v132, v133
    v_cvt_pk_bf16_f32 v143, v134, v135
    v_exp_f32 v104, v104
    v_exp_f32 v105, v105
    v_mfma_f32_32x32x16_bf16 v[56:71], a[28:31], v[140:143], v[56:71]
    buffer_store_dwordx4 a[220:223], v1, s[12:15], s64 offen offset:1024 sc1
    v_exp_f32 v106, v106
    v_exp_f32 v107, v107
    v_cvt_pk_bf16_f32 v136, v104, v105
    v_exp_f32 v108, v108
    v_exp_f32 v109, v109
    v_cvt_pk_bf16_f32 v137, v106, v107
    v_mfma_f32_32x32x16_bf16 v[120:135], a[16:19], v[32:35], 0
    buffer_load_dwordx4 v[168:171], v208, s[12:15], s50 offen offset:0 sc1
    v_exp_f32 v110, v110
    v_exp_f32 v111, v111
    v_cvt_pk_bf16_f32 v138, v108, v109
    v_exp_f32 v112, v112
    v_exp_f32 v113, v113
    v_cvt_pk_bf16_f32 v139, v110, v111
    v_mfma_f32_32x32x16_bf16 v[120:135], a[20:23], v[36:39], v[120:135]
    v_exp_f32 v114, v114
    v_exp_f32 v115, v115
    v_cvt_pk_bf16_f32 v140, v112, v113
    v_exp_f32 v116, v116
    v_exp_f32 v117, v117
    v_cvt_pk_bf16_f32 v141, v114, v115
    v_mfma_f32_32x32x16_bf16 v[72:87], a[24:27], v[136:139], v[72:87]
    v_exp_f32 v118, v118
    v_exp_f32 v119, v119
    v_cvt_pk_bf16_f32 v142, v116, v117
    v_cvt_pk_bf16_f32 v143, v118, v119
    s_nop 0
    v_exp_f32 v120, v120
    v_exp_f32_e64 v121, v121
    v_mfma_f32_32x32x16_bf16 v[72:87], a[28:31], v[140:143], v[72:87]
    s_waitcnt vmcnt(27)
    v_exp_f32 v122, v122
    v_exp_f32_e64 v123, v123
    v_cvt_pk_bf16_f32 v136, v120, v121
    v_exp_f32 v124, v124
    v_exp_f32 v125, v125
    v_cvt_pk_bf16_f32 v137, v122, v123
    v_mfma_f32_32x32x16_bf16 v[104:119], a[32:35], v[8:11], 0
    buffer_load_dwordx4 v[172:175], v208, s[12:15], s50 offen offset:1024 sc1
    v_exp_f32 v126, v126
    v_exp_f32 v127, v127
    v_cvt_pk_bf16_f32 v138, v124, v125
    v_exp_f32 v128, v128
    v_exp_f32 v129, v129
    v_cvt_pk_bf16_f32 v139, v126, v127
    v_mfma_f32_32x32x16_bf16 v[104:119], a[36:39], v[12:15], v[104:119]
    buffer_load_dwordx4 v[176:179], v1, s[12:15], s50 offen offset:2048 sc1
    v_exp_f32 v130, v130
    v_exp_f32 v131, v131
    v_cvt_pk_bf16_f32 v140, v128, v129
    v_exp_f32 v132, v132
    v_exp_f32 v133, v133
    v_cvt_pk_bf16_f32 v141, v130, v131
    v_mfma_f32_32x32x16_bf16 v[88:103], a[24:27], v[136:139], v[88:103]
    buffer_load_dwordx4 v[180:183], v1, s[12:15], s50 offen offset:3072 sc1
    v_exp_f32 v134, v134
    v_exp_f32 v135, v135
    v_cvt_pk_bf16_f32 v142, v132, v133
    v_cvt_pk_bf16_f32 v143, v134, v135
    v_exp_f32 v104, v104
    v_exp_f32 v105, v105
    v_mfma_f32_32x32x16_bf16 v[88:103], a[28:31], v[140:143], v[88:103]
    buffer_load_dwordx4 v[184:187], v208, s[12:15], s50 offen offset:2048 sc1
    v_exp_f32 v106, v106
    v_exp_f32 v107, v107
    v_cvt_pk_bf16_f32 v136, v104, v105
    v_exp_f32 v108, v108
    v_exp_f32 v109, v109
    v_cvt_pk_bf16_f32 v137, v106, v107
    v_mfma_f32_32x32x16_bf16 v[120:135], a[32:35], v[16:19], 0
    buffer_load_dwordx4 v[188:191], v208, s[12:15], s50 offen offset:3072 sc1
    v_exp_f32 v110, v110
    v_exp_f32 v111, v111
    v_cvt_pk_bf16_f32 v138, v108, v109
    v_exp_f32 v112, v112
    v_exp_f32 v113, v113
    v_cvt_pk_bf16_f32 v139, v110, v111
    v_mfma_f32_32x32x16_bf16 v[120:135], a[36:39], v[20:23], v[120:135]
    s_xor_b32 s50, s50, 4096
    v_exp_f32 v114, v114
    v_exp_f32 v115, v115
    v_cvt_pk_bf16_f32 v140, v112, v113
    v_exp_f32 v116, v116
    v_exp_f32 v117, v117
    v_cvt_pk_bf16_f32 v141, v114, v115
    v_mfma_f32_32x32x16_bf16 v[40:55], a[40:43], v[136:139], v[40:55]
    v_exp_f32 v118, v118
    v_exp_f32 v119, v119
    v_cvt_pk_bf16_f32 v142, v116, v117
    v_cvt_pk_bf16_f32 v143, v118, v119
    v_exp_f32 v120, v120
    v_exp_f32 v121, v121
    v_mfma_f32_32x32x16_bf16 v[40:55], a[44:47], v[140:143], v[40:55]
    buffer_load_dwordx4 a[192:195], v1, s[12:15], s50 offen offset:0 sc1
    v_exp_f32 v122, v122
    v_exp_f32 v123, v123
    v_cvt_pk_bf16_f32 v136, v120, v121
    v_exp_f32 v124, v124
    v_exp_f32 v125, v125
    v_cvt_pk_bf16_f32 v137, v122, v123
    v_mfma_f32_32x32x16_bf16 v[104:119], a[32:35], v[24:27], 0
    buffer_load_dwordx4 a[196:199], v1, s[12:15], s50 offen offset:1024 sc1
    v_exp_f32 v126, v126
    v_exp_f32 v127, v127
    v_cvt_pk_bf16_f32 v138, v124, v125
    v_exp_f32 v128, v128
    v_exp_f32 v129, v129
    v_cvt_pk_bf16_f32 v139, v126, v127
    v_mfma_f32_32x32x16_bf16 v[104:119], a[36:39], v[28:31], v[104:119]
    buffer_load_dwordx4 a[200:203], v208, s[12:15], s50 offen offset:0 sc1
    v_exp_f32 v130, v130
    v_exp_f32 v131, v131
    v_cvt_pk_bf16_f32 v140, v128, v129
    v_exp_f32 v132, v132
    v_exp_f32 v133, v133
    v_cvt_pk_bf16_f32 v141, v130, v131
    v_mfma_f32_32x32x16_bf16 v[56:71], a[40:43], v[136:139], v[56:71]
    v_exp_f32 v134, v134
    v_exp_f32 v135, v135
    v_cvt_pk_bf16_f32 v142, v132, v133
    v_cvt_pk_bf16_f32 v143, v134, v135
    v_exp_f32 v104, v104
    v_exp_f32 v105, v105
    v_mfma_f32_32x32x16_bf16 v[56:71], a[44:47], v[140:143], v[56:71]
    s_mov_b32 s60, 25329664
    v_exp_f32 v106, v106
    v_exp_f32 v107, v107
    v_cvt_pk_bf16_f32 v136, v104, v105
    v_exp_f32 v108, v108
    v_exp_f32 v109, v109
    v_cvt_pk_bf16_f32 v137, v106, v107
    v_mfma_f32_32x32x16_bf16 v[120:135], a[32:35], v[32:35], 0
    buffer_load_dword v209, v3, s[12:15], s60 offen sc1
    v_exp_f32 v110, v110
    v_exp_f32 v111, v111
    v_cvt_pk_bf16_f32 v138, v108, v109
    v_exp_f32 v112, v112
    v_exp_f32 v113, v113
    v_cvt_pk_bf16_f32 v139, v110, v111
    v_mfma_f32_32x32x16_bf16 v[120:135], a[36:39], v[36:39], v[120:135]
    buffer_load_dwordx4 a[204:207], v208, s[12:15], s50 offen offset:1024 sc1
    v_exp_f32 v114, v114
    v_exp_f32 v115, v115
    v_cvt_pk_bf16_f32 v140, v112, v113
    v_exp_f32 v116, v116
    v_exp_f32 v117, v117
    v_cvt_pk_bf16_f32 v141, v114, v115
    v_mfma_f32_32x32x16_bf16 v[72:87], a[40:43], v[136:139], v[72:87]
    buffer_load_dwordx4 a[176:179], v1, s[12:15], s50 offen offset:2048 sc1
    v_exp_f32 v118, v118
    v_exp_f32 v119, v119
    v_cvt_pk_bf16_f32 v142, v116, v117
    v_cvt_pk_bf16_f32 v143, v118, v119
    v_exp_f32 v120, v120
    v_exp_f32 v121, v121
    v_mfma_f32_32x32x16_bf16 v[72:87], a[44:47], v[140:143], v[72:87]
    s_waitcnt vmcnt(34)
    v_exp_f32 v122, v122
    v_exp_f32_e64 v123, v123
    v_cvt_pk_bf16_f32 v136, v120, v121
    v_exp_f32 v124, v124
    v_exp_f32 v125, v125
    v_cvt_pk_bf16_f32 v137, v122, v123
    v_mfma_f32_32x32x16_bf16 v[104:119], a[48:51], v[8:11], 0
    buffer_store_dwordx4 a[220:223], v1, s[12:15], s65 offen offset:0 sc1
    v_exp_f32 v126, v126
    v_exp_f32 v127, v127
    v_cvt_pk_bf16_f32 v138, v124, v125
    v_exp_f32 v128, v128
    v_exp_f32 v129, v129
    v_cvt_pk_bf16_f32 v139, v126, v127
    v_mfma_f32_32x32x16_bf16 v[104:119], a[52:55], v[12:15], v[104:119]
    buffer_load_dwordx4 a[180:183], v1, s[12:15], s50 offen offset:3072 sc1
    v_exp_f32 v130, v130
    v_exp_f32 v131, v131
    v_cvt_pk_bf16_f32 v140, v128, v129
    v_exp_f32 v132, v132
    v_exp_f32 v133, v133
    v_cvt_pk_bf16_f32 v141, v130, v131
    v_mfma_f32_32x32x16_bf16 v[88:103], a[40:43], v[136:139], v[88:103]
    v_exp_f32 v134, v134
    v_exp_f32 v135, v135
    v_cvt_pk_bf16_f32 v142, v132, v133
    v_cvt_pk_bf16_f32 v143, v134, v135
    v_exp_f32 v104, v104
    v_exp_f32 v105, v105
    v_mfma_f32_32x32x16_bf16 v[88:103], a[44:47], v[140:143], v[88:103]
    buffer_store_dwordx4 a[220:223], v1, s[12:15], s65 offen offset:1024 sc1
    v_exp_f32 v106, v106
    v_exp_f32 v107, v107
    v_cvt_pk_bf16_f32 v136, v104, v105
    v_exp_f32 v108, v108
    v_exp_f32 v109, v109
    v_cvt_pk_bf16_f32 v137, v106, v107
    v_mfma_f32_32x32x16_bf16 v[120:135], a[48:51], v[16:19], 0
    buffer_load_dwordx4 a[184:187], v208, s[12:15], s50 offen offset:2048 sc1
    v_exp_f32 v110, v110
    v_exp_f32 v111, v111
    v_cvt_pk_bf16_f32 v138, v108, v109
    v_exp_f32 v112, v112
    v_exp_f32 v113, v113
    v_cvt_pk_bf16_f32 v139, v110, v111
    v_mfma_f32_32x32x16_bf16 v[120:135], a[52:55], v[20:23], v[120:135]
    v_exp_f32 v114, v114
    v_exp_f32 v115, v115
    v_cvt_pk_bf16_f32 v140, v112, v113
    v_exp_f32 v116, v116
    v_exp_f32 v117, v117
    v_cvt_pk_bf16_f32 v141, v114, v115
    v_mfma_f32_32x32x16_bf16 v[40:55], a[56:59], v[136:139], v[40:55]
    v_exp_f32 v118, v118
    v_exp_f32 v119, v119
    v_cvt_pk_bf16_f32 v142, v116, v117
    v_cvt_pk_bf16_f32 v143, v118, v119
    s_nop 0
    v_exp_f32 v120, v120
    v_exp_f32_e64 v121, v121
    v_mfma_f32_32x32x16_bf16 v[40:55], a[60:63], v[140:143], v[40:55]
    buffer_store_dword a220, v210, s[12:15], s66 offen sc1
    v_exp_f32 v122, v122
    v_exp_f32 v123, v123
    v_cvt_pk_bf16_f32 v136, v120, v121
    v_exp_f32 v124, v124
    v_exp_f32 v125, v125
    v_cvt_pk_bf16_f32 v137, v122, v123
    v_mfma_f32_32x32x16_bf16 v[104:119], a[48:51], v[24:27], 0
    buffer_load_dwordx4 a[188:191], v208, s[12:15], s50 offen offset:3072 sc1
    v_exp_f32 v126, v126
    v_exp_f32 v127, v127
    v_cvt_pk_bf16_f32 v138, v124, v125
    v_exp_f32 v128, v128
    v_exp_f32 v129, v129
    v_cvt_pk_bf16_f32 v139, v126, v127
    v_mfma_f32_32x32x16_bf16 v[104:119], a[52:55], v[28:31], v[104:119]
    v_exp_f32 v130, v130
    v_exp_f32 v131, v131
    v_cvt_pk_bf16_f32 v140, v128, v129
    v_exp_f32 v132, v132
    v_exp_f32 v133, v133
    v_cvt_pk_bf16_f32 v141, v130, v131
    v_mfma_f32_32x32x16_bf16 v[56:71], a[56:59], v[136:139], v[56:71]
    v_exp_f32 v134, v134
    v_exp_f32 v135, v135
    v_cvt_pk_bf16_f32 v142, v132, v133
    v_cvt_pk_bf16_f32 v143, v134, v135
    s_nop 0
    v_exp_f32 v104, v104
    v_exp_f32_e64 v105, v105
    v_mfma_f32_32x32x16_bf16 v[56:71], a[60:63], v[140:143], v[56:71]
    buffer_store_dwordx4 a[220:223], v1, s[12:15], s101 offen offset:0 sc1
    v_exp_f32 v106, v106
    v_exp_f32 v107, v107
    v_cvt_pk_bf16_f32 v136, v104, v105
    v_exp_f32 v108, v108
    v_exp_f32 v109, v109
    v_cvt_pk_bf16_f32 v137, v106, v107
    v_mfma_f32_32x32x16_bf16 v[120:135], a[48:51], v[32:35], 0
    v_exp_f32 v110, v110
    v_exp_f32 v111, v111
    v_cvt_pk_bf16_f32 v138, v108, v109
    v_exp_f32 v112, v112
    v_exp_f32 v113, v113
    v_cvt_pk_bf16_f32 v139, v110, v111
    v_mfma_f32_32x32x16_bf16 v[120:135], a[52:55], v[36:39], v[120:135]
    v_exp_f32 v114, v114
    v_exp_f32 v115, v115
    v_cvt_pk_bf16_f32 v140, v112, v113
    v_exp_f32 v116, v116
    v_exp_f32 v117, v117
    v_cvt_pk_bf16_f32 v141, v114, v115
    v_mfma_f32_32x32x16_bf16 v[72:87], a[56:59], v[136:139], v[72:87]
    v_exp_f32 v118, v118
    v_exp_f32 v119, v119
    v_cvt_pk_bf16_f32 v142, v116, v117
    v_cvt_pk_bf16_f32 v143, v118, v119
    s_nop 0
    v_exp_f32 v120, v120
    v_exp_f32_e64 v121, v121
    v_mfma_f32_32x32x16_bf16 v[72:87], a[60:63], v[140:143], v[72:87]
    s_waitcnt vmcnt(35)
    v_exp_f32 v122, v122
    v_exp_f32_e64 v123, v123
    v_cvt_pk_bf16_f32 v136, v120, v121
    v_exp_f32 v124, v124
    v_exp_f32 v125, v125
    v_cvt_pk_bf16_f32 v137, v122, v123
    v_mfma_f32_32x32x16_bf16 v[104:119], a[64:67], v[8:11], 0
    s_waitcnt vmcnt(9)
    v_cmp_ne_u32 vcc, s39, v209
    s_cbranch_vccnz L_fw_5
L_fok_6:
    v_exp_f32 v126, v126
    v_exp_f32_e64 v127, v127
    v_cvt_pk_bf16_f32 v138, v124, v125
    v_exp_f32 v128, v128
    v_exp_f32 v129, v129
    v_cvt_pk_bf16_f32 v139, v126, v127
    v_mfma_f32_32x32x16_bf16 v[104:119], a[68:71], v[12:15], v[104:119]
    buffer_load_dwordx4 a[224:227], v252, s[12:15], s59 offen offset:0 sc1
    v_exp_f32 v130, v130
    v_exp_f32 v131, v131
    v_cvt_pk_bf16_f32 v140, v128, v129
    v_exp_f32 v132, v132
    v_exp_f32 v133, v133
    v_cvt_pk_bf16_f32 v141, v130, v131
    v_mfma_f32_32x32x16_bf16 v[88:103], a[56:59], v[136:139], v[88:103]
    buffer_load_dwordx4 a[228:231], v253, s[12:15], s59 offen offset:0 sc1
    v_exp_f32 v134, v134
    v_exp_f32 v135, v135
    v_cvt_pk_bf16_f32 v142, v132, v133
    v_cvt_pk_bf16_f32 v143, v134, v135
    v_exp_f32 v104, v104
    v_exp_f32 v105, v105
    v_mfma_f32_32x32x16_bf16 v[88:103], a[60:63], v[140:143], v[88:103]
    buffer_load_dwordx4 a[232:235], v252, s[12:15], s59 offen offset:2048 sc1
    v_exp_f32 v106, v106
    v_exp_f32 v107, v107
    v_cvt_pk_bf16_f32 v136, v104, v105
    v_exp_f32 v108, v108
    v_exp_f32 v109, v109
    v_cvt_pk_bf16_f32 v137, v106, v107
    v_mfma_f32_32x32x16_bf16 v[120:135], a[64:67], v[16:19], 0
    buffer_load_dwordx4 a[236:239], v253, s[12:15], s59 offen offset:2048 sc1
    v_exp_f32 v110, v110
    v_exp_f32 v111, v111
    v_cvt_pk_bf16_f32 v138, v108, v109
    v_exp_f32 v112, v112
    v_exp_f32 v113, v113
    v_cvt_pk_bf16_f32 v139, v110, v111
    v_mfma_f32_32x32x16_bf16 v[120:135], a[68:71], v[20:23], v[120:135]
    s_add_u32 s59, s59, 4096
    v_exp_f32 v114, v114
    v_exp_f32 v115, v115
    v_cvt_pk_bf16_f32 v140, v112, v113
    v_exp_f32 v116, v116
    v_exp_f32 v117, v117
    v_cvt_pk_bf16_f32 v141, v114, v115
    v_mfma_f32_32x32x16_bf16 v[40:55], a[72:75], v[136:139], v[40:55]
    buffer_load_dwordx4 a[240:243], v252, s[12:15], s59 offen offset:0 sc1
    v_exp_f32 v118, v118
    v_exp_f32 v119, v119
    v_cvt_pk_bf16_f32 v142, v116, v117
    v_cvt_pk_bf16_f32 v143, v118, v119
    v_exp_f32 v120, v120
    v_exp_f32 v121, v121
    v_mfma_f32_32x32x16_bf16 v[40:55], a[76:79], v[140:143], v[40:55]
    buffer_load_dwordx4 a[244:247], v253, s[12:15], s59 offen offset:0 sc1
    v_exp_f32 v122, v122
    v_exp_f32 v123, v123
    v_cvt_pk_bf16_f32 v136, v120, v121
    v_exp_f32 v124, v124
    v_exp_f32 v125, v125
    v_cvt_pk_bf16_f32 v137, v122, v123
    v_mfma_f32_32x32x16_bf16 v[104:119], a[64:67], v[24:27], 0
    buffer_load_dwordx4 a[248:251], v252, s[12:15], s59 offen offset:2048 sc1
    v_exp_f32 v126, v126
    v_exp_f32 v127, v127
    v_cvt_pk_bf16_f32 v138, v124, v125
    v_exp_f32 v128, v128
    v_exp_f32 v129, v129
    v_cvt_pk_bf16_f32 v139, v126, v127
    v_mfma_f32_32x32x16_bf16 v[104:119], a[68:71], v[28:31], v[104:119]
    buffer_load_dwordx4 a[252:255], v253, s[12:15], s59 offen offset:2048 sc1
    v_exp_f32 v130, v130
    v_exp_f32 v131, v131
    v_cvt_pk_bf16_f32 v140, v128, v129
    v_exp_f32 v132, v132
    v_exp_f32 v133, v133
    v_cvt_pk_bf16_f32 v141, v130, v131
    v_mfma_f32_32x32x16_bf16 v[56:71], a[72:75], v[136:139], v[56:71]
    s_add_u32 s59, s59, 4096
    v_exp_f32 v134, v134
    v_exp_f32 v135, v135
    v_cvt_pk_bf16_f32 v142, v132, v133
    v_cvt_pk_bf16_f32 v143, v134, v135
    v_exp_f32 v104, v104
    v_exp_f32 v105, v105
    v_mfma_f32_32x32x16_bf16 v[56:71], a[76:79], v[140:143], v[56:71]
    buffer_store_dwordx4 a[220:223], v1, s[12:15], s101 offen offset:1024 sc1
    v_exp_f32 v106, v106
    v_exp_f32 v107, v107
    v_cvt_pk_bf16_f32 v136, v104, v105
    v_exp_f32 v108, v108
    v_exp_f32 v109, v109
    v_cvt_pk_bf16_f32 v137, v106, v107
    v_mfma_f32_32x32x16_bf16 v[120:135], a[64:67], v[32:35], 0
    buffer_load_dwordx4 v[216:219], v252, s[12:15], s59 offen offset:0 sc1
    v_exp_f32 v110, v110
    v_exp_f32 v111, v111
    v_cvt_pk_bf16_f32 v138, v108, v109
    v_exp_f32 v112, v112
    v_exp_f32 v113, v113
    v_cvt_pk_bf16_f32 v139, v110, v111
    v_mfma_f32_32x32x16_bf16 v[120:135], a[68:71], v[36:39], v[120:135]
    v_exp_f32 v114, v114
    v_exp_f32 v115, v115
    v_cvt_pk_bf16_f32 v140, v112, v113
    v_exp_f32 v116, v116
    v_exp_f32 v117, v117
    v_cvt_pk_bf16_f32 v141, v114, v115
    v_mfma_f32_32x32x16_bf16 v[72:87], a[72:75], v[136:139], v[72:87]
    v_exp_f32 v118, v118
    v_exp_f32 v119, v119
    v_cvt_pk_bf16_f32 v142, v116, v117
    v_cvt_pk_bf16_f32 v143, v118, v119
    s_nop 0
    v_exp_f32 v120, v120
    v_exp_f32_e64 v121, v121
    v_mfma_f32_32x32x16_bf16 v[72:87], a[76:79], v[140:143], v[72:87]
    buffer_load_dwordx4 v[220:223], v253, s[12:15], s59 offen offset:0 sc1
    v_exp_f32 v122, v122
    v_exp_f32 v123, v123
    v_cvt_pk_bf16_f32 v136, v120, v121
    v_exp_f32 v124, v124
    v_exp_f32 v125, v125
    v_cvt_pk_bf16_f32 v137, v122, v123
    v_mfma_f32_32x32x16_bf16 v[104:119], a[80:83], v[8:11], 0
    buffer_load_dwordx4 v[224:227], v252, s[12:15], s59 offen offset:2048 sc1
    v_exp_f32 v126, v126
    v_exp_f32 v127, v127
    v_cvt_pk_bf16_f32 v138, v124, v125
    v_exp_f32 v128, v128
    v_exp_f32 v129, v129
    v_cvt_pk_bf16_f32 v139, v126, v127
    v_mfma_f32_32x32x16_bf16 v[104:119], a[84:87], v[12:15], v[104:119]
    buffer_load_dwordx4 v[228:231], v253, s[12:15], s59 offen offset:2048 sc1
    v_exp_f32 v130, v130
    v_exp_f32 v131, v131
    v_cvt_pk_bf16_f32 v140, v128, v129
    v_exp_f32 v132, v132
    v_exp_f32 v133, v133
    v_cvt_pk_bf16_f32 v141, v130, v131
    v_mfma_f32_32x32x16_bf16 v[88:103], a[72:75], v[136:139], v[88:103]
    s_add_u32 s59, s59, 4096
    v_exp_f32 v134, v134
    v_exp_f32 v135, v135
    v_cvt_pk_bf16_f32 v142, v132, v133
    v_cvt_pk_bf16_f32 v143, v134, v135
    v_exp_f32 v104, v104
    v_exp_f32 v105, v105
    v_mfma_f32_32x32x16_bf16 v[88:103], a[76:79], v[140:143], v[88:103]
    buffer_load_dwordx4 v[232:235], v252, s[12:15], s59 offen offset:0 sc1
    v_exp_f32 v106, v106
    v_exp_f32 v107, v107
    v_cvt_pk_bf16_f32 v136, v104, v105
    v_exp_f32 v108, v108
    v_exp_f32 v109, v109
    v_cvt_pk_bf16_f32 v137, v106, v107
    v_mfma_f32_32x32x16_bf16 v[120:135], a[80:83], v[16:19], 0
    buffer_load_dwordx4 v[236:239], v253, s[12:15], s59 offen offset:0 sc1
    v_exp_f32 v110, v110
    v_exp_f32 v111, v111
    v_cvt_pk_bf16_f32 v138, v108, v109
    v_exp_f32 v112, v112
    v_exp_f32 v113, v113
    v_cvt_pk_bf16_f32 v139, v110, v111
    v_mfma_f32_32x32x16_bf16 v[120:135], a[84:87], v[20:23], v[120:135]
    buffer_load_dwordx4 v[240:243], v252, s[12:15], s59 offen offset:2048 sc1
    v_exp_f32 v114, v114
    v_exp_f32 v115, v115
    v_cvt_pk_bf16_f32 v140, v112, v113
    v_exp_f32 v116, v116
    v_exp_f32 v117, v117
    v_cvt_pk_bf16_f32 v141, v114, v115
    v_mfma_f32_32x32x16_bf16 v[40:55], a[88:91], v[136:139], v[40:55]
    v_exp_f32 v118, v118
    v_exp_f32 v119, v119
    v_cvt_pk_bf16_f32 v142, v116, v117
    v_cvt_pk_bf16_f32 v143, v118, v119
    v_exp_f32 v120, v120
    v_exp_f32 v121, v121
    v_mfma_f32_32x32x16_bf16 v[40:55], a[92:95], v[140:143], v[40:55]
    buffer_load_dwordx4 v[244:247], v253, s[12:15], s59 offen offset:2048 sc1
    v_exp_f32 v122, v122
    v_exp_f32 v123, v123
    v_cvt_pk_bf16_f32 v136, v120, v121
    v_exp_f32 v124, v124
    v_exp_f32 v125, v125
    v_cvt_pk_bf16_f32 v137, v122, v123
    v_mfma_f32_32x32x16_bf16 v[104:119], a[80:83], v[24:27], 0
    s_add_u32 s59, s59, 4096
    v_exp_f32 v126, v126
    v_exp_f32 v127, v127
    v_cvt_pk_bf16_f32 v138, v124, v125
    v_exp_f32 v128, v128
    v_exp_f32 v129, v129
    v_cvt_pk_bf16_f32 v139, v126, v127
    v_mfma_f32_32x32x16_bf16 v[104:119], a[84:87], v[28:31], v[104:119]
    s_add_u32 m0, s54, 0
    v_exp_f32 v130, v130
    v_exp_f32_e64 v131, v131
    v_cvt_pk_bf16_f32 v140, v128, v129
    v_exp_f32 v132, v132
    v_exp_f32 v133, v133
    v_cvt_pk_bf16_f32 v141, v130, v131
    v_mfma_f32_32x32x16_bf16 v[56:71], a[88:91], v[136:139], v[56:71]
    buffer_load_dwordx4 v251, s[12:15], m0 offen offset:0 sc1 lds
    v_exp_f32 v134, v134
    v_exp_f32 v135, v135
    v_cvt_pk_bf16_f32 v142, v132, v133
    v_cvt_pk_bf16_f32 v143, v134, v135
    v_exp_f32 v104, v104
    v_exp_f32 v105, v105
    v_mfma_f32_32x32x16_bf16 v[56:71], a[92:95], v[140:143], v[56:71]
    buffer_store_dwordx4 a[220:223], v1, s[12:15], s101 offen offset:2048 sc1
    v_exp_f32 v106, v106
    v_exp_f32 v107, v107
    v_cvt_pk_bf16_f32 v136, v104, v105
    v_exp_f32 v108, v108
    v_exp_f32 v109, v109
    v_cvt_pk_bf16_f32 v137, v106, v107
    v_mfma_f32_32x32x16_bf16 v[120:135], a[80:83], v[32:35], 0
    buffer_load_dwordx4 v251, s[12:15], m0 offen offset:1024 sc1 lds
    v_exp_f32 v110, v110
    v_exp_f32 v111, v111
    v_cvt_pk_bf16_f32 v138, v108, v109
    v_exp_f32 v112, v112
    v_exp_f32 v113, v113
    v_cvt_pk_bf16_f32 v139, v110, v111
    v_mfma_f32_32x32x16_bf16 v[120:135], a[84:87], v[36:39], v[120:135]
    v_exp_f32 v114, v114
    v_exp_f32 v115, v115
    v_cvt_pk_bf16_f32 v140, v112, v113
    v_exp_f32 v116, v116
    v_exp_f32 v117, v117
    v_cvt_pk_bf16_f32 v141, v114, v115
    v_mfma_f32_32x32x16_bf16 v[72:87], a[88:91], v[136:139], v[72:87]
    v_exp_f32 v118, v118
    v_exp_f32 v119, v119
    v_cvt_pk_bf16_f32 v142, v116, v117
    v_cvt_pk_bf16_f32 v143, v118, v119
    s_nop 0
    v_exp_f32 v120, v120
    v_exp_f32_e64 v121, v121
    v_mfma_f32_32x32x16_bf16 v[72:87], a[92:95], v[140:143], v[72:87]
    buffer_load_dwordx4 v251, s[12:15], m0 offen offset:2048 sc1 lds
    v_exp_f32 v122, v122
    v_exp_f32 v123, v123
    v_cvt_pk_bf16_f32 v136, v120, v121
    v_exp_f32 v124, v124
    v_exp_f32 v125, v125
    v_cvt_pk_bf16_f32 v137, v122, v123
    v_mfma_f32_32x32x16_bf16 v[104:119], v[192:195], v[8:11], 0
    buffer_load_dwordx4 v251, s[12:15], m0 offen offset:3072 sc1 lds
    v_exp_f32 v126, v126
    v_exp_f32 v127, v127
    v_cvt_pk_bf16_f32 v138, v124, v125
    v_exp_f32 v128, v128
    v_exp_f32 v129, v129
    v_cvt_pk_bf16_f32 v139, v126, v127
    v_mfma_f32_32x32x16_bf16 v[104:119], v[196:199], v[12:15], v[104:119]
    s_add_u32 m0, s54, 4096
    v_exp_f32 v130, v130
    v_exp_f32 v131, v131
    v_cvt_pk_bf16_f32 v140, v128, v129
    v_exp_f32 v132, v132
    v_exp_f32 v133, v133
    v_cvt_pk_bf16_f32 v141, v130, v131
    v_mfma_f32_32x32x16_bf16 v[88:103], a[88:91], v[136:139], v[88:103]
    buffer_load_dwordx4 v251, s[12:15], m0 offen offset:0 sc1 lds
    v_exp_f32 v134, v134
    v_exp_f32 v135, v135
    v_cvt_pk_bf16_f32 v142, v132, v133
    v_cvt_pk_bf16_f32 v143, v134, v135
    v_exp_f32 v104, v104
    v_exp_f32 v105, v105
    v_mfma_f32_32x32x16_bf16 v[88:103], a[92:95], v[140:143], v[88:103]
    buffer_load_dwordx4 v251, s[12:15], m0 offen offset:1024 sc1 lds
    v_exp_f32 v106, v106
    v_exp_f32 v107, v107
    v_cvt_pk_bf16_f32 v136, v104, v105
    v_exp_f32 v108, v108
    v_exp_f32 v109, v109
    v_cvt_pk_bf16_f32 v137, v106, v107
    v_mfma_f32_32x32x16_bf16 v[120:135], v[192:195], v[16:19], 0
    buffer_load_dwordx4 v251, s[12:15], m0 offen offset:2048 sc1 lds
    v_exp_f32 v110, v110
    v_exp_f32 v111, v111
    v_cvt_pk_bf16_f32 v138, v108, v109
    v_exp_f32 v112, v112
    v_exp_f32 v113, v113
    v_cvt_pk_bf16_f32 v139, v110, v111
    v_mfma_f32_32x32x16_bf16 v[120:135], v[196:199], v[20:23], v[120:135]
    buffer_load_dwordx4 v251, s[12:15], m0 offen offset:3072 sc1 lds
    v_exp_f32 v114, v114
    v_exp_f32 v115, v115
    v_cvt_pk_bf16_f32 v140, v112, v113
    v_exp_f32 v116, v116
    v_exp_f32 v117, v117
    v_cvt_pk_bf16_f32 v141, v114, v115
    v_mfma_f32_32x32x16_bf16 v[40:55], v[200:203], v[136:139], v[40:55]
    s_add_u32 m0, s54, 8192
    v_exp_f32 v118, v118
    v_exp_f32 v119, v119
    v_cvt_pk_bf16_f32 v142, v116, v117
    v_cvt_pk_bf16_f32 v143, v118, v119
    v_exp_f32 v120, v120
    v_exp_f32 v121, v121
    v_mfma_f32_32x32x16_bf16 v[40:55], v[204:207], v[140:143], v[40:55]
    buffer_load_dwordx4 v251, s[12:15], m0 offen offset:0 sc1 lds
    v_exp_f32 v122, v122
    v_exp_f32 v123, v123
    v_cvt_pk_bf16_f32 v136, v120, v121
    v_exp_f32 v124, v124
    v_exp_f32 v125, v125
    v_cvt_pk_bf16_f32 v137, v122, v123
    v_mfma_f32_32x32x16_bf16 v[104:119], v[192:195], v[24:27], 0
    buffer_load_dwordx4 v251, s[12:15], m0 offen offset:1024 sc1 lds
    v_exp_f32 v126, v126
    v_exp_f32 v127, v127
    v_cvt_pk_bf16_f32 v138, v124, v125
    v_exp_f32 v128, v128
    v_exp_f32 v129, v129
    v_cvt_pk_bf16_f32 v139, v126, v127
    v_mfma_f32_32x32x16_bf16 v[104:119], v[196:199], v[28:31], v[104:119]
    buffer_load_dwordx4 v251, s[12:15], m0 offen offset:2048 sc1 lds
    v_exp_f32 v130, v130
    v_exp_f32 v131, v131
    v_cvt_pk_bf16_f32 v140, v128, v129
    v_exp_f32 v132, v132
    v_exp_f32 v133, v133
    v_cvt_pk_bf16_f32 v141, v130, v131
    v_mfma_f32_32x32x16_bf16 v[56:71], v[200:203], v[136:139], v[56:71]
    v_exp_f32 v134, v134
    v_exp_f32 v135, v135
    v_cvt_pk_bf16_f32 v142, v132, v133
    v_cvt_pk_bf16_f32 v143, v134, v135
    v_exp_f32 v104, v104
    v_exp_f32 v105, v105
    v_mfma_f32_32x32x16_bf16 v[56:71], v[204:207], v[140:143], v[56:71]
    buffer_store_dwordx4 a[220:223], v1, s[12:15], s101 offen offset:3072 sc1
    v_exp_f32 v106, v106
    v_exp_f32 v107, v107
    v_cvt_pk_bf16_f32 v136, v104, v105
    v_exp_f32 v108, v108
    v_exp_f32 v109, v109
    v_cvt_pk_bf16_f32 v137, v106, v107
    v_mfma_f32_32x32x16_bf16 v[120:135], v[192:195], v[32:35], 0
    buffer_load_dwordx4 v251, s[12:15], m0 offen offset:3072 sc1 lds
    v_exp_f32 v110, v110
    v_exp_f32 v111, v111
    v_cvt_pk_bf16_f32 v138, v108, v109
    v_exp_f32 v112, v112
    v_exp_f32 v113, v113
    v_cvt_pk_bf16_f32 v139, v110, v111
    v_mfma_f32_32x32x16_bf16 v[120:135], v[196:199], v[36:39], v[120:135]
    s_add_u32 m0, s54, 12288
    v_exp_f32 v114, v114
    v_exp_f32 v115, v115
    v_cvt_pk_bf16_f32 v140, v112, v113
    v_exp_f32 v116, v116
    v_exp_f32 v117, v117
    v_cvt_pk_bf16_f32 v141, v114, v115
    v_mfma_f32_32x32x16_bf16 v[72:87], v[200:203], v[136:139], v[72:87]
    v_exp_f32 v118, v118
    v_exp_f32 v119, v119
    v_cvt_pk_bf16_f32 v142, v116, v117
    v_cvt_pk_bf16_f32 v143, v118, v119
    v_exp_f32 v120, v120
    v_exp_f32 v121, v121
    v_mfma_f32_32x32x16_bf16 v[72:87], v[204:207], v[140:143], v[72:87]
    buffer_load_dwordx4 v251, s[12:15], m0 offen offset:0 sc1 lds
    v_exp_f32 v122, v122
    v_exp_f32 v123, v123
    v_cvt_pk_bf16_f32 v136, v120, v121
    v_exp_f32 v124, v124
    v_exp_f32 v125, v125
    v_cvt_pk_bf16_f32 v137, v122, v123
    v_mfma_f32_32x32x16_bf16 v[104:119], v[144:147], v[8:11], 0
    buffer_load_dwordx4 v251, s[12:15], m0 offen offset:1024 sc1 lds
    v_exp_f32 v126, v126
    v_exp_f32 v127, v127
    v_cvt_pk_bf16_f32 v138, v124, v125
    v_exp_f32 v128, v128
    v_exp_f32 v129, v129
    v_cvt_pk_bf16_f32 v139, v126, v127
    v_mfma_f32_32x32x16_bf16 v[104:119], v[148:151], v[12:15], v[104:119]
    v_exp_f32 v130, v130
    v_exp_f32 v131, v131
    v_cvt_pk_bf16_f32 v140, v128, v129
    v_exp_f32 v132, v132
    v_exp_f32 v133, v133
    v_cvt_pk_bf16_f32 v141, v130, v131
    v_mfma_f32_32x32x16_bf16 v[88:103], v[200:203], v[136:139], v[88:103]
    v_exp_f32 v134, v134
    v_exp_f32 v135, v135
    v_cvt_pk_bf16_f32 v142, v132, v133
    v_cvt_pk_bf16_f32 v143, v134, v135
    s_nop 0
    v_exp_f32 v104, v104
    v_exp_f32_e64 v105, v105
    v_mfma_f32_32x32x16_bf16 v[88:103], v[204:207], v[140:143], v[88:103]
    buffer_load_dwordx4 v251, s[12:15], m0 offen offset:2048 sc1 lds
    v_exp_f32 v106, v106
    v_exp_f32 v107, v107
    v_cvt_pk_bf16_f32 v136, v104, v105
    v_exp_f32 v108, v108
    v_exp_f32 v109, v109
    v_cvt_pk_bf16_f32 v137, v106, v107
    v_mfma_f32_32x32x16_bf16 v[120:135], v[144:147], v[16:19], 0
    buffer_load_dwordx4 v251, s[12:15], m0 offen offset:3072 sc1 lds
    v_exp_f32 v110, v110
    v_exp_f32 v111, v111
    v_cvt_pk_bf16_f32 v138, v108, v109
    v_exp_f32 v112, v112
    v_exp_f32 v113, v113
    v_cvt_pk_bf16_f32 v139, v110, v111
    v_mfma_f32_32x32x16_bf16 v[120:135], v[148:151], v[20:23], v[120:135]
    s_add_u32 m0, s54, 16384
    v_exp_f32 v114, v114
    v_exp_f32 v115, v115
    v_cvt_pk_bf16_f32 v140, v112, v113
    v_exp_f32 v116, v116
    v_exp_f32 v117, v117
    v_cvt_pk_bf16_f32 v141, v114, v115
    v_mfma_f32_32x32x16_bf16 v[40:55], v[152:155], v[136:139], v[40:55]
    buffer_load_dwordx4 v251, s[12:15], m0 offen offset:0 sc1 lds
    v_exp_f32 v118, v118
    v_exp_f32 v119, v119
    v_cvt_pk_bf16_f32 v142, v116, v117
    v_cvt_pk_bf16_f32 v143, v118, v119
    v_exp_f32 v120, v120
    v_exp_f32 v121, v121
    v_mfma_f32_32x32x16_bf16 v[40:55], v[156:159], v[140:143], v[40:55]
    buffer_load_dwordx4 v251, s[12:15], m0 offen offset:1024 sc1 lds
    v_exp_f32 v122, v122
    v_exp_f32 v123, v123
    v_cvt_pk_bf16_f32 v136, v120, v121
    v_exp_f32 v124, v124
    v_exp_f32 v125, v125
    v_cvt_pk_bf16_f32 v137, v122, v123
    v_mfma_f32_32x32x16_bf16 v[104:119], v[144:147], v[24:27], 0
    buffer_load_dwordx4 v251, s[12:15], m0 offen offset:2048 sc1 lds
    v_exp_f32 v126, v126
    v_exp_f32 v127, v127
    v_cvt_pk_bf16_f32 v138, v124, v125
    v_exp_f32 v128, v128
    v_exp_f32 v129, v129
    v_cvt_pk_bf16_f32 v139, v126, v127
    v_mfma_f32_32x32x16_bf16 v[104:119], v[148:151], v[28:31], v[104:119]
    buffer_load_dwordx4 v251, s[12:15], m0 offen offset:3072 sc1 lds
    v_exp_f32 v130, v130
    v_exp_f32 v131, v131
    v_cvt_pk_bf16_f32 v140, v128, v129
    v_exp_f32 v132, v132
    v_exp_f32 v133, v133
    v_cvt_pk_bf16_f32 v141, v130, v131
    v_mfma_f32_32x32x16_bf16 v[56:71], v[152:155], v[136:139], v[56:71]
    s_add_u32 m0, s54, 20480
    v_exp_f32 v134, v134
    v_exp_f32 v135, v135
    v_cvt_pk_bf16_f32 v142, v132, v133
    v_cvt_pk_bf16_f32 v143, v134, v135
    v_exp_f32 v104, v104
    v_exp_f32 v105, v105
    v_mfma_f32_32x32x16_bf16 v[56:71], v[156:159], v[140:143], v[56:71]
    buffer_store_dwordx4 a[220:223], v1, s[12:15], s58 offen offset:0 sc1
    v_exp_f32 v106, v106
    v_exp_f32 v107, v107
    v_cvt_pk_bf16_f32 v136, v104, v105
    v_exp_f32 v108, v108
    v_exp_f32 v109, v109
    v_cvt_pk_bf16_f32 v137, v106, v107
    v_mfma_f32_32x32x16_bf16 v[120:135], v[144:147], v[32:35], 0
    buffer_load_dwordx4 v251, s[12:15], m0 offen offset:0 sc1 lds
    v_exp_f32 v110, v110
    v_exp_f32 v111, v111
    v_cvt_pk_bf16_f32 v138, v108, v109
    v_exp_f32 v112, v112
    v_exp_f32 v113, v113
    v_cvt_pk_bf16_f32 v139, v110, v111
    v_mfma_f32_32x32x16_bf16 v[120:135], v[148:151], v[36:39], v[120:135]
    v_exp_f32 v114, v114
    v_exp_f32 v115, v115
    v_cvt_pk_bf16_f32 v140, v112, v113
    v_exp_f32 v116, v116
    v_exp_f32 v117, v117
    v_cvt_pk_bf16_f32 v141, v114, v115
    v_mfma_f32_32x32x16_bf16 v[72:87], v[152:155], v[136:139], v[72:87]
    v_exp_f32 v118, v118
    v_exp_f32 v119, v119
    v_cvt_pk_bf16_f32 v142, v116, v117
    v_cvt_pk_bf16_f32 v143, v118, v119
    s_nop 0
    v_exp_f32 v120, v120
    v_exp_f32_e64 v121, v121
    v_mfma_f32_32x32x16_bf16 v[72:87], v[156:159], v[140:143], v[72:87]
    buffer_load_dwordx4 v251, s[12:15], m0 offen offset:1024 sc1 lds
    v_exp_f32 v122, v122
    v_exp_f32 v123, v123
    v_cvt_pk_bf16_f32 v136, v120, v121
    v_exp_f32 v124, v124
    v_exp_f32 v125, v125
    v_cvt_pk_bf16_f32 v137, v122, v123
    v_mfma_f32_32x32x16_bf16 v[104:119], v[160:163], v[8:11], 0
    buffer_load_dwordx4 v251, s[12:15], m0 offen offset:2048 sc1 lds
    v_exp_f32 v126, v126
    v_exp_f32 v127, v127
    v_cvt_pk_bf16_f32 v138, v124, v125
    v_exp_f32 v128, v128
    v_exp_f32 v129, v129
    v_cvt_pk_bf16_f32 v139, v126, v127
    v_mfma_f32_32x32x16_bf16 v[104:119], v[164:167], v[12:15], v[104:119]
    buffer_load_dwordx4 v251, s[12:15], m0 offen offset:3072 sc1 lds
    v_exp_f32 v130, v130
    v_exp_f32 v131, v131
    v_cvt_pk_bf16_f32 v140, v128, v129
    v_exp_f32 v132, v132
    v_exp_f32 v133, v133
    v_cvt_pk_bf16_f32 v141, v130, v131
    v_mfma_f32_32x32x16_bf16 v[88:103], v[152:155], v[136:139], v[88:103]
    s_add_u32 m0, s54, 24576
    v_exp_f32 v134, v134
    v_exp_f32 v135, v135
    v_cvt_pk_bf16_f32 v142, v132, v133
    v_cvt_pk_bf16_f32 v143, v134, v135
    v_exp_f32 v104, v104
    v_exp_f32 v105, v105
    v_mfma_f32_32x32x16_bf16 v[88:103], v[156:159], v[140:143], v[88:103]
    buffer_load_dwordx4 v251, s[12:15], m0 offen offset:0 sc1 lds
    v_exp_f32 v106, v106
    v_exp_f32 v107, v107
    v_cvt_pk_bf16_f32 v136, v104, v105
    v_exp_f32 v108, v108
    v_exp_f32 v109, v109
    v_cvt_pk_bf16_f32 v137, v106, v107
    v_mfma_f32_32x32x16_bf16 v[120:135], v[160:163], v[16:19], 0
    buffer_load_dwordx4 v251, s[12:15], m0 offen offset:1024 sc1 lds
    v_exp_f32 v110, v110
    v_exp_f32 v111, v111
    v_cvt_pk_bf16_f32 v138, v108, v109
    v_exp_f32 v112, v112
    v_exp_f32 v113, v113
    v_cvt_pk_bf16_f32 v139, v110, v111
    v_mfma_f32_32x32x16_bf16 v[120:135], v[164:167], v[20:23], v[120:135]
    v_exp_f32 v114, v114
    v_exp_f32 v115, v115
    v_cvt_pk_bf16_f32 v140, v112, v113
    v_exp_f32 v116, v116
    v_exp_f32 v117, v117
    v_cvt_pk_bf16_f32 v141, v114, v115
    v_mfma_f32_32x32x16_bf16 v[40:55], v[168:171], v[136:139], v[40:55]
    v_exp_f32 v118, v118
    v_exp_f32 v119, v119
    v_cvt_pk_bf16_f32 v142, v116, v117
    v_cvt_pk_bf16_f32 v143, v118, v119
    s_nop 0
    v_exp_f32 v120, v120
    v_exp_f32_e64 v121, v121
    v_mfma_f32_32x32x16_bf16 v[40:55], v[172:175], v[140:143], v[40:55]
    buffer_load_dwordx4 v251, s[12:15], m0 offen offset:2048 sc1 lds
    v_exp_f32 v122, v122
    v_exp_f32 v123, v123
    v_cvt_pk_bf16_f32 v136, v120, v121
    v_exp_f32 v124, v124
    v_exp_f32 v125, v125
    v_cvt_pk_bf16_f32 v137, v122, v123
    v_mfma_f32_32x32x16_bf16 v[104:119], v[160:163], v[24:27], 0
    buffer_load_dwordx4 v251, s[12:15], m0 offen offset:3072 sc1 lds
    v_exp_f32 v126, v126
    v_exp_f32 v127, v127
    v_cvt_pk_bf16_f32 v138, v124, v125
    v_exp_f32 v128, v128
    v_exp_f32 v129, v129
    v_cvt_pk_bf16_f32 v139, v126, v127
    v_mfma_f32_32x32x16_bf16 v[104:119], v[164:167], v[28:31], v[104:119]
    buffer_load_dwordx4 a[0:3], v252, s[12:15], s33 offen offset:0 sc1
    v_exp_f32 v130, v130
    v_exp_f32 v131, v131
    v_cvt_pk_bf16_f32 v140, v128, v129
    v_exp_f32 v132, v132
    v_exp_f32 v133, v133
    v_cvt_pk_bf16_f32 v141, v130, v131
    v_mfma_f32_32x32x16_bf16 v[56:71], v[168:171], v[136:139], v[56:71]
    v_exp_f32 v134, v134
    v_exp_f32 v135, v135
    v_cvt_pk_bf16_f32 v142, v132, v133
    v_cvt_pk_bf16_f32 v143, v134, v135
    v_exp_f32 v104, v104
    v_exp_f32 v105, v105
    v_mfma_f32_32x32x16_bf16 v[56:71], v[172:175], v[140:143], v[56:71]
    buffer_store_dwordx4 a[220:223], v1, s[12:15], s58 offen offset:1024 sc1
    v_exp_f32 v106, v106
    v_exp_f32 v107, v107
    v_cvt_pk_bf16_f32 v136, v104, v105
    v_exp_f32 v108, v108
    v_exp_f32 v109, v109
    v_cvt_pk_bf16_f32 v137, v106, v107
    v_mfma_f32_32x32x16_bf16 v[120:135], v[160:163], v[32:35], 0
    buffer_load_dwordx4 a[4:7], v253, s[12:15], s33 offen offset:0 sc1
    v_exp_f32 v110, v110
    v_exp_f32 v111, v111
    v_cvt_pk_bf16_f32 v138, v108, v109
    v_exp_f32 v112, v112
    v_exp_f32 v113, v113
    v_cvt_pk_bf16_f32 v139, v110, v111
    v_mfma_f32_32x32x16_bf16 v[120:135], v[164:167], v[36:39], v[120:135]
    v_exp_f32 v114, v114
    v_exp_f32 v115, v115
    v_cvt_pk_bf16_f32 v140, v112, v113
    v_exp_f32 v116, v116
    v_exp_f32 v117, v117
    v_cvt_pk_bf16_f32 v141, v114, v115
    v_mfma_f32_32x32x16_bf16 v[72:87], v[168:171], v[136:139], v[72:87]
    v_exp_f32 v118, v118
    v_exp_f32 v119, v119
    v_cvt_pk_bf16_f32 v142, v116, v117
    v_cvt_pk_bf16_f32 v143, v118, v119
    s_nop 0
    v_exp_f32 v120, v120
    v_exp_f32_e64 v121, v121
    v_mfma_f32_32x32x16_bf16 v[72:87], v[172:175], v[140:143], v[72:87]
    buffer_load_dwordx4 a[8:11], v252, s[12:15], s33 offen offset:2048 sc1
    v_exp_f32 v122, v122
    v_exp_f32 v123, v123
    v_cvt_pk_bf16_f32 v136, v120, v121
    v_exp_f32 v124, v124
    v_exp_f32 v125, v125
    v_cvt_pk_bf16_f32 v137, v122, v123
    v_mfma_f32_32x32x16_bf16 v[104:119], v[176:179], v[8:11], 0
    buffer_load_dwordx4 a[12:15], v253, s[12:15], s33 offen offset:2048 sc1
    v_exp_f32 v126, v126
    v_exp_f32 v127, v127
    v_cvt_pk_bf16_f32 v138, v124, v125
    v_exp_f32 v128, v128
    v_exp_f32 v129, v129
    v_cvt_pk_bf16_f32 v139, v126, v127
    v_mfma_f32_32x32x16_bf16 v[104:119], v[180:183], v[12:15], v[104:119]
    s_add_u32 s33, s33, 4096
    v_exp_f32 v130, v130
    v_exp_f32 v131, v131
    v_cvt_pk_bf16_f32 v140, v128, v129
    v_exp_f32 v132, v132
    v_exp_f32 v133, v133
    v_cvt_pk_bf16_f32 v141, v130, v131
    v_mfma_f32_32x32x16_bf16 v[88:103], v[168:171], v[136:139], v[88:103]
    buffer_load_dwordx4 a[16:19], v252, s[12:15], s33 offen offset:0 sc1
    v_exp_f32 v134, v134
    v_exp_f32 v135, v135
    v_cvt_pk_bf16_f32 v142, v132, v133
    v_cvt_pk_bf16_f32 v143, v134, v135
    v_exp_f32 v104, v104
    v_exp_f32 v105, v105
    v_mfma_f32_32x32x16_bf16 v[88:103], v[172:175], v[140:143], v[88:103]
    buffer_load_dwordx4 a[20:23], v253, s[12:15], s33 offen offset:0 sc1
    v_exp_f32 v106, v106
    v_exp_f32 v107, v107
    v_cvt_pk_bf16_f32 v136, v104, v105
    v_exp_f32 v108, v108
    v_exp_f32 v109, v109
    v_cvt_pk_bf16_f32 v137, v106, v107
    v_mfma_f32_32x32x16_bf16 v[120:135], v[176:179], v[16:19], 0
    buffer_load_dwordx4 a[24:27], v252, s[12:15], s33 offen offset:2048 sc1
    v_exp_f32 v110, v110
    v_exp_f32 v111, v111
    v_cvt_pk_bf16_f32 v138, v108, v109
    v_exp_f32 v112, v112
    v_exp_f32 v113, v113
    v_cvt_pk_bf16_f32 v139, v110, v111
    v_mfma_f32_32x32x16_bf16 v[120:135], v[180:183], v[20:23], v[120:135]
    buffer_load_dwordx4 a[28:31], v253, s[12:15], s33 offen offset:2048 sc1
    v_exp_f32 v114, v114
    v_exp_f32 v115, v115
    v_cvt_pk_bf16_f32 v140, v112, v113
    v_exp_f32 v116, v116
    v_exp_f32 v117, v117
    v_cvt_pk_bf16_f32 v141, v114, v115
    v_mfma_f32_32x32x16_bf16 v[40:55], v[184:187], v[136:139], v[40:55]
    s_add_u32 s33, s33, 4096
    v_exp_f32 v118, v118
    v_exp_f32 v119, v119
    v_cvt_pk_bf16_f32 v142, v116, v117
    v_cvt_pk_bf16_f32 v143, v118, v119
    v_exp_f32 v120, v120
    v_exp_f32 v121, v121
    v_mfma_f32_32x32x16_bf16 v[40:55], v[188:191], v[140:143], v[40:55]
    buffer_load_dwordx4 a[32:35], v252, s[12:15], s33 offen offset:0 sc1
    v_exp_f32 v122, v122
    v_exp_f32 v123, v123
    v_cvt_pk_bf16_f32 v136, v120, v121
    v_exp_f32 v124, v124
    v_exp_f32 v125, v125
    v_cvt_pk_bf16_f32 v137, v122, v123
    v_mfma_f32_32x32x16_bf16 v[104:119], v[176:179], v[24:27], 0
    buffer_load_dwordx4 a[36:39], v253, s[12:15], s33 offen offset:0 sc1
    v_exp_f32 v126, v126
    v_exp_f32 v127, v127
    v_cvt_pk_bf16_f32 v138, v124, v125
    v_exp_f32 v128, v128
    v_exp_f32 v129, v129
    v_cvt_pk_bf16_f32 v139, v126, v127
    v_mfma_f32_32x32x16_bf16 v[104:119], v[180:183], v[28:31], v[104:119]
    v_exp_f32 v130, v130
    v_exp_f32 v131, v131
    v_cvt_pk_bf16_f32 v140, v128, v129
    v_exp_f32 v132, v132
    v_exp_f32 v133, v133
    v_cvt_pk_bf16_f32 v141, v130, v131
    v_mfma_f32_32x32x16_bf16 v[56:71], v[184:187], v[136:139], v[56:71]
    v_exp_f32 v134, v134
    v_exp_f32 v135, v135
    v_cvt_pk_bf16_f32 v142, v132, v133
    v_cvt_pk_bf16_f32 v143, v134, v135
    s_nop 0
    v_exp_f32 v104, v104
    v_exp_f32_e64 v105, v105
    v_mfma_f32_32x32x16_bf16 v[56:71], v[188:191], v[140:143], v[56:71]
    s_waitcnt vmcnt(63)
    v_exp_f32 v106, v106
    v_exp_f32_e64 v107, v107
    v_cvt_pk_bf16_f32 v136, v104, v105
    v_exp_f32 v108, v108
    v_exp_f32 v109, v109
    v_cvt_pk_bf16_f32 v137, v106, v107
    v_mfma_f32_32x32x16_bf16 v[120:135], a[192:195], v[8:11], 0
    buffer_store_dwordx4 a[220:223], v1, s[12:15], s58 offen offset:2048 sc1
    v_exp_f32 v110, v110
    v_exp_f32 v111, v111
    v_cvt_pk_bf16_f32 v138, v108, v109
    v_exp_f32 v112, v112
    v_exp_f32 v113, v113
    v_cvt_pk_bf16_f32 v139, v110, v111
    v_mfma_f32_32x32x16_bf16 v[120:135], a[196:199], v[12:15], v[120:135]
    buffer_load_dwordx4 a[40:43], v252, s[12:15], s33 offen offset:2048 sc1
    v_exp_f32 v114, v114
    v_exp_f32 v115, v115
    v_cvt_pk_bf16_f32 v140, v112, v113
    v_exp_f32 v116, v116
    v_exp_f32 v117, v117
    v_cvt_pk_bf16_f32 v141, v114, v115
    v_mfma_f32_32x32x16_bf16 v[72:87], v[184:187], v[136:139], v[72:87]
    buffer_load_dwordx4 a[44:47], v253, s[12:15], s33 offen offset:2048 sc1
    v_exp_f32 v118, v118
    v_exp_f32 v119, v119
    v_cvt_pk_bf16_f32 v142, v116, v117
    v_cvt_pk_bf16_f32 v143, v118, v119
    v_exp_f32 v120, v120
    v_exp_f32 v121, v121
    v_mfma_f32_32x32x16_bf16 v[72:87], v[188:191], v[140:143], v[72:87]
    s_add_u32 s33, s33, 4096
    v_exp_f32 v122, v122
    v_exp_f32 v123, v123
    v_cvt_pk_bf16_f32 v136, v120, v121
    v_exp_f32 v124, v124
    v_exp_f32 v125, v125
    v_cvt_pk_bf16_f32 v137, v122, v123
    v_mfma_f32_32x32x16_bf16 v[104:119], a[192:195], v[16:19], 0
    buffer_load_dwordx4 a[48:51], v252, s[12:15], s33 offen offset:0 sc1
    v_exp_f32 v126, v126
    v_exp_f32 v127, v127
    v_cvt_pk_bf16_f32 v138, v124, v125
    v_exp_f32 v128, v128
    v_exp_f32 v129, v129
    v_cvt_pk_bf16_f32 v139, v126, v127
    v_mfma_f32_32x32x16_bf16 v[104:119], a[196:199], v[20:23], v[104:119]
    buffer_load_dwordx4 a[52:55], v253, s[12:15], s33 offen offset:0 sc1
    v_exp_f32 v130, v130
    v_exp_f32 v131, v131
    v_cvt_pk_bf16_f32 v140, v128, v129
    v_exp_f32 v132, v132
    v_exp_f32 v133, v133
    v_cvt_pk_bf16_f32 v141, v130, v131
    v_mfma_f32_32x32x16_bf16 v[40:55], a[200:203], v[136:139], v[40:55]
    v_exp_f32 v134, v134
    v_exp_f32 v135, v135
    v_cvt_pk_bf16_f32 v142, v132, v133
    v_cvt_pk_bf16_f32 v143, v134, v135
    v_exp_f32 v104, v104
    v_exp_f32 v105, v105
    v_mfma_f32_32x32x16_bf16 v[40:55], a[204:207], v[140:143], v[40:55]
    buffer_load_dwordx4 a[56:59], v252, s[12:15], s33 offen offset:2048 sc1
    v_exp_f32 v106, v106
    v_exp_f32 v107, v107
    v_cvt_pk_bf16_f32 v136, v104, v105
    v_exp_f32 v108, v108
    v_exp_f32 v109, v109
    v_cvt_pk_bf16_f32 v137, v106, v107
    v_mfma_f32_32x32x16_bf16 v[120:135], a[192:195], v[24:27], 0
    buffer_load_dwordx4 a[60:63], v253, s[12:15], s33 offen offset:2048 sc1
    v_exp_f32 v110, v110
    v_exp_f32 v111, v111
    v_cvt_pk_bf16_f32 v138, v108, v109
    v_exp_f32 v112, v112
    v_exp_f32 v113, v113
    v_cvt_pk_bf16_f32 v139, v110, v111
    v_mfma_f32_32x32x16_bf16 v[120:135], a[196:199], v[28:31], v[120:135]
    s_add_u32 s33, s33, 4096
    v_exp_f32 v114, v114
    v_exp_f32 v115, v115
    v_cvt_pk_bf16_f32 v140, v112, v113
    v_exp_f32 v116, v116
    v_exp_f32 v117, v117
    v_cvt_pk_bf16_f32 v141, v114, v115
    v_mfma_f32_32x32x16_bf16 v[56:71], a[200:203], v[136:139], v[56:71]
    buffer_load_dwordx4 v[144:147], v254, s[4:7], 0 offen offset:0
    v_exp_f32 v118, v118
    v_exp_f32 v119, v119
    v_cvt_pk_bf16_f32 v142, v116, v117
    v_cvt_pk_bf16_f32 v143, v118, v119
    v_exp_f32 v120, v120
    v_exp_f32 v121, v121
    v_mfma_f32_32x32x16_bf16 v[56:71], a[204:207], v[140:143], v[56:71]
    s_waitcnt vmcnt(63)
    v_exp_f32 v122, v122
    v_exp_f32_e64 v123, v123
    v_cvt_pk_bf16_f32 v136, v120, v121
    v_exp_f32 v124, v124
    v_exp_f32 v125, v125
    v_cvt_pk_bf16_f32 v137, v122, v123
    v_mfma_f32_32x32x16_bf16 v[104:119], a[176:179], v[8:11], 0
    buffer_load_dwordx4 v[148:151], v254, s[4:7], 0 offen offset:16
    v_exp_f32 v126, v126
    v_exp_f32 v127, v127
    v_cvt_pk_bf16_f32 v138, v124, v125
    v_exp_f32 v128, v128
    v_exp_f32 v129, v129
    v_cvt_pk_bf16_f32 v139, v126, v127
    v_mfma_f32_32x32x16_bf16 v[104:119], a[180:183], v[12:15], v[104:119]
    v_exp_f32 v130, v130
    v_exp_f32 v131, v131
    v_cvt_pk_bf16_f32 v140, v128, v129
    v_exp_f32 v132, v132
    v_exp_f32 v133, v133
    v_cvt_pk_bf16_f32 v141, v130, v131
    v_mfma_f32_32x32x16_bf16 v[72:87], a[200:203], v[136:139], v[72:87]
    v_exp_f32 v134, v134
    v_exp_f32 v135, v135
    v_cvt_pk_bf16_f32 v142, v132, v133
    v_cvt_pk_bf16_f32 v143, v134, v135
    s_nop 0
    v_exp_f32 v104, v104
    v_exp_f32_e64 v105, v105
    v_mfma_f32_32x32x16_bf16 v[72:87], a[204:207], v[140:143], v[72:87]
    s_waitcnt vmcnt(8)
    v_exp_f32 v106, v106
    v_exp_f32_e64 v107, v107
    v_cvt_pk_bf16_f32 v136, v104, v105
    v_exp_f32 v108, v108
    v_exp_f32 v109, v109
    v_cvt_pk_bf16_f32 v137, v106, v107
    v_mfma_f32_32x32x16_bf16 v[120:135], a[176:179], v[16:19], 0
    v_exp_f32 v110, v110
    v_exp_f32 v111, v111
    v_cvt_pk_bf16_f32 v138, v108, v109
    v_exp_f32 v112, v112
    v_exp_f32 v113, v113
    v_cvt_pk_bf16_f32 v139, v110, v111
    v_mfma_f32_32x32x16_bf16 v[120:135], a[180:183], v[20:23], v[120:135]
    v_exp_f32 v114, v114
    v_exp_f32 v115, v115
    v_cvt_pk_bf16_f32 v140, v112, v113
    v_exp_f32 v116, v116
    v_exp_f32 v117, v117
    v_cvt_pk_bf16_f32 v141, v114, v115
    v_mfma_f32_32x32x16_bf16 v[40:55], a[184:187], v[136:139], v[40:55]
    v_exp_f32 v118, v118
    v_exp_f32 v119, v119
    v_cvt_pk_bf16_f32 v142, v116, v117
    v_cvt_pk_bf16_f32 v143, v118, v119
    s_nop 0
    v_exp_f32 v120, v120
    v_exp_f32_e64 v121, v121
    v_mfma_f32_32x32x16_bf16 v[40:55], a[188:191], v[140:143], v[40:55]
    v_exp_f32 v122, v122
    v_exp_f32 v123, v123
    v_cvt_pk_bf16_f32 v136, v120, v121
    v_exp_f32 v124, v124
    v_exp_f32 v125, v125
    v_cvt_pk_bf16_f32 v137, v122, v123
    v_mfma_f32_32x32x16_bf16 v[104:119], a[176:179], v[24:27], 0
    v_exp_f32 v126, v126
    v_exp_f32 v127, v127
    v_cvt_pk_bf16_f32 v138, v124, v125
    v_exp_f32 v128, v128
    v_exp_f32 v129, v129
    v_cvt_pk_bf16_f32 v139, v126, v127
    v_mfma_f32_32x32x16_bf16 v[104:119], a[180:183], v[28:31], v[104:119]
    ds_write_b128 v4, v[40:43] offset:0
    v_exp_f32 v130, v130
    v_exp_f32 v131, v131
    v_cvt_pk_bf16_f32 v140, v128, v129
    v_exp_f32 v132, v132
    v_exp_f32 v133, v133
    v_cvt_pk_bf16_f32 v141, v130, v131
    v_mfma_f32_32x32x16_bf16 v[56:71], a[184:187], v[136:139], v[56:71]
    ds_write_b128 v4, v[44:47] offset:1024
    v_exp_f32 v134, v134
    v_exp_f32 v135, v135
    v_cvt_pk_bf16_f32 v142, v132, v133
    v_cvt_pk_bf16_f32 v143, v134, v135
    v_exp_f32 v104, v104
    v_exp_f32 v105, v105
    v_mfma_f32_32x32x16_bf16 v[56:71], a[188:191], v[140:143], v[56:71]
    ds_write_b128 v4, v[48:51] offset:2048
    v_exp_f32 v106, v106
    v_exp_f32 v107, v107
    v_cvt_pk_bf16_f32 v136, v104, v105
    v_exp_f32 v108, v108
    v_exp_f32 v109, v109
    v_cvt_pk_bf16_f32 v137, v106, v107
    v_mfma_f32_32x32x16_bf16 v[120:135], v[176:179], v[32:35], 0
    ds_write_b128 v4, v[52:55] offset:3072
    v_exp_f32 v110, v110
    v_exp_f32 v111, v111
    v_cvt_pk_bf16_f32 v138, v108, v109
    v_exp_f32 v112, v112
    v_exp_f32 v113, v113
    v_cvt_pk_bf16_f32 v139, v110, v111
    v_mfma_f32_32x32x16_bf16 v[120:135], v[180:183], v[36:39], v[120:135]
    ds_write_b128 v5, v[56:59] offset:0
    v_exp_f32 v114, v114
    v_exp_f32 v115, v115
    v_cvt_pk_bf16_f32 v140, v112, v113
    v_exp_f32 v116, v116
    v_exp_f32 v117, v117
    v_cvt_pk_bf16_f32 v141, v114, v115
    v_mfma_f32_32x32x16_bf16 v[72:87], a[184:187], v[136:139], v[72:87]
    ds_write_b128 v5, v[60:63] offset:1024
    v_exp_f32 v118, v118
    v_exp_f32 v119, v119
    v_cvt_pk_bf16_f32 v142, v116, v117
    v_cvt_pk_bf16_f32 v143, v118, v119
    v_exp_f32 v120, v120
    v_exp_f32 v121, v121
    v_mfma_f32_32x32x16_bf16 v[72:87], a[188:191], v[140:143], v[72:87]
    ds_write_b128 v5, v[64:67] offset:2048
    v_exp_f32 v122, v122
    v_exp_f32 v123, v123
    v_cvt_pk_bf16_f32 v136, v120, v121
    v_exp_f32 v124, v124
    v_exp_f32 v125, v125
    v_cvt_pk_bf16_f32 v137, v122, v123
    v_mfma_f32_32x32x16_bf16 v[104:119], a[192:195], v[32:35], 0
    ds_write_b128 v5, v[68:71] offset:3072
    v_exp_f32 v126, v126
    v_exp_f32 v127, v127
    v_cvt_pk_bf16_f32 v138, v124, v125
    v_exp_f32 v128, v128
    v_exp_f32 v129, v129
    v_cvt_pk_bf16_f32 v139, v126, v127
    v_mfma_f32_32x32x16_bf16 v[104:119], a[196:199], v[36:39], v[104:119]
    ds_write_b128 v6, v[72:75] offset:0
    v_exp_f32 v130, v130
    v_exp_f32 v131, v131
    v_cvt_pk_bf16_f32 v140, v128, v129
    v_exp_f32 v132, v132
    v_exp_f32 v133, v133
    v_cvt_pk_bf16_f32 v141, v130, v131
    v_mfma_f32_32x32x16_bf16 v[88:103], v[184:187], v[136:139], v[88:103]
    ds_write_b128 v6, v[76:79] offset:1024
    v_exp_f32 v134, v134
    v_exp_f32 v135, v135
    v_cvt_pk_bf16_f32 v142, v132, v133
    v_cvt_pk_bf16_f32 v143, v134, v135
    v_exp_f32 v104, v104
    v_exp_f32 v105, v105
    v_mfma_f32_32x32x16_bf16 v[88:103], v[188:191], v[140:143], v[88:103]
    ds_write_b128 v6, v[80:83] offset:2048
    v_exp_f32 v106, v106
    v_exp_f32 v107, v107
    v_cvt_pk_bf16_f32 v136, v104, v105
    v_exp_f32 v108, v108
    v_exp_f32 v109, v109
    v_cvt_pk_bf16_f32 v137, v106, v107
    v_mfma_f32_32x32x16_bf16 v[120:135], a[176:179], v[32:35], 0
    ds_write_b128 v6, v[84:87] offset:3072
    v_exp_f32 v110, v110
    v_exp_f32 v111, v111
    v_cvt_pk_bf16_f32 v138, v108, v109
    v_exp_f32 v112, v112
    v_exp_f32 v113, v113
    v_cvt_pk_bf16_f32 v139, v110, v111
    v_mfma_f32_32x32x16_bf16 v[120:135], a[180:183], v[36:39], v[120:135]
    v_exp_f32 v114, v114
    v_exp_f32 v115, v115
    v_cvt_pk_bf16_f32 v140, v112, v113
    v_exp_f32 v116, v116
    v_exp_f32 v117, v117
    v_cvt_pk_bf16_f32 v141, v114, v115
    v_mfma_f32_32x32x16_bf16 v[88:103], a[200:203], v[136:139], v[88:103]
    s_waitcnt lgkmcnt(0)
    s_barrier
    v_exp_f32 v118, v118
    v_exp_f32 v119, v119
    v_cvt_pk_bf16_f32 v142, v116, v117
    v_cvt_pk_bf16_f32 v143, v118, v119
    v_exp_f32 v120, v120
    v_exp_f32 v121, v121
    v_mfma_f32_32x32x16_bf16 v[88:103], a[204:207], v[140:143], v[88:103]
    buffer_store_dwordx4 v[212:215], v211, s[12:15], s67 offen sc1
    ds_read_b128 v[40:43], v7 offset:0
    ds_read_b128 v[56:59], v7 offset:4096
    ds_read_b128 v[72:75], v7 offset:8192
    v_exp_f32 v122, v122
    v_exp_f32 v123, v123
    v_cvt_pk_bf16_f32 v136, v120, v121
    v_exp_f32 v124, v124
    v_exp_f32 v125, v125
    v_cvt_pk_bf16_f32 v137, v122, v123
    ds_read_b128 v[44:47], v7 offset:1024
    ds_read_b128 v[60:63], v7 offset:5120
    ds_read_b128 v[76:79], v7 offset:9216
    v_exp_f32 v126, v126
    v_exp_f32 v127, v127
    v_cvt_pk_bf16_f32 v138, v124, v125
    v_exp_f32 v128, v128
    v_exp_f32 v129, v129
    v_cvt_pk_bf16_f32 v139, v126, v127
    ds_read_b128 v[48:51], v7 offset:2048
    ds_read_b128 v[64:67], v7 offset:6144
    ds_read_b128 v[80:83], v7 offset:10240
    v_exp_f32 v130, v130
    v_exp_f32 v131, v131
    v_cvt_pk_bf16_f32 v140, v128, v129
    v_exp_f32 v132, v132
    v_exp_f32 v133, v133
    v_cvt_pk_bf16_f32 v141, v130, v131
    v_mfma_f32_32x32x16_bf16 v[88:103], a[184:187], v[136:139], v[88:103]
    ds_read_b128 v[52:55], v7 offset:3072
    ds_read_b128 v[68:71], v7 offset:7168
    ds_read_b128 v[84:87], v7 offset:11264
    v_exp_f32 v134, v134
    v_exp_f32 v135, v135
    v_cvt_pk_bf16_f32 v142, v132, v133
    v_cvt_pk_bf16_f32 v143, v134, v135
    s_nop 1
    v_mfma_f32_32x32x16_bf16 v[88:103], a[188:191], v[140:143], v[88:103]
    s_waitcnt lgkmcnt(9)
    v_pk_add_f32 v[40:41], v[40:41], v[56:57]
    v_pk_add_f32 v[42:43], v[42:43], v[58:59]
    v_pk_add_f32 v[40:41], v[40:41], v[72:73]
    v_pk_add_f32 v[42:43], v[42:43], v[74:75]
    s_waitcnt lgkmcnt(6)
    v_pk_add_f32 v[44:45], v[44:45], v[60:61]
    v_pk_add_f32 v[46:47], v[46:47], v[62:63]
    v_pk_add_f32 v[44:45], v[44:45], v[76:77]
    v_pk_add_f32 v[46:47], v[46:47], v[78:79]
    s_waitcnt lgkmcnt(3)
    v_pk_add_f32 v[48:49], v[48:49], v[64:65]
    v_pk_add_f32 v[50:51], v[50:51], v[66:67]
    v_pk_add_f32 v[48:49], v[48:49], v[80:81]
    v_pk_add_f32 v[50:51], v[50:51], v[82:83]
    s_waitcnt lgkmcnt(0)
    v_pk_add_f32 v[52:53], v[52:53], v[68:69]
    v_pk_add_f32 v[54:55], v[54:55], v[70:71]
    v_pk_add_f32 v[52:53], v[52:53], v[84:85]
    v_pk_add_f32 v[54:55], v[54:55], v[86:87]
    v_add_f32 v248, v100, v52
    v_add_f32_e64 v249, v100, v52
    v_pk_add_f32 v[88:89], v[88:89], v[40:41]
    v_pk_add_f32 v[90:91], v[90:91], v[42:43]
    v_permlane32_swap_b32 v249, v248
    s_mov_b32 s56, 1342177280
    v_pk_add_f32 v[92:93], v[92:93], v[44:45]
    v_pk_add_f32 v[94:95], v[94:95], v[46:47]
    v_subrev_u32 v249, 394264576, v248
    v_rcp_f32 v248, v248
    v_cmp_lt_u32 vcc, s56, v249
    v_pk_add_f32 v[96:97], v[96:97], v[48:49]
    v_pk_add_f32 v[98:99], v[98:99], v[50:51]
    v_pk_add_f32 v[100:101], v[100:101], v[52:53]
    v_pk_add_f32 v[102:103], v[102:103], v[54:55]
    s_andn2_b32 s57, vcc_lo, s42
    s_cselect_b32 s55, 1073741824, s3
    s_cselect_b32 s3, s3, 1073741824
    v_pk_mul_f32 v[88:89], v[88:89], v[248:249] op_sel_hi:[1,0]
    v_pk_mul_f32 v[90:91], v[90:91], v[248:249] op_sel_hi:[1,0]
    v_pk_mul_f32 v[92:93], v[92:93], v[248:249] op_sel_hi:[1,0]
    v_pk_mul_f32 v[94:95], v[94:95], v[248:249] op_sel_hi:[1,0]
    v_cvt_pk_bf16_f32 v136, v88, v89
    v_cvt_pk_bf16_f32 v137, v90, v91
    v_cvt_pk_bf16_f32 v138, v92, v93
    v_cvt_pk_bf16_f32 v139, v94, v95
    buffer_store_dwordx4 v[136:139], v1, s[12:15], s55 offen offset:0 sc1
    v_pk_mul_f32 v[96:97], v[96:97], v[248:249] op_sel_hi:[1,0]
    v_pk_mul_f32 v[98:99], v[98:99], v[248:249] op_sel_hi:[1,0]
    v_pk_mul_f32 v[100:101], v[100:101], v[248:249] op_sel_hi:[1,0]
    v_pk_mul_f32 v[102:103], v[102:103], v[248:249] op_sel_hi:[1,0]
    v_cvt_pk_bf16_f32 v140, v96, v97
    v_cvt_pk_bf16_f32 v141, v98, v99
    v_cvt_pk_bf16_f32 v142, v100, v101
    v_cvt_pk_bf16_f32 v143, v102, v103
    s_mov_b32 exec_lo, 0
    v_mov_b32 v142, 0
    v_mov_b32 v143, 0
    s_mov_b32 exec_lo, -1
    buffer_store_dwordx4 v[140:143], v1, s[12:15], s55 offen offset:1024 sc1
    v_mov_b32 v248, s57
    v_and_b32 v249, 3, v0
    ds_write_b32 v7, v248
    v_mul_u32_u24 v249, 12288, v249
    v_add_u32 v249, 114688, v249
    s_add_u32 s50, s69, 4096
    s_add_u32 s51, s70, 4096
    s_add_u32 s55, s71, 4096
    s_waitcnt vmcnt(3)
    v_lshlrev_b32 v104, 16, v144
    v_and_b32 v105, 0xffff0000, v144
    v_lshlrev_b32_e64 v106, 16, v145
    v_and_b32 v107, 0xffff0000, v145
    v_lshlrev_b32_e64 v108, 16, v146
    v_and_b32 v109, 0xffff0000, v146
    v_lshlrev_b32_e64 v110, 16, v147
    v_and_b32 v111, 0xffff0000, v147
    v_lshlrev_b32_e64 v112, 16, v148
    v_and_b32 v113, 0xffff0000, v148
    v_lshlrev_b32_e64 v114, 16, v149
    v_and_b32 v115, 0xffff0000, v149
    v_lshlrev_b32_e64 v116, 16, v150
    v_and_b32 v117, 0xffff0000, v150
    v_lshlrev_b32_e64 v118, 16, v151
    v_and_b32 v119, 0xffff0000, v151
    buffer_load_dwordx4 v[72:75], v1, s[12:15], s71 offen offset:0 sc1
    buffer_load_dwordx4 v[76:79], v1, s[12:15], s71 offen offset:1024 sc1
    buffer_load_dwordx4 v[80:83], v1, s[12:15], s71 offen offset:2048 sc1
    buffer_load_dwordx4 v[84:87], v1, s[12:15], s71 offen offset:3072 sc1
    buffer_load_dwordx4 v[88:91], v1, s[12:15], s55 offen offset:0 sc1
    buffer_load_dwordx4 v[92:95], v1, s[12:15], s55 offen offset:1024 sc1
    buffer_load_dwordx4 v[96:99], v1, s[12:15], s55 offen offset:2048 sc1
    buffer_load_dwordx4 a[64:67], v252, s[12:15], s33 offen offset:0 sc1
    buffer_load_dwordx4 a[68:71], v253, s[12:15], s33 offen offset:0 sc1
    s_mov_b32 s60, 25198592
    buffer_load_dword v209, v2, s[12:15], s60 offen sc1
    s_waitcnt vmcnt(0)
    v_cmp_ne_u32 vcc, s39, v209
    s_cbranch_vccnz L_fw_7
L_fok_8:
    buffer_load_dwordx4 v[136:139], v1, s[12:15], s69 offen offset:0 sc1
    buffer_load_dwordx4 v[140:143], v1, s[12:15], s69 offen offset:1024 sc1
    buffer_load_dwordx4 v[144:147], v1, s[12:15], s69 offen offset:2048 sc1
    buffer_load_dwordx4 v[148:151], v1, s[12:15], s69 offen offset:3072 sc1
    buffer_load_dwordx4 v[152:155], v1, s[12:15], s50 offen offset:0 sc1
    buffer_load_dwordx4 v[156:159], v1, s[12:15], s50 offen offset:1024 sc1
    buffer_load_dwordx4 v[160:163], v1, s[12:15], s50 offen offset:2048 sc1
    buffer_load_dwordx4 v[164:167], v1, s[12:15], s50 offen offset:3072 sc1
    buffer_load_dwordx4 v[168:171], v1, s[12:15], s70 offen offset:0 sc1
    buffer_load_dwordx4 v[172:175], v1, s[12:15], s70 offen offset:1024 sc1
    s_waitcnt lgkmcnt(0)
    s_barrier
    ds_read_b32 v248, v249
    s_waitcnt lgkmcnt(0)
    s_barrier
    v_cmp_ne_u32 vcc, 0, v248
    s_cbranch_vccnz L_fb
    s_lshl_b32 s55, s28, 4
    s_lshr_b32 s56, s36, 1
    s_add_u32 s55, s55, s56
    v_min_u32 v249, 6, v0
    v_lshlrev_b32 v249, 1, v249
    v_add_u32 v249, s55, v249
    v_lshlrev_b32 v249, 7, v249
    s_cmp_ge_u32 s89, 14
    s_cbranch_scc1 L_cidle
    s_waitcnt vmcnt(8)
    v_max_u32 v209, v136, v140
    v_cmp_eq_u32 vcc, -1, v209
    s_cbranch_vccnz L_rs_9
L_rok_10:
    v_mfma_f32_32x32x16_bf16 v[8:23], a[224:227], v[136:139], 0
    buffer_load_dwordx4 v[176:179], v1, s[12:15], s70 offen offset:2048 sc1
    v_mfma_f32_32x32x16_bf16 v[8:23], a[232:235], v[140:143], v[8:23]
    buffer_load_dwordx4 v[180:183], v1, s[12:15], s70 offen offset:3072 sc1
    v_mfma_f32_32x32x16_bf16 v[40:55], a[228:231], v[136:139], 0
    buffer_load_dwordx4 v[184:187], v1, s[12:15], s51 offen offset:0 sc1
    v_mfma_f32_32x32x16_bf16 v[40:55], a[236:239], v[140:143], v[40:55]
    buffer_load_dwordx4 v[188:191], v1, s[12:15], s51 offen offset:1024 sc1
    s_waitcnt vmcnt(10)
    v_max_u32 v209, v144, v148
    v_cmp_eq_u32 vcc, -1, v209
    s_cbranch_vccnz L_rs_11
L_rok_12:
    v_mfma_f32_32x32x16_bf16 v[8:23], a[240:243], v[144:147], v[8:23]
    buffer_load_dwordx4 v[192:195], v1, s[12:15], s51 offen offset:2048 sc1
    v_mfma_f32_32x32x16_bf16 v[8:23], a[248:251], v[148:151], v[8:23]
    buffer_load_dwordx4 v[196:199], v1, s[12:15], s51 offen offset:3072 sc1
    v_mfma_f32_32x32x16_bf16 v[40:55], a[244:247], v[144:147], v[40:55]
    v_mfma_f32_32x32x16_bf16 v[40:55], a[252:255], v[148:151], v[40:55]
    s_waitcnt vmcnt(10)
    v_max_u32 v209, v152, v156
    v_cmp_eq_u32 vcc, -1, v209
    s_cbranch_vccnz L_rs_13
L_rok_14:
    v_mfma_f32_32x32x16_bf16 v[8:23], v[216:219], v[152:155], v[8:23]
    v_mfma_f32_32x32x16_bf16 v[8:23], v[224:227], v[156:159], v[8:23]
    v_mfma_f32_32x32x16_bf16 v[40:55], v[220:223], v[152:155], v[40:55]
    v_mfma_f32_32x32x16_bf16 v[40:55], v[228:231], v[156:159], v[40:55]
    s_waitcnt vmcnt(8)
    v_max_u32 v209, v160, v164
    v_cmp_eq_u32 vcc, -1, v209
    s_cbranch_vccnz L_rs_15
L_rok_16:
    v_mfma_f32_32x32x16_bf16 v[8:23], v[232:235], v[160:163], v[8:23]
    v_mfma_f32_32x32x16_bf16 v[8:23], v[240:243], v[164:167], v[8:23]
    v_mfma_f32_32x32x16_bf16 v[40:55], v[236:239], v[160:163], v[40:55]
    v_mfma_f32_32x32x16_bf16 v[40:55], v[244:247], v[164:167], v[40:55]
    s_waitcnt vmcnt(6)
    v_max_u32 v209, v168, v172
    v_cmp_eq_u32 vcc, -1, v209
    s_cbranch_vccnz L_rs_17
L_rok_18:
    v_mfma_f32_32x32x16_bf16 v[24:39], a[224:227], v[168:171], 0
    v_mfma_f32_32x32x16_bf16 v[24:39], a[232:235], v[172:175], v[24:39]
    s_nop 3
    ds_write_b128 v4, v[8:11] offset:0
    s_waitcnt vmcnt(4)
    v_max_u32 v209, v176, v180
    v_cmp_eq_u32 vcc, -1, v209
    s_cbranch_vccnz L_rs_19
L_rok_20:
    v_mfma_f32_32x32x16_bf16 v[24:39], a[240:243], v[176:179], v[24:39]
    ds_write_b128 v4, v[12:15] offset:1024
    v_mfma_f32_32x32x16_bf16 v[24:39], a[248:251], v[180:183], v[24:39]
    ds_write_b128 v4, v[16:19] offset:2048
    s_waitcnt vmcnt(2)
    v_max_u32 v209, v184, v188
    v_cmp_eq_u32 vcc, -1, v209
    s_cbranch_vccnz L_rs_21
L_rok_22:
    v_mfma_f32_32x32x16_bf16 v[24:39], v[216:219], v[184:187], v[24:39]
    ds_write_b128 v4, v[20:23] offset:3072
    v_mfma_f32_32x32x16_bf16 v[24:39], v[224:227], v[188:191], v[24:39]
    ds_write_b128 v6, v[40:43] offset:0
    s_waitcnt vmcnt(0)
    v_max_u32 v209, v192, v196
    v_cmp_eq_u32 vcc, -1, v209
    s_cbranch_vccnz L_rs_23
L_rok_24:
    v_mfma_f32_32x32x16_bf16 v[24:39], v[232:235], v[192:195], v[24:39]
    ds_write_b128 v6, v[44:47] offset:1024
    v_mfma_f32_32x32x16_bf16 v[24:39], v[240:243], v[196:199], v[24:39]
    ds_write_b128 v6, v[48:51] offset:2048
    v_mfma_f32_32x32x16_bf16 v[56:71], a[228:231], v[168:171], v[104:119]
    buffer_store_dwordx4 v[212:215], v211, s[12:15], s68 offen sc1
    ds_write_b128 v6, v[52:55] offset:3072
    v_mfma_f32_32x32x16_bf16 v[56:71], a[236:239], v[172:175], v[56:71]
    v_mfma_f32_32x32x16_bf16 v[56:71], a[244:247], v[176:179], v[56:71]
    s_nop 5
    ds_write_b128 v5, v[24:27] offset:0
    v_mfma_f32_32x32x16_bf16 v[56:71], a[252:255], v[180:183], v[56:71]
    ds_write_b128 v5, v[28:31] offset:1024
    v_mfma_f32_32x32x16_bf16 v[56:71], v[220:223], v[184:187], v[56:71]
    ds_write_b128 v5, v[32:35] offset:2048
    v_mfma_f32_32x32x16_bf16 v[56:71], v[228:231], v[188:191], v[56:71]
    ds_write_b128 v5, v[36:39] offset:3072
    v_mfma_f32_32x32x16_bf16 v[56:71], v[236:239], v[192:195], v[56:71]
    v_mfma_f32_32x32x16_bf16 v[56:71], v[244:247], v[196:199], v[56:71]
    s_waitcnt lgkmcnt(0)
    s_barrier
    ds_read_b128 v[8:11], v7 offset:0
    ds_read_b128 v[24:27], v7 offset:4096
    ds_read_b128 v[40:43], v7 offset:8192
    ds_read_b128 v[12:15], v7 offset:1024
    ds_read_b128 v[28:31], v7 offset:5120
    ds_read_b128 v[44:47], v7 offset:9216
    ds_read_b128 v[16:19], v7 offset:2048
    ds_read_b128 v[32:35], v7 offset:6144
    ds_read_b128 v[48:51], v7 offset:10240
    ds_read_b128 v[20:23], v7 offset:3072
    ds_read_b128 v[36:39], v7 offset:7168
    ds_read_b128 v[52:55], v7 offset:11264
    s_waitcnt lgkmcnt(11)
    v_pk_add_f32 v[56:57], v[56:57], v[8:9]
    v_pk_add_f32 v[58:59], v[58:59], v[10:11]
    s_waitcnt lgkmcnt(10)
    v_pk_add_f32 v[56:57], v[56:57], v[24:25]
    v_pk_add_f32 v[58:59], v[58:59], v[26:27]
    s_waitcnt lgkmcnt(9)
    v_pk_add_f32 v[56:57], v[56:57], v[40:41]
    v_pk_add_f32 v[58:59], v[58:59], v[42:43]
    v_cvt_pk_bf16_f32 v136, v56, v57
    v_cvt_pk_bf16_f32 v137, v58, v59
    s_waitcnt lgkmcnt(8)
    v_pk_add_f32 v[60:61], v[60:61], v[12:13]
    v_pk_add_f32 v[62:63], v[62:63], v[14:15]
    s_waitcnt lgkmcnt(7)
    v_pk_add_f32 v[60:61], v[60:61], v[28:29]
    v_pk_add_f32 v[62:63], v[62:63], v[30:31]
    s_waitcnt lgkmcnt(6)
    v_pk_add_f32 v[60:61], v[60:61], v[44:45]
    v_pk_add_f32 v[62:63], v[62:63], v[46:47]
    v_cvt_pk_bf16_f32 v138, v60, v61
    v_cvt_pk_bf16_f32 v139, v62, v63
    buffer_store_dwordx4 v[136:139], v1, s[12:15], s34 offen offset:0 sc1
    s_waitcnt lgkmcnt(5)
    v_pk_add_f32 v[64:65], v[64:65], v[16:17]
    v_pk_add_f32 v[66:67], v[66:67], v[18:19]
    s_waitcnt lgkmcnt(4)
    v_pk_add_f32 v[64:65], v[64:65], v[32:33]
    v_pk_add_f32 v[66:67], v[66:67], v[34:35]
    s_waitcnt lgkmcnt(3)
    v_pk_add_f32 v[64:65], v[64:65], v[48:49]
    v_pk_add_f32 v[66:67], v[66:67], v[50:51]
    v_cvt_pk_bf16_f32 v140, v64, v65
    v_cvt_pk_bf16_f32 v141, v66, v67
    s_waitcnt lgkmcnt(2)
    v_pk_add_f32 v[68:69], v[68:69], v[20:21]
    v_pk_add_f32 v[70:71], v[70:71], v[22:23]
    s_waitcnt lgkmcnt(1)
    v_pk_add_f32 v[68:69], v[68:69], v[36:37]
    v_pk_add_f32 v[70:71], v[70:71], v[38:39]
    s_waitcnt lgkmcnt(0)
    v_pk_add_f32 v[68:69], v[68:69], v[52:53]
    v_pk_add_f32 v[70:71], v[70:71], v[54:55]
    v_cvt_pk_bf16_f32 v142, v68, v69
    v_cvt_pk_bf16_f32 v143, v70, v71
    buffer_store_dwordx4 v[140:143], v1, s[12:15], s34 offen offset:1024 sc1
    v_pk_add_f32 v[16:17], v[56:57], v[58:59]
    v_pk_mul_f32 v[18:19], v[56:57], v[56:57]
    v_pk_fma_f32 v[18:19], v[58:59], v[58:59], v[18:19]
    v_pk_add_f32 v[16:17], v[16:17], v[60:61]
    v_pk_fma_f32 v[18:19], v[60:61], v[60:61], v[18:19]
    v_pk_add_f32 v[16:17], v[16:17], v[62:63]
    v_pk_fma_f32 v[18:19], v[62:63], v[62:63], v[18:19]
    v_pk_add_f32 v[16:17], v[16:17], v[64:65]
    v_pk_fma_f32 v[18:19], v[64:65], v[64:65], v[18:19]
    v_pk_add_f32 v[16:17], v[16:17], v[66:67]
    v_pk_fma_f32 v[18:19], v[66:67], v[66:67], v[18:19]
    v_pk_add_f32 v[16:17], v[16:17], v[68:69]
    v_pk_fma_f32 v[18:19], v[68:69], v[68:69], v[18:19]
    v_pk_add_f32 v[16:17], v[16:17], v[70:71]
    v_pk_fma_f32 v[18:19], v[70:71], v[70:71], v[18:19]
    v_add_f32 v16, v16, v17
    v_add_f32 v18, v18, v19
    s_nop 1
    v_permlane32_swap_b32 v16, v18
    v_add_f32_e64 v16, v16, v18
    buffer_store_dword v16, v210, s[12:15], s100 offen sc1
L_c1:
    s_mov_b32 s50, s72
    s_barrier
    s_mul_i32 s52, s36, 7168
    s_mul_i32 s53, s29, 200704
    s_add_u32 s53, s53, s52
    s_add_u32 s53, s53, 17940480
    s_add_u32 m0, s52, 114688
    s_add_u32 s56, s53, 0
    buffer_load_dwordx4 v1, s[12:15], s56 offen offset:0 sc1 lds
    buffer_load_dwordx4 v1, s[12:15], s56 offen offset:1024 sc1 lds
    buffer_load_dwordx4 v1, s[12:15], s56 offen offset:2048 sc1 lds
    s_mov_b32 s60, 25231360
    buffer_load_dword v248, v249, s[12:15], s60 offen sc1
    buffer_load_dwordx4 v1, s[12:15], s56 offen offset:3072 sc1 lds
    s_add_u32 m0, s52, 118784
    s_add_u32 s56, s53, 4096
    buffer_load_dwordx4 v1, s[12:15], s56 offen offset:0 sc1 lds
    buffer_load_dwordx4 v1, s[12:15], s56 offen offset:1024 sc1 lds
    buffer_load_dwordx4 v1, s[12:15], s56 offen offset:2048 sc1 lds
    v_accvgpr_write_b32 a224, v56
    v_accvgpr_write_b32 a225, v57
    v_accvgpr_write_b32 a226, v58
    v_accvgpr_write_b32 a227, v59
    v_accvgpr_write_b32 a228, v60
    v_accvgpr_write_b32 a229, v61
    v_accvgpr_write_b32 a230, v62
    v_accvgpr_write_b32 a231, v63
    v_accvgpr_write_b32 a232, v64
    v_accvgpr_write_b32 a233, v65
    v_accvgpr_write_b32 a234, v66
    v_accvgpr_write_b32 a235, v67
    v_accvgpr_write_b32 a236, v68
    v_accvgpr_write_b32 a237, v69
    v_accvgpr_write_b32 a238, v70
    v_accvgpr_write_b32 a239, v71
    v_mov_b32_e64 v250, v210
    v_lshlrev_b32 v2, 3, v0
    s_lshl_b32 s55, s36, 11
    s_add_u32 s55, s55, 143360
    v_add_u32 v3, s55, v2
    v_readfirstlane_b32 s55, v254
    v_lshrrev_b32_e64 v245, 2, v0
    v_mul_u32_u24 v245, 1792, v245
    v_and_b32_e64 v246, 3, v0
    v_lshl_add_u32 v245, v246, 4, v245
    v_add_u32_e64 v254, s55, v245
    s_mul_i32 s55, s36, 12288
    s_add_u32 s55, s55, 57344
    v_and_b32_e64 v245, 1, v0
    v_mul_u32_u24 v245, 1040, v245
    v_bfe_u32 v246, v0, 1, 4
    v_lshl_add_u32 v245, v246, 6, v245
    v_and_b32_e64 v246, 32, v0
    v_add3_u32 v244, v245, v246, s55
    v_subrev_u32 v4, 57344, v4
    v_subrev_u32 v5, 57344, v5
    v_subrev_u32 v6, 57344, v6
    v_subrev_u32 v7, 57344, v7
    v_pk_add_f32 v[72:73], v[72:73], v[76:77]
    v_pk_add_f32 v[74:75], v[74:75], v[78:79]
    v_pk_add_f32 v[72:73], v[72:73], v[80:81]
    v_pk_add_f32 v[74:75], v[74:75], v[82:83]
    v_pk_add_f32 v[72:73], v[72:73], v[84:85]
    v_pk_add_f32 v[74:75], v[74:75], v[86:87]
    v_pk_add_f32 v[72:73], v[72:73], v[88:89]
    v_pk_add_f32 v[74:75], v[74:75], v[90:91]
    v_pk_add_f32 v[72:73], v[72:73], v[92:93]
    v_pk_add_f32 v[74:75], v[74:75], v[94:95]
    v_pk_add_f32 v[72:73], v[72:73], v[96:97]
    v_pk_add_f32 v[74:75], v[74:75], v[98:99]
    v_cvt_pk_bf16_f32 v100, v72, v72
    v_and_b32 v101, 0xffff0000, v100
    v_sub_f32_e64 v101, v72, v101
    v_cvt_pk_bf16_f32 v101, v101, v101
    ds_write_b64 v3, v[100:101] offset:0
    v_cvt_pk_bf16_f32 v102, v73, v73
    v_and_b32 v103, 0xffff0000, v102
    v_sub_f32_e64 v103, v73, v103
    v_cvt_pk_bf16_f32 v103, v103, v103
    ds_write_b64 v3, v[102:103] offset:512
    v_cvt_pk_bf16_f32 v104, v74, v74
    v_and_b32 v105, 0xffff0000, v104
    v_sub_f32_e64 v105, v74, v105
    v_cvt_pk_bf16_f32 v105, v105, v105
    ds_write_b64 v3, v[104:105] offset:1024
    v_cvt_pk_bf16_f32 v106, v75, v75
    v_and_b32 v107, 0xffff0000, v106
    v_sub_f32_e64 v107, v75, v107
    v_cvt_pk_bf16_f32 v107, v107, v107
    ds_write_b64 v3, v[106:107] offset:1536
    s_mul_i32 s55, s29, 7
    s_and_b32 s55, s55, 3
    s_lshl_b32 s55, s55, 9
    s_add_u32 s55, s55, 143360
    v_add_u32 v3, s55, v2
    v_add_u32 v2, 57344, v1
    v_add_u32 v251, 114688, v1
    s_waitcnt lgkmcnt(0)
    ds_read_b128 v[184:187], v1 offset:0
    ds_read_b128 v[188:191], v1 offset:28672
    ds_read_b128 v[192:195], v2 offset:0
    ds_read_b128 v[196:199], v1 offset:1024
    ds_read_b128 v[200:203], v1 offset:29696
    ds_read_b128 v[204:207], v2 offset:1024
    s_waitcnt vmcnt(4)
    v_cmp_ne_u32 vcc, s39, v248
    s_cbranch_vccnz L_fw_25
L_fok_26:
    buffer_load_dwordx4 v[8:11], v1, s[12:15], s50 offen offset:0 sc1
    buffer_load_dwordx4 v[12:15], v1, s[12:15], s50 offen offset:1024 sc1
    buffer_load_dwordx4 v[16:19], v1, s[12:15], s50 offen offset:2048 sc1
    buffer_load_dwordx4 v[20:23], v1, s[12:15], s50 offen offset:3072 sc1
    s_add_u32 s50, s50, 4096
    buffer_load_dwordx4 v[24:27], v1, s[12:15], s50 offen offset:0 sc1
    buffer_load_dwordx4 v[28:31], v1, s[12:15], s50 offen offset:1024 sc1
    buffer_load_dwordx4 v[32:35], v1, s[12:15], s50 offen offset:2048 sc1
    buffer_load_dwordx4 v[36:39], v1, s[12:15], s50 offen offset:3072 sc1
    s_add_u32 s50, s50, 4096
    buffer_load_dwordx4 v[40:43], v1, s[12:15], s50 offen offset:0 sc1
    buffer_load_dwordx4 v[44:47], v1, s[12:15], s50 offen offset:1024 sc1
    s_waitcnt vmcnt(8)
    v_max_u32 v248, v8, v12
    v_cmp_eq_u32 vcc, -1, v248
    s_cbranch_vccnz L_rs_27
L_rok_28:
    s_waitcnt lgkmcnt(4)
    v_mfma_f32_32x32x16_bf16 v[120:135], v[184:187], v[8:11], 0
    ds_read_b128 v[208:211], v1 offset:2048
    buffer_load_dwordx4 v[48:51], v1, s[12:15], s50 offen offset:2048 sc1
    v_mfma_f32_32x32x16_bf16 v[136:151], v[188:191], v[8:11], 0
    ds_read_b128 v[212:215], v1 offset:30720
    s_waitcnt lgkmcnt(4)
    v_mfma_f32_32x32x16_bf16 v[152:167], v[192:195], v[8:11], 0
    ds_read_b128 v[184:187], v2 offset:2048
    buffer_load_dwordx4 v[52:55], v1, s[12:15], s50 offen offset:3072 sc1
    s_add_u32 s50, s50, 4096
    v_mfma_f32_32x32x16_bf16 v[120:135], v[196:199], v[12:15], v[120:135]
    ds_read_b128 v[188:191], v1 offset:3072
    s_waitcnt lgkmcnt(4)
    v_mfma_f32_32x32x16_bf16 v[136:151], v[200:203], v[12:15], v[136:151]
    ds_read_b128 v[192:195], v1 offset:31744
    buffer_load_dwordx4 v[56:59], v1, s[12:15], s50 offen offset:0 sc1
    v_mfma_f32_32x32x16_bf16 v[152:167], v[204:207], v[12:15], v[152:167]
    ds_read_b128 v[196:199], v2 offset:3072
    s_waitcnt vmcnt(9)
    v_max_u32 v248, v16, v20
    v_cmp_eq_u32 vcc, -1, v248
    s_cbranch_vccnz L_rs_29
L_rok_30:
    s_waitcnt lgkmcnt(4)
    v_mfma_f32_32x32x16_bf16 v[120:135], v[208:211], v[16:19], v[120:135]
    ds_read_b128 v[200:203], v1 offset:4096
    buffer_load_dwordx4 v[60:63], v1, s[12:15], s50 offen offset:1024 sc1
    v_mfma_f32_32x32x16_bf16 v[136:151], v[212:215], v[16:19], v[136:151]
    ds_read_b128 v[204:207], v1 offset:32768
    s_waitcnt lgkmcnt(4)
    v_mfma_f32_32x32x16_bf16 v[152:167], v[184:187], v[16:19], v[152:167]
    ds_read_b128 v[208:211], v2 offset:4096
    buffer_load_dwordx4 v[64:67], v1, s[12:15], s50 offen offset:2048 sc1
    v_mfma_f32_32x32x16_bf16 v[120:135], v[188:191], v[20:23], v[120:135]
    ds_read_b128 v[212:215], v1 offset:5120
    s_waitcnt lgkmcnt(4)
    v_mfma_f32_32x32x16_bf16 v[136:151], v[192:195], v[20:23], v[136:151]
    ds_read_b128 v[184:187], v1 offset:33792
    buffer_load_dwordx4 v[68:71], v1, s[12:15], s50 offen offset:3072 sc1
    s_add_u32 s50, s50, 4096
    v_mfma_f32_32x32x16_bf16 v[152:167], v[196:199], v[20:23], v[152:167]
    ds_read_b128 v[188:191], v2 offset:5120
    s_waitcnt vmcnt(8)
    v_max3_u32 v248, v24, v28, v32
    v_max_u32 v248, v248, v36
    v_cmp_eq_u32 vcc, -1, v248
    s_cbranch_vccnz L_rs_31
L_rok_32:
    s_waitcnt lgkmcnt(4)
    v_mfma_f32_32x32x16_bf16 v[120:135], v[200:203], v[24:27], v[120:135]
    ds_read_b128 v[192:195], v1 offset:6144
    buffer_load_dwordx4 v[72:75], v1, s[12:15], s50 offen offset:0 sc1
    v_mfma_f32_32x32x16_bf16 v[136:151], v[204:207], v[24:27], v[136:151]
    ds_read_b128 v[196:199], v1 offset:34816
    s_waitcnt lgkmcnt(4)
    v_mfma_f32_32x32x16_bf16 v[152:167], v[208:211], v[24:27], v[152:167]
    ds_read_b128 v[200:203], v2 offset:6144
    buffer_load_dwordx4 v[76:79], v1, s[12:15], s50 offen offset:1024 sc1
    v_mfma_f32_32x32x16_bf16 v[120:135], v[212:215], v[28:31], v[120:135]
    ds_read_b128 v[204:207], v1 offset:7168
    s_waitcnt lgkmcnt(4)
    v_mfma_f32_32x32x16_bf16 v[136:151], v[184:187], v[28:31], v[136:151]
    ds_read_b128 v[208:211], v1 offset:35840
    buffer_load_dwordx4 v[80:83], v1, s[12:15], s50 offen offset:2048 sc1
    v_mfma_f32_32x32x16_bf16 v[152:167], v[188:191], v[28:31], v[152:167]
    ds_read_b128 v[212:215], v2 offset:7168
    s_waitcnt lgkmcnt(4)
    v_mfma_f32_32x32x16_bf16 v[120:135], v[192:195], v[32:35], v[120:135]
    ds_read_b128 v[184:187], v1 offset:8192
    buffer_load_dwordx4 v[84:87], v1, s[12:15], s50 offen offset:3072 sc1
    s_add_u32 s50, s50, 4096
    v_mfma_f32_32x32x16_bf16 v[136:151], v[196:199], v[32:35], v[136:151]
    ds_read_b128 v[188:191], v1 offset:36864
    s_waitcnt lgkmcnt(4)
    v_mfma_f32_32x32x16_bf16 v[152:167], v[200:203], v[32:35], v[152:167]
    ds_read_b128 v[192:195], v2 offset:8192
    buffer_load_dwordx4 v[88:91], v1, s[12:15], s50 offen offset:0 sc1
    v_mfma_f32_32x32x16_bf16 v[120:135], v[204:207], v[36:39], v[120:135]
    ds_read_b128 v[196:199], v1 offset:9216
    s_waitcnt lgkmcnt(4)
    v_mfma_f32_32x32x16_bf16 v[136:151], v[208:211], v[36:39], v[136:151]
    ds_read_b128 v[200:203], v1 offset:37888
    buffer_load_dwordx4 v[92:95], v1, s[12:15], s50 offen offset:1024 sc1
    v_mfma_f32_32x32x16_bf16 v[152:167], v[212:215], v[36:39], v[152:167]
    ds_read_b128 v[204:207], v2 offset:9216
    s_waitcnt vmcnt(10)
    v_max3_u32 v248, v40, v44, v48
    v_max_u32 v248, v248, v52
    v_cmp_eq_u32 vcc, -1, v248
    s_cbranch_vccnz L_rs_33
L_rok_34:
    s_waitcnt lgkmcnt(4)
    v_mfma_f32_32x32x16_bf16 v[120:135], v[184:187], v[40:43], v[120:135]
    ds_read_b128 v[208:211], v1 offset:10240
    buffer_load_dwordx4 v[96:99], v1, s[12:15], s50 offen offset:2048 sc1
    v_mfma_f32_32x32x16_bf16 v[136:151], v[188:191], v[40:43], v[136:151]
    ds_read_b128 v[212:215], v1 offset:38912
    s_waitcnt lgkmcnt(4)
    v_mfma_f32_32x32x16_bf16 v[152:167], v[192:195], v[40:43], v[152:167]
    ds_read_b128 v[184:187], v2 offset:10240
    buffer_load_dwordx4 v[100:103], v1, s[12:15], s50 offen offset:3072 sc1
    s_add_u32 s50, s50, 4096
    v_mfma_f32_32x32x16_bf16 v[120:135], v[196:199], v[44:47], v[120:135]
    ds_read_b128 v[188:191], v1 offset:11264
    s_waitcnt lgkmcnt(4)
    v_mfma_f32_32x32x16_bf16 v[136:151], v[200:203], v[44:47], v[136:151]
    ds_read_b128 v[192:195], v1 offset:39936
    buffer_load_dwordx4 v[104:107], v1, s[12:15], s50 offen offset:0 sc1
    v_mfma_f32_32x32x16_bf16 v[152:167], v[204:207], v[44:47], v[152:167]
    ds_read_b128 v[196:199], v2 offset:11264
    s_waitcnt lgkmcnt(4)
    v_mfma_f32_32x32x16_bf16 v[120:135], v[208:211], v[48:51], v[120:135]
    ds_read_b128 v[200:203], v1 offset:12288
    buffer_load_dwordx4 v[108:111], v1, s[12:15], s50 offen offset:1024 sc1
    v_mfma_f32_32x32x16_bf16 v[136:151], v[212:215], v[48:51], v[136:151]
    ds_read_b128 v[204:207], v1 offset:40960
    s_waitcnt lgkmcnt(4)
    v_mfma_f32_32x32x16_bf16 v[152:167], v[184:187], v[48:51], v[152:167]
    ds_read_b128 v[208:211], v2 offset:12288
    buffer_load_dwordx4 v[112:115], v1, s[12:15], s50 offen offset:2048 sc1
    v_mfma_f32_32x32x16_bf16 v[120:135], v[188:191], v[52:55], v[120:135]
    ds_read_b128 v[212:215], v1 offset:13312
    s_waitcnt lgkmcnt(4)
    v_mfma_f32_32x32x16_bf16 v[136:151], v[192:195], v[52:55], v[136:151]
    ds_read_b128 v[184:187], v1 offset:41984
    buffer_load_dwordx4 v[116:119], v1, s[12:15], s50 offen offset:3072 sc1
    s_add_u32 s50, s50, 4096
    v_mfma_f32_32x32x16_bf16 v[152:167], v[196:199], v[52:55], v[152:167]
    ds_read_b128 v[188:191], v2 offset:13312
    buffer_load_dword v168, v250, s[12:15], s73 offen offset:0 sc1
    s_waitcnt vmcnt(13)
    v_max3_u32 v248, v56, v60, v64
    v_max_u32 v248, v248, v68
    v_cmp_eq_u32 vcc, -1, v248
    s_cbranch_vccnz L_rs_35
L_rok_36:
    s_waitcnt lgkmcnt(4)
    v_mfma_f32_32x32x16_bf16 v[120:135], v[200:203], v[56:59], v[120:135]
    ds_read_b128 v[192:195], v1 offset:14336
    buffer_load_dword v169, v250, s[12:15], s73 offen offset:256 sc1
    v_mfma_f32_32x32x16_bf16 v[136:151], v[204:207], v[56:59], v[136:151]
    ds_read_b128 v[196:199], v1 offset:43008
    buffer_load_dword v170, v250, s[12:15], s73 offen offset:512 sc1
    s_waitcnt lgkmcnt(4)
    v_mfma_f32_32x32x16_bf16 v[152:167], v[208:211], v[56:59], v[152:167]
    ds_read_b128 v[200:203], v2 offset:14336
    buffer_load_dword v171, v250, s[12:15], s73 offen offset:768 sc1
    v_mfma_f32_32x32x16_bf16 v[120:135], v[212:215], v[60:63], v[120:135]
    ds_read_b128 v[204:207], v1 offset:15360
    buffer_load_dword v172, v250, s[12:15], s73 offen offset:1024 sc1
    s_waitcnt lgkmcnt(4)
    v_mfma_f32_32x32x16_bf16 v[136:151], v[184:187], v[60:63], v[136:151]
    ds_read_b128 v[208:211], v1 offset:44032
    buffer_load_dword v173, v250, s[12:15], s73 offen offset:1280 sc1
    v_mfma_f32_32x32x16_bf16 v[152:167], v[188:191], v[60:63], v[152:167]
    ds_read_b128 v[212:215], v2 offset:15360
    buffer_load_dword v174, v250, s[12:15], s73 offen offset:1536 sc1
    s_waitcnt lgkmcnt(4)
    v_mfma_f32_32x32x16_bf16 v[120:135], v[192:195], v[64:67], v[120:135]
    ds_read_b128 v[184:187], v1 offset:16384
    buffer_load_dword v175, v250, s[12:15], s73 offen offset:1792 sc1
    v_mfma_f32_32x32x16_bf16 v[136:151], v[196:199], v[64:67], v[136:151]
    ds_read_b128 v[188:191], v1 offset:45056
    buffer_load_dword v176, v250, s[12:15], s73 offen offset:2048 sc1
    s_waitcnt lgkmcnt(4)
    v_mfma_f32_32x32x16_bf16 v[152:167], v[200:203], v[64:67], v[152:167]
    ds_read_b128 v[192:195], v2 offset:16384
    buffer_load_dword v177, v250, s[12:15], s73 offen offset:2304 sc1
    v_mfma_f32_32x32x16_bf16 v[120:135], v[204:207], v[68:71], v[120:135]
    ds_read_b128 v[196:199], v1 offset:17408
    buffer_load_dwordx4 a[72:75], v252, s[12:15], s33 offen offset:2048 sc1
    buffer_load_dword v178, v250, s[12:15], s73 offen offset:2560 sc1
    s_waitcnt lgkmcnt(4)
    v_mfma_f32_32x32x16_bf16 v[136:151], v[208:211], v[68:71], v[136:151]
    ds_read_b128 v[200:203], v1 offset:46080
    buffer_load_dword v179, v250, s[12:15], s73 offen offset:2816 sc1
    v_mfma_f32_32x32x16_bf16 v[152:167], v[212:215], v[68:71], v[152:167]
    ds_read_b128 v[204:207], v2 offset:17408
    buffer_load_dwordx4 a[76:79], v253, s[12:15], s33 offen offset:2048 sc1
    s_add_u32 s33, s33, 4096
    buffer_load_dword v180, v250, s[12:15], s73 offen offset:3072 sc1
    s_waitcnt vmcnt(23)
    v_max3_u32 v248, v72, v76, v80
    v_max_u32 v248, v248, v84
    v_cmp_eq_u32 vcc, -1, v248
    s_cbranch_vccnz L_rs_37
L_rok_38:
    s_waitcnt lgkmcnt(4)
    v_mfma_f32_32x32x16_bf16 v[120:135], v[184:187], v[72:75], v[120:135]
    ds_read_b128 v[208:211], v1 offset:18432
    buffer_load_dword v181, v250, s[12:15], s73 offen offset:3328 sc1
    v_mfma_f32_32x32x16_bf16 v[136:151], v[188:191], v[72:75], v[136:151]
    ds_read_b128 v[212:215], v1 offset:47104
    buffer_load_dwordx4 a[80:83], v252, s[12:15], s33 offen offset:0 sc1
    s_waitcnt lgkmcnt(4)
    v_mfma_f32_32x32x16_bf16 v[152:167], v[192:195], v[72:75], v[152:167]
    ds_read_b128 v[184:187], v2 offset:18432
    v_mfma_f32_32x32x16_bf16 v[120:135], v[196:199], v[76:79], v[120:135]
    ds_read_b128 v[188:191], v1 offset:19456
    buffer_load_dwordx4 a[84:87], v253, s[12:15], s33 offen offset:0 sc1
    s_waitcnt lgkmcnt(4)
    v_mfma_f32_32x32x16_bf16 v[136:151], v[200:203], v[76:79], v[136:151]
    ds_read_b128 v[192:195], v1 offset:48128
    v_mfma_f32_32x32x16_bf16 v[152:167], v[204:207], v[76:79], v[152:167]
    ds_read_b128 v[196:199], v2 offset:19456
    buffer_load_dwordx4 a[88:91], v252, s[12:15], s33 offen offset:2048 sc1
    s_waitcnt lgkmcnt(4)
    v_mfma_f32_32x32x16_bf16 v[120:135], v[208:211], v[80:83], v[120:135]
    ds_read_b128 v[200:203], v1 offset:20480
    v_mfma_f32_32x32x16_bf16 v[136:151], v[212:215], v[80:83], v[136:151]
    ds_read_b128 v[204:207], v1 offset:49152
    buffer_load_dwordx4 a[92:95], v253, s[12:15], s33 offen offset:2048 sc1
    s_add_u32 s33, s33, 4096
    s_waitcnt lgkmcnt(4)
    v_mfma_f32_32x32x16_bf16 v[152:167], v[184:187], v[80:83], v[152:167]
    ds_read_b128 v[208:211], v2 offset:20480
    v_mfma_f32_32x32x16_bf16 v[120:135], v[188:191], v[84:87], v[120:135]
    ds_read_b128 v[212:215], v1 offset:21504
    buffer_load_dwordx4 a[96:99], v252, s[12:15], s33 offen offset:0 sc1
    s_waitcnt lgkmcnt(4)
    v_mfma_f32_32x32x16_bf16 v[136:151], v[192:195], v[84:87], v[136:151]
    ds_read_b128 v[184:187], v1 offset:50176
    v_mfma_f32_32x32x16_bf16 v[152:167], v[196:199], v[84:87], v[152:167]
    ds_read_b128 v[188:191], v2 offset:21504
    buffer_load_dwordx4 a[100:103], v253, s[12:15], s33 offen offset:0 sc1
    s_waitcnt vmcnt(26)
    v_max3_u32 v248, v88, v92, v96
    v_max_u32 v248, v248, v100
    v_cmp_eq_u32 vcc, -1, v248
    s_cbranch_vccnz L_rs_39
L_rok_40:
    s_waitcnt lgkmcnt(4)
    v_mfma_f32_32x32x16_bf16 v[120:135], v[200:203], v[88:91], v[120:135]
    ds_read_b128 v[192:195], v1 offset:22528
    v_mfma_f32_32x32x16_bf16 v[136:151], v[204:207], v[88:91], v[136:151]
    ds_read_b128 v[196:199], v1 offset:51200
    buffer_load_dwordx4 a[104:107], v252, s[12:15], s33 offen offset:2048 sc1
    s_waitcnt lgkmcnt(4)
    v_mfma_f32_32x32x16_bf16 v[152:167], v[208:211], v[88:91], v[152:167]
    ds_read_b128 v[200:203], v2 offset:22528
    v_mfma_f32_32x32x16_bf16 v[120:135], v[212:215], v[92:95], v[120:135]
    ds_read_b128 v[204:207], v1 offset:23552
    buffer_load_dwordx4 a[108:111], v253, s[12:15], s33 offen offset:2048 sc1
    s_add_u32 s33, s33, 4096
    s_waitcnt lgkmcnt(4)
    v_mfma_f32_32x32x16_bf16 v[136:151], v[184:187], v[92:95], v[136:151]
    ds_read_b128 v[208:211], v1 offset:52224
    v_mfma_f32_32x32x16_bf16 v[152:167], v[188:191], v[92:95], v[152:167]
    ds_read_b128 v[212:215], v2 offset:23552
    buffer_load_dwordx4 a[112:115], v252, s[12:15], s33 offen offset:0 sc1
    s_waitcnt lgkmcnt(4)
    v_mfma_f32_32x32x16_bf16 v[120:135], v[192:195], v[96:99], v[120:135]
    ds_read_b128 v[184:187], v1 offset:24576
    v_mfma_f32_32x32x16_bf16 v[136:151], v[196:199], v[96:99], v[136:151]
    ds_read_b128 v[188:191], v1 offset:53248
    buffer_load_dwordx4 a[116:119], v253, s[12:15], s33 offen offset:0 sc1
    s_waitcnt lgkmcnt(4)
    v_mfma_f32_32x32x16_bf16 v[152:167], v[200:203], v[96:99], v[152:167]
    ds_read_b128 v[192:195], v2 offset:24576
    s_waitcnt vmcnt(10)
    v_max3_u32 v248, v168, v169, v170
    v_max3_u32 v248, v248, v171, v172
    v_max3_u32 v248, v248, v173, v174
    v_max3_u32 v248, v248, v175, v176
    v_max3_u32 v248, v248, v177, v178
    v_max3_u32 v248, v248, v179, v180
    v_max_u32 v248, v248, v181
    v_cmp_eq_u32 vcc, -1, v248
    s_cbranch_vccnz L_rs_41
L_rok_42:
    v_add_f32 v168, v168, v169
    v_add_f32 v168, v168, v170
    v_add_f32 v168, v168, v171
    v_add_f32_e64 v168, v168, v172
    v_mfma_f32_32x32x16_bf16 v[120:135], v[204:207], v[100:103], v[120:135]
    ds_read_b128 v[196:199], v1 offset:25600
    buffer_load_dwordx4 a[120:123], v252, s[12:15], s33 offen offset:2048 sc1
    v_add_f32 v168, v168, v173
    v_add_f32 v168, v168, v174
    v_add_f32 v168, v168, v175
    s_waitcnt lgkmcnt(4)
    v_mfma_f32_32x32x16_bf16 v[136:151], v[208:211], v[100:103], v[136:151]
    ds_read_b128 v[200:203], v1 offset:54272
    v_add_f32 v168, v168, v176
    v_add_f32 v168, v168, v177
    v_add_f32 v168, v168, v178
    v_add_f32 v168, v168, v179
    v_add_f32_e64 v168, v168, v180
    v_mfma_f32_32x32x16_bf16 v[152:167], v[212:215], v[100:103], v[152:167]
    ds_read_b128 v[204:207], v2 offset:25600
    buffer_load_dwordx4 a[124:127], v253, s[12:15], s33 offen offset:2048 sc1
    s_add_u32 s33, s33, 4096
    v_add_f32 v168, v168, v181
    v_mov_b32 v169, v168
    v_max3_u32 v248, v104, v108, v112
    v_max_u32 v248, v248, v116
    v_cmp_eq_u32 vcc, -1, v248
    s_cbranch_vccnz L_rs_43
L_rok_44:
    s_waitcnt lgkmcnt(4)
    v_mfma_f32_32x32x16_bf16 v[120:135], v[184:187], v[104:107], v[120:135]
    ds_read_b128 v[208:211], v1 offset:26624
    v_permlane32_swap_b32 v168, v169
    v_mul_f32 v168, 0xbb124925, v168
    v_mul_f32 v169, 0x3b124925, v169
    v_cvt_pk_bf16_f32 v220, v168, v168
    v_fma_f32 v169, -v168, v168, v169
    v_mfma_f32_32x32x16_bf16 v[136:151], v[188:191], v[104:107], v[136:151]
    ds_read_b128 v[212:215], v1 offset:55296
    buffer_load_dwordx4 a[128:131], v252, s[12:15], s33 offen offset:0 sc1
    v_and_b32 v220, 0xffff0000, v220
    v_max_f32 v169, 0, v169
    v_sub_f32 v220, v168, v220
    s_waitcnt lgkmcnt(4)
    v_mfma_f32_32x32x16_bf16 v[152:167], v[192:195], v[104:107], v[152:167]
    ds_read_b128 v[184:187], v2 offset:26624
    v_add_f32 v222, 0x3727c5ac, v169
    v_cvt_pk_bf16_f32 v218, v168, v220
    v_cvt_pk_bf16_f32 v219, v168, v220
    v_rsq_f32_e64 v220, v222
    v_mfma_f32_32x32x16_bf16 v[120:135], v[196:199], v[108:111], v[120:135]
    ds_read_b128 v[188:191], v1 offset:27648
    buffer_load_dwordx4 a[132:135], v253, s[12:15], s33 offen offset:0 sc1
    v_sqrt_f32_e64 v222, v222
    v_mul_f32 v220, 0xbfb8aa3b, v220
    s_waitcnt lgkmcnt(4)
    v_mfma_f32_32x32x16_bf16 v[136:151], v[200:203], v[108:111], v[136:151]
    ds_read_b128 v[192:195], v1 offset:56320
    v_mfma_f32_32x32x16_bf16 v[152:167], v[204:207], v[108:111], v[152:167]
    ds_read_b128 v[196:199], v2 offset:27648
    buffer_load_dwordx4 a[136:139], v252, s[12:15], s33 offen offset:2048 sc1
    s_waitcnt lgkmcnt(4)
    v_mfma_f32_32x32x16_bf16 v[120:135], v[208:211], v[112:115], v[120:135]
    ds_read_b128 v[200:203], v2 offset:28672
    v_mfma_f32_32x32x16_bf16 v[136:151], v[212:215], v[112:115], v[136:151]
    ds_read_b128 v[204:207], v2 offset:29696
    buffer_load_dwordx4 a[140:143], v253, s[12:15], s33 offen offset:2048 sc1
    s_add_u32 s33, s33, 4096
    s_waitcnt lgkmcnt(4)
    v_mfma_f32_32x32x16_bf16 v[152:167], v[184:187], v[112:115], v[152:167]
    ds_read_b128 v[208:211], v2 offset:30720
    v_mfma_f32_32x32x16_bf16 v[120:135], v[188:191], v[116:119], v[120:135]
    ds_read_b128 v[212:215], v2 offset:31744
    buffer_load_dwordx4 a[144:147], v252, s[12:15], s33 offen offset:0 sc1
    s_waitcnt lgkmcnt(4)
    v_mfma_f32_32x32x16_bf16 v[136:151], v[192:195], v[116:119], v[136:151]
    ds_read_b128 v[184:187], v2 offset:32768
    v_mfma_f32_32x32x16_bf16 v[152:167], v[196:199], v[116:119], v[152:167]
    ds_read_b128 v[188:191], v2 offset:33792
    s_barrier
    ds_read_b64 v[224:225], v3 offset:0
    ds_read_b64 v[226:227], v3 offset:512
    ds_read_b64 v[228:229], v3 offset:1024
    ds_read_b64 v[230:231], v3 offset:1536
    s_waitcnt lgkmcnt(8)
    v_mfma_f32_32x32x16_bf16 v[168:183], v[200:203], v[8:11], 0
    ds_read_b128 v[192:195], v2 offset:34816
    v_mfma_f32_32x32x16_bf16 v[168:183], v[204:207], v[12:15], v[168:183]
    ds_read_b128 v[196:199], v2 offset:35840
    s_add_u32 m0, s52, 0
    s_add_u32 s56, s53, 28672
    buffer_load_dwordx4 v1, s[12:15], s56 offen offset:0 sc1 lds
    s_waitcnt lgkmcnt(8)
    v_mfma_f32_32x32x16_bf16 v[168:183], v[208:211], v[16:19], v[168:183]
    ds_read_b128 v[200:203], v2 offset:36864
    s_waitcnt lgkmcnt(3)
    v_mfma_f32_32x32x8bf16_1k v[120:135], v[224:225], v[218:219], v[120:135]
    v_mfma_f32_32x32x8bf16_1k v[136:151], v[226:227], v[218:219], v[136:151]
    v_mfma_f32_32x32x8bf16_1k v[152:167], v[228:229], v[218:219], v[152:167]
    v_mfma_f32_32x32x16_bf16 v[168:183], v[212:215], v[20:23], v[168:183]
    ds_read_b128 v[204:207], v2 offset:37888
    buffer_load_dwordx4 v1, s[12:15], s56 offen offset:1024 sc1 lds
    v_mfma_f32_32x32x16_bf16 v[168:183], v[184:187], v[24:27], v[168:183]
    ds_read_b128 v[208:211], v2 offset:38912
    buffer_load_dwordx4 v1, s[12:15], s56 offen offset:2048 sc1 lds
    v_mfma_f32_32x32x16_bf16 v[168:183], v[188:191], v[28:31], v[168:183]
    ds_read_b128 v[212:215], v2 offset:39936
    buffer_load_dwordx4 v1, s[12:15], s56 offen offset:3072 sc1 lds
    s_waitcnt lgkmcnt(4)
    v_mfma_f32_32x32x16_bf16 v[168:183], v[192:195], v[32:35], v[168:183]
    ds_read_b128 v[184:187], v2 offset:40960
    v_mul_f32 v120, v220, v120
    v_mul_f32 v121, v220, v121
    v_mul_f32 v122, v220, v122
    v_mul_f32 v123, v220, v123
    v_mul_f32 v124, v220, v124
    v_mul_f32 v125, v220, v125
    v_mfma_f32_32x32x16_bf16 v[168:183], v[196:199], v[36:39], v[168:183]
    ds_read_b128 v[188:191], v2 offset:41984
    s_add_u32 m0, s52, 4096
    s_add_u32 s56, s53, 32768
    buffer_load_dwordx4 v1, s[12:15], s56 offen offset:0 sc1 lds
    v_mul_f32 v126, v220, v126
    s_waitcnt lgkmcnt(4)
    v_mfma_f32_32x32x16_bf16 v[168:183], v[200:203], v[40:43], v[168:183]
    ds_read_b128 v[192:195], v2 offset:43008
    ds_read_b64 v[224:225], v3 offset:2048
    v_mul_f32 v127, v220, v127
    v_exp_f32 v120, v120
    v_exp_f32_e64 v121, v121
    v_mfma_f32_32x32x16_bf16 v[168:183], v[204:207], v[44:47], v[168:183]
    ds_read_b128 v[196:199], v2 offset:44032
    buffer_load_dwordx4 v1, s[12:15], s56 offen offset:1024 sc1 lds
    v_exp_f32 v122, v122
    s_waitcnt lgkmcnt(5)
    v_mfma_f32_32x32x16_bf16 v[168:183], v[208:211], v[48:51], v[168:183]
    ds_read_b128 v[200:203], v2 offset:45056
    v_exp_f32 v123, v123
    v_exp_f32 v124, v124
    v_exp_f32_e64 v125, v125
    v_mfma_f32_32x32x16_bf16 v[168:183], v[212:215], v[52:55], v[168:183]
    ds_read_b128 v[204:207], v2 offset:46080
    buffer_load_dwordx4 v1, s[12:15], s56 offen offset:2048 sc1 lds
    v_exp_f32 v126, v126
    s_waitcnt lgkmcnt(5)
    v_mfma_f32_32x32x16_bf16 v[168:183], v[184:187], v[56:59], v[168:183]
    ds_read_b128 v[208:211], v2 offset:47104
    v_exp_f32_e64 v127, v127
    v_fma_f32 v120, v120, v222, v222
    v_fma_f32 v121, v121, v222, v222
    v_fma_f32 v122, v122, v222, v222
    v_fma_f32 v123, v123, v222, v222
    v_mfma_f32_32x32x16_bf16 v[168:183], v[188:191], v[60:63], v[168:183]
    ds_read_b128 v[212:215], v2 offset:48128
    s_add_u32 m0, s52, 28672
    s_add_u32 s56, s53, 57344
    buffer_load_dwordx4 v1, s[12:15], s56 offen offset:0 sc1 lds
    v_fma_f32 v124, v124, v222, v222
    s_waitcnt lgkmcnt(4)
    v_mfma_f32_32x32x16_bf16 v[168:183], v[192:195], v[64:67], v[168:183]
    ds_read_b128 v[184:187], v2 offset:49152
    v_fma_f32 v125, v125, v222, v222
    v_fma_f32 v126, v126, v222, v222
    v_fma_f32 v127, v127, v222, v222
    v_rcp_f32 v120, v120
    v_mfma_f32_32x32x16_bf16 v[168:183], v[196:199], v[68:71], v[168:183]
    ds_read_b128 v[188:191], v2 offset:50176
    buffer_load_dwordx4 v1, s[12:15], s56 offen offset:1024 sc1 lds
    v_rcp_f32 v121, v121
    s_waitcnt lgkmcnt(4)
    v_mfma_f32_32x32x16_bf16 v[168:183], v[200:203], v[72:75], v[168:183]
    ds_read_b128 v[192:195], v2 offset:51200
    v_rcp_f32 v122, v122
    v_rcp_f32 v123, v123
    v_rcp_f32_e64 v124, v124
    v_mfma_f32_32x32x16_bf16 v[168:183], v[204:207], v[76:79], v[168:183]
    ds_read_b128 v[196:199], v2 offset:52224
    buffer_load_dwordx4 v1, s[12:15], s56 offen offset:2048 sc1 lds
    v_rcp_f32 v125, v125
    s_waitcnt lgkmcnt(4)
    v_mfma_f32_32x32x16_bf16 v[168:183], v[208:211], v[80:83], v[168:183]
    ds_read_b128 v[200:203], v2 offset:53248
    v_rcp_f32 v126, v126
    v_rcp_f32 v127, v127
    v_mul_f32 v120, v120, v128
    v_mul_f32 v121, v121, v129
    v_mfma_f32_32x32x16_bf16 v[168:183], v[212:215], v[84:87], v[168:183]
    ds_read_b128 v[204:207], v2 offset:54272
    buffer_load_dwordx4 v1, s[12:15], s56 offen offset:3072 sc1 lds
    v_mul_f32 v122, v122, v130
    v_mul_f32 v123, v123, v131
    v_mul_f32 v124, v124, v132
    s_waitcnt lgkmcnt(4)
    v_mfma_f32_32x32x16_bf16 v[168:183], v[184:187], v[88:91], v[168:183]
    ds_read_b128 v[208:211], v2 offset:55296
    v_mul_f32 v125, v125, v133
    v_mul_f32 v126, v126, v134
    v_mul_f32_e64 v127, v127, v135
    v_cvt_pk_bf16_f32 v232, v120, v121
    v_cvt_pk_bf16_f32 v233, v122, v123
    v_mfma_f32_32x32x16_bf16 v[168:183], v[188:191], v[92:95], v[168:183]
    ds_read_b128 v[212:215], v2 offset:56320
    s_add_u32 m0, s52, 32768
    s_add_u32 s56, s53, 61440
    buffer_load_dwordx4 v1, s[12:15], s56 offen offset:0 sc1 lds
    v_cvt_pk_bf16_f32 v234, v124, v125
    s_waitcnt lgkmcnt(4)
    v_mfma_f32_32x32x16_bf16 v[168:183], v[192:195], v[96:99], v[168:183]
    ds_read_b128 v[184:187], v251 offset:0
    v_cvt_pk_bf16_f32 v235, v126, v127
    buffer_store_dwordx4 v[232:235], v1, s[12:15], s101 offen offset:0 sc1
    v_mul_f32 v136, v220, v136
    v_mul_f32_e64 v137, v220, v137
    v_mfma_f32_32x32x16_bf16 v[168:183], v[196:199], v[100:103], v[168:183]
    ds_read_b128 v[188:191], v251 offset:1024
    buffer_load_dwordx4 v1, s[12:15], s56 offen offset:1024 sc1 lds
    v_mul_f32 v138, v220, v138
    v_mul_f32 v139, v220, v139
    v_mul_f32 v140, v220, v140
    s_waitcnt lgkmcnt(4)
    v_mfma_f32_32x32x16_bf16 v[168:183], v[200:203], v[104:107], v[168:183]
    ds_read_b128 v[192:195], v251 offset:2048
    v_mul_f32 v141, v220, v141
    v_mul_f32 v142, v220, v142
    v_mul_f32 v143, v220, v143
    v_exp_f32 v136, v136
    v_mfma_f32_32x32x16_bf16 v[168:183], v[204:207], v[108:111], v[168:183]
    ds_read_b128 v[196:199], v251 offset:3072
    buffer_load_dwordx4 v1, s[12:15], s56 offen offset:2048 sc1 lds
    v_exp_f32 v137, v137
    s_waitcnt lgkmcnt(4)
    v_mfma_f32_32x32x16_bf16 v[168:183], v[208:211], v[112:115], v[168:183]
    ds_read_b128 v[200:203], v251 offset:4096
    v_exp_f32 v138, v138
    v_exp_f32 v139, v139
    v_exp_f32_e64 v140, v140
    v_mfma_f32_32x32x16_bf16 v[168:183], v[212:215], v[116:119], v[168:183]
    ds_read_b128 v[204:207], v251 offset:5120
    v_mfma_f32_32x32x8bf16_1k v[168:183], v[230:231], v[218:219], v[168:183]
    s_waitcnt lgkmcnt(4)
    v_mfma_f32_32x32x16_bf16 v[120:135], v[184:187], v[8:11], 0
    ds_read_b128 v[208:211], v251 offset:6144
    v_exp_f32 v141, v141
    v_exp_f32_e64 v142, v142
    v_mfma_f32_32x32x16_bf16 v[120:135], v[188:191], v[12:15], v[120:135]
    ds_read_b128 v[212:215], v251 offset:7168
    buffer_load_dwordx4 a[148:151], v253, s[12:15], s33 offen offset:0 sc1
    v_exp_f32_e64 v143, v143
    v_fma_f32 v136, v136, v222, v222
    v_fma_f32 v137, v137, v222, v222
    s_waitcnt lgkmcnt(4)
    v_mfma_f32_32x32x16_bf16 v[120:135], v[192:195], v[16:19], v[120:135]
    ds_read_b128 v[184:187], v251 offset:8192
    v_fma_f32 v138, v138, v222, v222
    v_fma_f32 v139, v139, v222, v222
    v_fma_f32 v140, v140, v222, v222
    v_fma_f32 v141, v141, v222, v222
    v_fma_f32 v142, v142, v222, v222
    v_mfma_f32_32x32x16_bf16 v[120:135], v[196:199], v[20:23], v[120:135]
    ds_read_b128 v[188:191], v251 offset:9216
    buffer_load_dwordx4 a[152:155], v252, s[12:15], s33 offen offset:2048 sc1
    v_fma_f32 v143, v143, v222, v222
    v_rcp_f32 v136, v136
    s_waitcnt lgkmcnt(4)
    v_mfma_f32_32x32x16_bf16 v[120:135], v[200:203], v[24:27], v[120:135]
    ds_read_b128 v[192:195], v251 offset:10240
    v_rcp_f32 v137, v137
    v_rcp_f32_e64 v138, v138
    v_mfma_f32_32x32x16_bf16 v[120:135], v[204:207], v[28:31], v[120:135]
    ds_read_b128 v[196:199], v251 offset:11264
    buffer_load_dwordx4 a[156:159], v253, s[12:15], s33 offen offset:2048 sc1
    s_add_u32 s33, s33, 4096
    v_rcp_f32 v139, v139
    s_waitcnt lgkmcnt(4)
    v_mfma_f32_32x32x16_bf16 v[120:135], v[208:211], v[32:35], v[120:135]
    ds_read_b128 v[200:203], v251 offset:12288
    v_rcp_f32 v140, v140
    v_rcp_f32 v141, v141
    v_rcp_f32_e64 v142, v142
    v_mfma_f32_32x32x16_bf16 v[120:135], v[212:215], v[36:39], v[120:135]
    ds_read_b128 v[204:207], v251 offset:13312
    buffer_load_dwordx4 a[160:163], v252, s[12:15], s33 offen offset:0 sc1
    v_rcp_f32_e64 v143, v143
    v_mul_f32 v136, v136, v144
    s_waitcnt lgkmcnt(4)
    v_mfma_f32_32x32x16_bf16 v[120:135], v[184:187], v[40:43], v[120:135]
    ds_read_b128 v[208:211], v251 offset:14336
    ds_read_b64 v[226:227], v3 offset:2560
    v_mul_f32 v137, v137, v145
    v_mul_f32 v138, v138, v146
    v_mul_f32 v139, v139, v147
    v_mul_f32 v140, v140, v148
    v_mul_f32_e64 v141, v141, v149
    v_mfma_f32_32x32x16_bf16 v[120:135], v[188:191], v[44:47], v[120:135]
    ds_read_b128 v[212:215], v251 offset:15360
    buffer_load_dwordx4 a[164:167], v253, s[12:15], s33 offen offset:0 sc1
    v_mul_f32 v142, v142, v150
    v_mul_f32 v143, v143, v151
    v_cvt_pk_bf16_f32 v236, v136, v137
    s_waitcnt lgkmcnt(5)
    v_mfma_f32_32x32x16_bf16 v[120:135], v[192:195], v[48:51], v[120:135]
    ds_read_b128 v[184:187], v251 offset:16384
    v_cvt_pk_bf16_f32 v237, v138, v139
    v_cvt_pk_bf16_f32 v238, v140, v141
    v_cvt_pk_bf16_f32 v239, v142, v143
    buffer_store_dwordx4 v[236:239], v1, s[12:15], s101 offen offset:1024 sc1
    v_mfma_f32_32x32x16_bf16 v[120:135], v[196:199], v[52:55], v[120:135]
    ds_read_b128 v[188:191], v251 offset:17408
    buffer_load_dwordx4 a[168:171], v252, s[12:15], s33 offen offset:2048 sc1
    v_mul_f32 v152, v220, v152
    v_mul_f32_e64 v153, v220, v153
    v_mul_f32 v154, v220, v154
    s_waitcnt lgkmcnt(5)
    v_mfma_f32_32x32x16_bf16 v[120:135], v[200:203], v[56:59], v[120:135]
    ds_read_b128 v[192:195], v251 offset:18432
    v_mul_f32 v155, v220, v155
    v_mul_f32 v156, v220, v156
    v_mul_f32 v157, v220, v157
    v_mul_f32 v158, v220, v158
    v_mul_f32_e64 v159, v220, v159
    v_mfma_f32_32x32x16_bf16 v[120:135], v[204:207], v[60:63], v[120:135]
    ds_read_b128 v[196:199], v251 offset:19456
    buffer_load_dwordx4 a[172:175], v253, s[12:15], s33 offen offset:2048 sc1
    s_add_u32 s33, s33, 4096
    v_exp_f32 v152, v152
    s_waitcnt lgkmcnt(4)
    v_mfma_f32_32x32x16_bf16 v[120:135], v[208:211], v[64:67], v[120:135]
    ds_read_b128 v[200:203], v251 offset:20480
    v_exp_f32 v153, v153
    v_exp_f32 v154, v154
    v_mfma_f32_32x32x16_bf16 v[120:135], v[212:215], v[68:71], v[120:135]
    ds_read_b128 v[204:207], v251 offset:21504
    buffer_load_dwordx4 a[176:179], v252, s[12:15], s33 offen offset:0 sc1
    v_exp_f32_e64 v155, v155
    v_exp_f32 v156, v156
    s_waitcnt lgkmcnt(4)
    v_mfma_f32_32x32x16_bf16 v[120:135], v[184:187], v[72:75], v[120:135]
    ds_read_b128 v[208:211], v251 offset:22528
    v_exp_f32 v157, v157
    v_exp_f32 v158, v158
    v_mfma_f32_32x32x16_bf16 v[120:135], v[188:191], v[76:79], v[120:135]
    ds_read_b128 v[212:215], v251 offset:23552
    buffer_load_dwordx4 a[180:183], v253, s[12:15], s33 offen offset:0 sc1
    v_exp_f32_e64 v159, v159
    v_fma_f32 v152, v152, v222, v222
    v_fma_f32 v153, v153, v222, v222
    s_waitcnt lgkmcnt(4)
    v_mfma_f32_32x32x16_bf16 v[120:135], v[192:195], v[80:83], v[120:135]
    ds_read_b128 v[184:187], v251 offset:24576
    v_fma_f32 v154, v154, v222, v222
    v_fma_f32 v155, v155, v222, v222
    v_fma_f32 v156, v156, v222, v222
    v_fma_f32 v157, v157, v222, v222
    v_fma_f32 v158, v158, v222, v222
    v_mfma_f32_32x32x16_bf16 v[120:135], v[196:199], v[84:87], v[120:135]
    ds_read_b128 v[188:191], v251 offset:25600
    buffer_load_dwordx4 a[184:187], v252, s[12:15], s33 offen offset:2048 sc1
    v_fma_f32 v159, v159, v222, v222
    v_rcp_f32 v152, v152
    s_waitcnt lgkmcnt(4)
    v_mfma_f32_32x32x16_bf16 v[120:135], v[200:203], v[88:91], v[120:135]
    ds_read_b128 v[192:195], v251 offset:26624
    v_rcp_f32 v153, v153
    v_rcp_f32_e64 v154, v154
    v_mfma_f32_32x32x16_bf16 v[120:135], v[204:207], v[92:95], v[120:135]
    ds_read_b128 v[196:199], v251 offset:27648
    buffer_load_dwordx4 a[188:191], v253, s[12:15], s33 offen offset:2048 sc1
    s_add_u32 s33, s33, 4096
    v_rcp_f32 v155, v155
    s_waitcnt vmcnt(12)
    s_barrier
    s_waitcnt lgkmcnt(4)
    v_mfma_f32_32x32x16_bf16 v[120:135], v[208:211], v[96:99], v[120:135]
    ds_read_b128 v[200:203], v1 offset:0
    v_rcp_f32 v156, v156
    v_rcp_f32 v157, v157
    v_rcp_f32_e64 v158, v158
    v_mfma_f32_32x32x16_bf16 v[120:135], v[212:215], v[100:103], v[120:135]
    ds_read_b128 v[204:207], v1 offset:1024
    buffer_load_dwordx4 a[192:195], v252, s[12:15], s33 offen offset:0 sc1
    v_rcp_f32_e64 v159, v159
    v_mul_f32 v152, v152, v160
    s_waitcnt lgkmcnt(4)
    v_mfma_f32_32x32x16_bf16 v[120:135], v[184:187], v[104:107], v[120:135]
    ds_read_b128 v[208:211], v1 offset:2048
    v_mul_f32 v153, v153, v161
    v_mul_f32 v154, v154, v162
    v_mul_f32 v155, v155, v163
    v_mul_f32 v156, v156, v164
    v_mul_f32_e64 v157, v157, v165
    v_mfma_f32_32x32x16_bf16 v[120:135], v[188:191], v[108:111], v[120:135]
    ds_read_b128 v[212:215], v1 offset:3072
    buffer_load_dwordx4 a[196:199], v253, s[12:15], s33 offen offset:0 sc1
    v_mul_f32 v158, v158, v166
    v_mul_f32 v159, v159, v167
    v_cvt_pk_bf16_f32 v232, v152, v153
    s_waitcnt lgkmcnt(4)
    v_mfma_f32_32x32x16_bf16 v[120:135], v[192:195], v[112:115], v[120:135]
    ds_read_b128 v[184:187], v1 offset:4096
    v_cvt_pk_bf16_f32 v233, v154, v155
    v_cvt_pk_bf16_f32 v234, v156, v157
    v_cvt_pk_bf16_f32 v235, v158, v159
    buffer_store_dwordx4 v[232:235], v1, s[12:15], s101 offen offset:2048 sc1
    v_mfma_f32_32x32x16_bf16 v[120:135], v[196:199], v[116:119], v[120:135]
    ds_read_b128 v[188:191], v1 offset:5120
    v_mfma_f32_32x32x8bf16_1k v[120:135], v[224:225], v[218:219], v[120:135]
    s_waitcnt lgkmcnt(4)
    v_mfma_f32_32x32x16_bf16 v[136:151], v[200:203], v[8:11], 0
    ds_read_b128 v[192:195], v1 offset:6144
    v_mul_f32 v168, v220, v168
    v_mul_f32 v169, v220, v169
    v_mul_f32 v170, v220, v170
    v_mul_f32 v171, v220, v171
    v_mul_f32_e64 v172, v220, v172
    v_mfma_f32_32x32x16_bf16 v[136:151], v[204:207], v[12:15], v[136:151]
    ds_read_b128 v[196:199], v1 offset:7168
    buffer_load_dwordx4 a[200:203], v252, s[12:15], s33 offen offset:2048 sc1
    v_mul_f32 v173, v220, v173
    v_mul_f32 v174, v220, v174
    v_mul_f32 v175, v220, v175
    s_waitcnt lgkmcnt(4)
    v_mfma_f32_32x32x16_bf16 v[136:151], v[208:211], v[16:19], v[136:151]
    ds_read_b128 v[200:203], v1 offset:8192
    v_exp_f32 v168, v168
    v_exp_f32 v169, v169
    v_mfma_f32_32x32x16_bf16 v[136:151], v[212:215], v[20:23], v[136:151]
    ds_read_b128 v[204:207], v1 offset:9216
    buffer_load_dwordx4 a[204:207], v253, s[12:15], s33 offen offset:2048 sc1
    s_add_u32 s33, s33, 4096
    v_exp_f32 v170, v170
    s_waitcnt lgkmcnt(4)
    v_mfma_f32_32x32x16_bf16 v[136:151], v[184:187], v[24:27], v[136:151]
    ds_read_b128 v[208:211], v1 offset:10240
    v_exp_f32 v171, v171
    v_exp_f32 v172, v172
    v_exp_f32_e64 v173, v173
    v_mfma_f32_32x32x16_bf16 v[136:151], v[188:191], v[28:31], v[136:151]
    ds_read_b128 v[212:215], v1 offset:11264
    buffer_load_dwordx4 a[208:211], v252, s[12:15], s33 offen offset:0 sc1
    v_exp_f32 v174, v174
    s_waitcnt lgkmcnt(4)
    v_mfma_f32_32x32x16_bf16 v[136:151], v[192:195], v[32:35], v[136:151]
    ds_read_b128 v[184:187], v1 offset:12288
    v_exp_f32_e64 v175, v175
    v_fma_f32 v168, v168, v222, v222
    v_fma_f32 v169, v169, v222, v222
    v_fma_f32 v170, v170, v222, v222
    v_fma_f32 v171, v171, v222, v222
    v_mfma_f32_32x32x16_bf16 v[136:151], v[196:199], v[36:39], v[136:151]
    ds_read_b128 v[188:191], v1 offset:13312
    buffer_load_dwordx4 a[212:215], v253, s[12:15], s33 offen offset:0 sc1
    v_fma_f32 v172, v172, v222, v222
    v_fma_f32 v173, v173, v222, v222
    v_fma_f32 v174, v174, v222, v222
    s_waitcnt lgkmcnt(4)
    v_mfma_f32_32x32x16_bf16 v[136:151], v[200:203], v[40:43], v[136:151]
    ds_read_b128 v[192:195], v1 offset:14336
    ds_read_b64 v[228:229], v3 offset:3072
    v_fma_f32 v175, v175, v222, v222
    v_rcp_f32 v168, v168
    v_rcp_f32_e64 v169, v169
    v_mfma_f32_32x32x16_bf16 v[136:151], v[204:207], v[44:47], v[136:151]
    ds_read_b128 v[196:199], v1 offset:15360
    buffer_load_dwordx4 a[216:219], v252, s[12:15], s33 offen offset:2048 sc1
    v_rcp_f32 v170, v170
    s_waitcnt lgkmcnt(5)
    v_mfma_f32_32x32x16_bf16 v[136:151], v[208:211], v[48:51], v[136:151]
    ds_read_b128 v[200:203], v1 offset:16384
    v_rcp_f32 v171, v171
    v_rcp_f32 v172, v172
    v_rcp_f32_e64 v173, v173
    v_mfma_f32_32x32x16_bf16 v[136:151], v[212:215], v[52:55], v[136:151]
    ds_read_b128 v[204:207], v1 offset:17408
    buffer_load_dwordx4 a[220:223], v253, s[12:15], s33 offen offset:2048 sc1
    s_add_u32 s33, s33, 4096
    v_rcp_f32 v174, v174
    s_waitcnt lgkmcnt(5)
    v_mfma_f32_32x32x16_bf16 v[136:151], v[184:187], v[56:59], v[136:151]
    ds_read_b128 v[208:211], v1 offset:18432
    v_rcp_f32 v175, v175
    v_mul_f32 v168, v168, v176
    v_mul_f32 v169, v169, v177
    v_mul_f32 v170, v170, v178
    v_mfma_f32_32x32x16_bf16 v[136:151], v[188:191], v[60:63], v[136:151]
    ds_read_b128 v[212:215], v1 offset:19456
    v_mul_f32 v171, v171, v179
    v_mul_f32 v172, v172, v180
    v_mul_f32 v173, v173, v181
    v_mul_f32 v174, v174, v182
    v_mul_f32 v175, v175, v183
    s_waitcnt lgkmcnt(4)
    v_mfma_f32_32x32x16_bf16 v[136:151], v[192:195], v[64:67], v[136:151]
    ds_read_b128 v[184:187], v1 offset:20480
    v_cvt_pk_bf16_f32 v236, v168, v169
    v_cvt_pk_bf16_f32 v237, v170, v171
    v_cvt_pk_bf16_f32 v238, v172, v173
    v_cvt_pk_bf16_f32 v239, v174, v175
    v_mfma_f32_32x32x16_bf16 v[136:151], v[196:199], v[68:71], v[136:151]
    ds_read_b128 v[188:191], v1 offset:21504
    buffer_store_dwordx4 v[236:239], v1, s[12:15], s101 offen offset:3072 sc1
    v_mul_f32 v120, v220, v120
    v_mul_f32 v121, v220, v121
    v_mul_f32_e64 v122, v220, v122
    v_mul_f32 v123, v220, v123
    s_waitcnt lgkmcnt(4)
    v_mfma_f32_32x32x16_bf16 v[136:151], v[200:203], v[72:75], v[136:151]
    ds_read_b128 v[192:195], v1 offset:22528
    v_mul_f32 v124, v220, v124
    v_mul_f32 v125, v220, v125
    v_mul_f32 v126, v220, v126
    v_mul_f32 v127, v220, v127
    v_mfma_f32_32x32x16_bf16 v[136:151], v[204:207], v[76:79], v[136:151]
    ds_read_b128 v[196:199], v1 offset:23552
    v_exp_f32 v120, v120
    v_exp_f32 v121, v121
    v_exp_f32 v122, v122
    s_waitcnt lgkmcnt(4)
    v_mfma_f32_32x32x16_bf16 v[136:151], v[208:211], v[80:83], v[136:151]
    ds_read_b128 v[200:203], v1 offset:24576
    v_exp_f32 v123, v123
    v_exp_f32 v124, v124
    v_mfma_f32_32x32x16_bf16 v[136:151], v[212:215], v[84:87], v[136:151]
    ds_read_b128 v[204:207], v1 offset:25600
    v_exp_f32 v125, v125
    v_exp_f32 v126, v126
    v_exp_f32 v127, v127
    s_waitcnt lgkmcnt(4)
    v_mfma_f32_32x32x16_bf16 v[136:151], v[184:187], v[88:91], v[136:151]
    ds_read_b128 v[208:211], v1 offset:26624
    v_fma_f32 v120, v120, v222, v222
    v_fma_f32 v121, v121, v222, v222
    v_fma_f32 v122, v122, v222, v222
    v_fma_f32 v123, v123, v222, v222
    v_fma_f32 v124, v124, v222, v222
    v_mfma_f32_32x32x16_bf16 v[136:151], v[188:191], v[92:95], v[136:151]
    ds_read_b128 v[212:215], v1 offset:27648
    v_fma_f32 v125, v125, v222, v222
    v_fma_f32 v126, v126, v222, v222
    v_fma_f32 v127, v127, v222, v222
    v_rcp_f32 v120, v120
    s_waitcnt lgkmcnt(4)
    v_mfma_f32_32x32x16_bf16 v[136:151], v[192:195], v[96:99], v[136:151]
    ds_read_b128 v[184:187], v1 offset:28672
    v_rcp_f32 v121, v121
    v_rcp_f32 v122, v122
    v_mfma_f32_32x32x16_bf16 v[136:151], v[196:199], v[100:103], v[136:151]
    ds_read_b128 v[188:191], v1 offset:29696
    v_rcp_f32 v123, v123
    v_rcp_f32 v124, v124
    v_rcp_f32 v125, v125
    s_waitcnt lgkmcnt(4)
    v_mfma_f32_32x32x16_bf16 v[136:151], v[200:203], v[104:107], v[136:151]
    ds_read_b128 v[192:195], v1 offset:30720
    v_rcp_f32 v126, v126
    v_rcp_f32 v127, v127
    v_mul_f32_e64 v120, v120, v128
    v_mfma_f32_32x32x16_bf16 v[136:151], v[204:207], v[108:111], v[136:151]
    ds_read_b128 v[196:199], v1 offset:31744
    v_mul_f32 v121, v121, v129
    v_mul_f32 v122, v122, v130
    v_mul_f32 v123, v123, v131
    v_mul_f32 v124, v124, v132
    v_mul_f32 v125, v125, v133
    s_waitcnt lgkmcnt(4)
    v_mfma_f32_32x32x16_bf16 v[136:151], v[208:211], v[112:115], v[136:151]
    ds_read_b128 v[200:203], v1 offset:32768
    v_mul_f32 v126, v126, v134
    v_mul_f32 v127, v127, v135
    v_cvt_pk_bf16_f32 v232, v120, v121
    v_cvt_pk_bf16_f32 v233, v122, v123
    v_cvt_pk_bf16_f32 v234, v124, v125
    v_mfma_f32_32x32x16_bf16 v[136:151], v[212:215], v[116:119], v[136:151]
    ds_read_b128 v[204:207], v1 offset:33792
    v_mfma_f32_32x32x8bf16_1k v[136:151], v[226:227], v[218:219], v[136:151]
    s_waitcnt lgkmcnt(4)
    v_mfma_f32_32x32x16_bf16 v[152:167], v[184:187], v[8:11], 0
    ds_read_b128 v[208:211], v1 offset:34816
    v_cvt_pk_bf16_f32 v235, v126, v127
    s_add_u32 s101, s101, 4096
    buffer_store_dwordx4 v[232:235], v1, s[12:15], s101 offen offset:0 sc1
    s_nop 5
    v_mul_f32_e64 v136, v220, v136
    v_mfma_f32_32x32x16_bf16 v[152:167], v[188:191], v[12:15], v[152:167]
    ds_read_b128 v[212:215], v1 offset:35840
    v_mul_f32 v137, v220, v137
    v_mul_f32 v138, v220, v138
    v_mul_f32 v139, v220, v139
    v_mul_f32 v140, v220, v140
    v_mul_f32 v141, v220, v141
    s_waitcnt lgkmcnt(4)
    v_mfma_f32_32x32x16_bf16 v[152:167], v[192:195], v[16:19], v[152:167]
    ds_read_b128 v[184:187], v1 offset:36864
    v_mul_f32 v142, v220, v142
    v_mul_f32 v143, v220, v143
    v_exp_f32_e64 v136, v136
    v_mfma_f32_32x32x16_bf16 v[152:167], v[196:199], v[20:23], v[152:167]
    ds_read_b128 v[188:191], v1 offset:37888
    v_exp_f32 v137, v137
    v_exp_f32 v138, v138
    v_exp_f32 v139, v139
    s_waitcnt lgkmcnt(4)
    v_mfma_f32_32x32x16_bf16 v[152:167], v[200:203], v[24:27], v[152:167]
    ds_read_b128 v[192:195], v1 offset:38912
    buffer_load_dwordx4 v[8:11], v1, s[12:15], s78 offen offset:0 sc1
    v_exp_f32_e64 v140, v140
    v_mfma_f32_32x32x16_bf16 v[152:167], v[204:207], v[28:31], v[152:167]
    ds_read_b128 v[196:199], v1 offset:39936
    v_exp_f32 v141, v141
    v_exp_f32 v142, v142
    v_exp_f32 v143, v143
    s_waitcnt lgkmcnt(4)
    v_mfma_f32_32x32x16_bf16 v[152:167], v[208:211], v[32:35], v[152:167]
    ds_read_b128 v[200:203], v1 offset:40960
    buffer_load_dwordx4 v[12:15], v1, s[12:15], s79 offen offset:0 sc1
    v_fma_f32 v136, v136, v222, v222
    v_fma_f32 v137, v137, v222, v222
    v_fma_f32 v138, v138, v222, v222
    v_mfma_f32_32x32x16_bf16 v[152:167], v[212:215], v[36:39], v[152:167]
    ds_read_b128 v[204:207], v1 offset:41984
    v_fma_f32 v139, v139, v222, v222
    v_fma_f32 v140, v140, v222, v222
    v_fma_f32 v141, v141, v222, v222
    v_fma_f32 v142, v142, v222, v222
    v_fma_f32 v143, v143, v222, v222
    s_waitcnt lgkmcnt(4)
    v_mfma_f32_32x32x16_bf16 v[152:167], v[184:187], v[40:43], v[152:167]
    ds_read_b128 v[208:211], v1 offset:43008
    buffer_load_dwordx4 v[16:19], v1, s[12:15], s80 offen offset:0 sc1
    v_rcp_f32 v136, v136
    v_mfma_f32_32x32x16_bf16 v[152:167], v[188:191], v[44:47], v[152:167]
    ds_read_b128 v[212:215], v1 offset:44032
    v_rcp_f32 v137, v137
    v_rcp_f32 v138, v138
    v_rcp_f32 v139, v139
    s_waitcnt lgkmcnt(4)
    v_mfma_f32_32x32x16_bf16 v[152:167], v[192:195], v[48:51], v[152:167]
    ds_read_b128 v[184:187], v1 offset:45056
    buffer_load_dwordx4 v[20:23], v1, s[12:15], s81 offen offset:0 sc1
    v_rcp_f32_e64 v140, v140
    v_mfma_f32_32x32x16_bf16 v[152:167], v[196:199], v[52:55], v[152:167]
    ds_read_b128 v[188:191], v1 offset:46080
    v_rcp_f32 v141, v141
    v_rcp_f32 v142, v142
    v_rcp_f32 v143, v143
    s_waitcnt lgkmcnt(4)
    v_mfma_f32_32x32x16_bf16 v[152:167], v[200:203], v[56:59], v[152:167]
    ds_read_b128 v[192:195], v1 offset:47104
    buffer_load_dwordx4 v[24:27], v1, s[12:15], s82 offen offset:0 sc1
    v_mul_f32 v136, v136, v144
    v_mul_f32 v137, v137, v145
    v_mul_f32_e64 v138, v138, v146
    v_mfma_f32_32x32x16_bf16 v[152:167], v[204:207], v[60:63], v[152:167]
    ds_read_b128 v[196:199], v1 offset:48128
    buffer_load_dwordx4 v[28:31], v1, s[12:15], s83 offen offset:0 sc1
    v_mul_f32 v139, v139, v147
    v_mul_f32 v140, v140, v148
    v_mul_f32 v141, v141, v149
    s_waitcnt lgkmcnt(4)
    v_mfma_f32_32x32x16_bf16 v[152:167], v[208:211], v[64:67], v[152:167]
    ds_read_b128 v[200:203], v1 offset:49152
    v_mul_f32 v142, v142, v150
    v_mul_f32 v143, v143, v151
    v_cvt_pk_bf16_f32 v236, v136, v137
    v_cvt_pk_bf16_f32 v237, v138, v139
    v_cvt_pk_bf16_f32 v238, v140, v141
    v_mfma_f32_32x32x16_bf16 v[152:167], v[212:215], v[68:71], v[152:167]
    ds_read_b128 v[204:207], v1 offset:50176
    buffer_load_dwordx4 v[32:35], v1, s[12:15], s84 offen offset:0 sc1
    v_cvt_pk_bf16_f32 v239, v142, v143
    buffer_store_dwordx4 v[236:239], v1, s[12:15], s101 offen offset:1024 sc1
    s_waitcnt lgkmcnt(4)
    v_mfma_f32_32x32x16_bf16 v[152:167], v[184:187], v[72:75], v[152:167]
    ds_read_b128 v[208:211], v1 offset:51200
    v_mfma_f32_32x32x16_bf16 v[152:167], v[188:191], v[76:79], v[152:167]
    ds_read_b128 v[212:215], v1 offset:52224
    buffer_load_dwordx4 v[36:39], v1, s[12:15], s85 offen offset:0 sc1
    s_waitcnt lgkmcnt(4)
    v_mfma_f32_32x32x16_bf16 v[152:167], v[192:195], v[80:83], v[152:167]
    ds_read_b128 v[184:187], v1 offset:53248
    v_mfma_f32_32x32x16_bf16 v[152:167], v[196:199], v[84:87], v[152:167]
    ds_read_b128 v[188:191], v1 offset:54272
    buffer_load_dwordx4 v[40:43], v1, s[12:15], s78 offen offset:1024 sc1
    s_waitcnt lgkmcnt(4)
    v_mfma_f32_32x32x16_bf16 v[152:167], v[200:203], v[88:91], v[152:167]
    ds_read_b128 v[192:195], v1 offset:55296
    v_mfma_f32_32x32x16_bf16 v[152:167], v[204:207], v[92:95], v[152:167]
    ds_read_b128 v[196:199], v1 offset:56320
    buffer_load_dwordx4 v[44:47], v1, s[12:15], s79 offen offset:1024 sc1
    s_waitcnt lgkmcnt(4)
    v_mfma_f32_32x32x16_bf16 v[152:167], v[208:211], v[96:99], v[152:167]
    buffer_load_dwordx4 v[48:51], v1, s[12:15], s80 offen offset:1024 sc1
    v_mfma_f32_32x32x16_bf16 v[152:167], v[212:215], v[100:103], v[152:167]
    s_waitcnt lgkmcnt(2)
    v_mfma_f32_32x32x16_bf16 v[152:167], v[184:187], v[104:107], v[152:167]
    buffer_load_dwordx4 v[52:55], v1, s[12:15], s81 offen offset:1024 sc1
    v_mfma_f32_32x32x16_bf16 v[152:167], v[188:191], v[108:111], v[152:167]
    s_waitcnt lgkmcnt(0)
    v_mfma_f32_32x32x16_bf16 v[152:167], v[192:195], v[112:115], v[152:167]
    buffer_load_dwordx4 v[56:59], v1, s[12:15], s82 offen offset:1024 sc1
    v_mfma_f32_32x32x16_bf16 v[152:167], v[196:199], v[116:119], v[152:167]
    v_mfma_f32_32x32x8bf16_1k v[152:167], v[228:229], v[218:219], v[152:167]
    s_cmp_ge_u32 s89, 14
    s_cbranch_scc1 L_tail
    s_waitcnt vmcnt(10)
    v_max3_u32 v247, v8, v12, v16
    v_max_u32 v247, v247, v20
    v_cmp_eq_u32 vcc, -1, v247
    s_cbranch_vccnz L_rs_45
L_rok_46:
    v_mfma_f32_32x32x16_bf16 v[184:199], a[0:3], v[8:11], 0
    buffer_load_dwordx4 v[60:63], v1, s[12:15], s83 offen offset:1024 sc1
    v_accvgpr_read_b32 v168, a224
    v_accvgpr_read_b32 v169, a225
    v_accvgpr_read_b32 v170, a226
    v_accvgpr_read_b32 v171, a227
    v_accvgpr_read_b32 v172, a228
    v_mfma_f32_32x32x16_bf16 v[120:135], a[4:7], v[8:11], 0
    v_accvgpr_read_b32 v173, a229
    v_accvgpr_read_b32 v174, a230
    v_accvgpr_read_b32 v175, a231
    v_accvgpr_read_b32 v176, a232
    v_accvgpr_read_b32 v177, a233
    v_accvgpr_read_b32 v178, a234
    v_mfma_f32_32x32x16_bf16 v[184:199], a[56:59], v[12:15], v[184:199]
    buffer_load_dwordx4 v[64:67], v1, s[12:15], s84 offen offset:1024 sc1
    v_accvgpr_read_b32 v179, a235
    v_accvgpr_read_b32 v180, a236
    v_accvgpr_read_b32 v181, a237
    v_accvgpr_read_b32 v182, a238
    v_mfma_f32_32x32x16_bf16 v[120:135], a[60:63], v[12:15], v[120:135]
    buffer_load_dwordx4 v[68:71], v1, s[12:15], s85 offen offset:1024 sc1
    v_accvgpr_read_b32 v183, a239
    v_mul_f32 v152, v220, v152
    v_mul_f32 v153, v220, v153
    v_mul_f32_e64 v154, v220, v154
    v_mfma_f32_32x32x16_bf16 v[184:199], a[112:115], v[16:19], v[184:199]
    v_mul_f32 v155, v220, v155
    v_mul_f32 v156, v220, v156
    v_mul_f32 v157, v220, v157
    v_mul_f32 v158, v220, v158
    v_mul_f32_e64 v159, v220, v159
    v_mfma_f32_32x32x16_bf16 v[120:135], a[116:119], v[16:19], v[120:135]
    buffer_load_dwordx4 v[72:75], v1, s[12:15], s78 offen offset:2048 sc1
    v_exp_f32 v152, v152
    v_exp_f32 v153, v153
    v_mfma_f32_32x32x16_bf16 v[184:199], a[168:171], v[20:23], v[184:199]
    v_exp_f32 v154, v154
    v_exp_f32 v155, v155
    v_exp_f32_e64 v156, v156
    v_mfma_f32_32x32x16_bf16 v[120:135], a[172:175], v[20:23], v[120:135]
    buffer_load_dwordx4 v[76:79], v1, s[12:15], s79 offen offset:2048 sc1
    v_exp_f32_e64 v157, v157
    v_exp_f32 v158, v158
    s_waitcnt vmcnt(10)
    v_max3_u32 v247, v24, v28, v32
    v_max_u32 v247, v247, v36
    v_cmp_eq_u32 vcc, -1, v247
    s_cbranch_vccnz L_rs_47
L_rok_48:
    v_mfma_f32_32x32x16_bf16 v[136:151], a[0:3], v[24:27], 0
    v_exp_f32 v159, v159
    v_fma_f32 v152, v152, v222, v222
    v_fma_f32 v153, v153, v222, v222
    v_fma_f32 v154, v154, v222, v222
    v_fma_f32 v155, v155, v222, v222
    v_fma_f32 v156, v156, v222, v222
    v_mfma_f32_32x32x16_bf16 v[168:183], a[4:7], v[24:27], v[168:183]
    buffer_load_dwordx4 v[80:83], v1, s[12:15], s80 offen offset:2048 sc1
    v_fma_f32 v157, v157, v222, v222
    v_fma_f32 v158, v158, v222, v222
    v_fma_f32 v159, v159, v222, v222
    v_mfma_f32_32x32x16_bf16 v[136:151], a[56:59], v[28:31], v[136:151]
    v_rcp_f32 v152, v152
    v_rcp_f32 v153, v153
    v_rcp_f32_e64 v154, v154
    v_mfma_f32_32x32x16_bf16 v[168:183], a[60:63], v[28:31], v[168:183]
    buffer_load_dwordx4 v[84:87], v1, s[12:15], s81 offen offset:2048 sc1
    v_rcp_f32 v155, v155
    v_rcp_f32 v156, v156
    v_mfma_f32_32x32x16_bf16 v[136:151], a[112:115], v[32:35], v[136:151]
    buffer_load_dwordx4 v[88:91], v1, s[12:15], s82 offen offset:2048 sc1
    v_rcp_f32 v157, v157
    v_rcp_f32 v158, v158
    v_mfma_f32_32x32x16_bf16 v[168:183], a[116:119], v[32:35], v[168:183]
    v_rcp_f32 v159, v159
    v_mul_f32 v152, v152, v160
    v_mul_f32 v153, v153, v161
    v_mul_f32 v154, v154, v162
    v_mul_f32 v155, v155, v163
    v_mul_f32 v156, v156, v164
    v_mfma_f32_32x32x16_bf16 v[136:151], a[168:171], v[36:39], v[136:151]
    buffer_load_dwordx4 v[92:95], v1, s[12:15], s83 offen offset:2048 sc1
    v_mul_f32 v157, v157, v165
    v_mul_f32 v158, v158, v166
    v_mul_f32_e64 v159, v159, v167
    v_cvt_pk_bf16_f32 v232, v152, v153
    v_mfma_f32_32x32x16_bf16 v[168:183], a[172:175], v[36:39], v[168:183]
    v_cvt_pk_bf16_f32 v233, v154, v155
    v_cvt_pk_bf16_f32 v234, v156, v157
    v_cvt_pk_bf16_f32 v235, v158, v159
    buffer_store_dwordx4 v[232:235], v1, s[12:15], s101 offen offset:2048 sc1
    s_waitcnt vmcnt(11)
    v_max3_u32 v247, v40, v44, v48
    v_max_u32 v247, v247, v52
    v_cmp_eq_u32 vcc, -1, v247
    s_cbranch_vccnz L_rs_49
L_rok_50:
    v_mfma_f32_32x32x16_bf16 v[184:199], a[8:11], v[40:43], v[184:199]
    buffer_load_dwordx4 v[96:99], v1, s[12:15], s84 offen offset:2048 sc1
    v_mfma_f32_32x32x16_bf16 v[120:135], a[12:15], v[40:43], v[120:135]
    v_mfma_f32_32x32x16_bf16 v[184:199], a[64:67], v[44:47], v[184:199]
    buffer_load_dwordx4 v[100:103], v1, s[12:15], s85 offen offset:2048 sc1
    v_mfma_f32_32x32x16_bf16 v[120:135], a[68:71], v[44:47], v[120:135]
    v_mfma_f32_32x32x16_bf16 v[184:199], a[120:123], v[48:51], v[184:199]
    buffer_load_dwordx4 v[104:107], v1, s[12:15], s78 offen offset:3072 sc1
    s_add_u32 s78, s78, 4096
    v_mfma_f32_32x32x16_bf16 v[120:135], a[124:127], v[48:51], v[120:135]
    buffer_load_dwordx4 v[108:111], v1, s[12:15], s79 offen offset:3072 sc1
    s_add_u32 s79, s79, 4096
    v_mfma_f32_32x32x16_bf16 v[184:199], a[176:179], v[52:55], v[184:199]
    v_mfma_f32_32x32x16_bf16 v[120:135], a[180:183], v[52:55], v[120:135]
    buffer_load_dwordx4 v[112:115], v1, s[12:15], s80 offen offset:3072 sc1
    s_add_u32 s80, s80, 4096
    s_waitcnt vmcnt(12)
    v_max3_u32 v247, v56, v60, v64
    v_max_u32 v247, v247, v68
    v_cmp_eq_u32 vcc, -1, v247
    s_cbranch_vccnz L_rs_51
L_rok_52:
    v_mfma_f32_32x32x16_bf16 v[136:151], a[8:11], v[56:59], v[136:151]
    v_mfma_f32_32x32x16_bf16 v[168:183], a[12:15], v[56:59], v[168:183]
    buffer_load_dwordx4 v[116:119], v1, s[12:15], s81 offen offset:3072 sc1
    s_add_u32 s81, s81, 4096
    v_mfma_f32_32x32x16_bf16 v[136:151], a[64:67], v[60:63], v[136:151]
    v_mfma_f32_32x32x16_bf16 v[168:183], a[68:71], v[60:63], v[168:183]
    buffer_load_dwordx4 v[200:203], v1, s[12:15], s82 offen offset:3072 sc1
    s_add_u32 s82, s82, 4096
    v_mfma_f32_32x32x16_bf16 v[136:151], a[120:123], v[64:67], v[136:151]
    v_mfma_f32_32x32x16_bf16 v[168:183], a[124:127], v[64:67], v[168:183]
    buffer_load_dwordx4 v[204:207], v1, s[12:15], s83 offen offset:3072 sc1
    s_add_u32 s83, s83, 4096
    v_mfma_f32_32x32x16_bf16 v[136:151], a[176:179], v[68:71], v[136:151]
    buffer_load_dwordx4 v[208:211], v1, s[12:15], s84 offen offset:3072 sc1
    s_add_u32 s84, s84, 4096
    v_mfma_f32_32x32x16_bf16 v[168:183], a[180:183], v[68:71], v[168:183]
    s_waitcnt vmcnt(12)
    v_max3_u32 v247, v72, v76, v80
    v_max_u32 v247, v247, v84
    v_cmp_eq_u32 vcc, -1, v247
    s_cbranch_vccnz L_rs_53
L_rok_54:
    v_mfma_f32_32x32x16_bf16 v[184:199], a[16:19], v[72:75], v[184:199]
    buffer_load_dwordx4 v[212:215], v1, s[12:15], s85 offen offset:3072 sc1
    s_add_u32 s85, s85, 4096
    v_mfma_f32_32x32x16_bf16 v[120:135], a[20:23], v[72:75], v[120:135]
    v_mfma_f32_32x32x16_bf16 v[184:199], a[72:75], v[76:79], v[184:199]
    buffer_load_dwordx4 v[8:11], v1, s[12:15], s78 offen offset:0 sc1
    v_mfma_f32_32x32x16_bf16 v[120:135], a[76:79], v[76:79], v[120:135]
    v_mfma_f32_32x32x16_bf16 v[184:199], a[128:131], v[80:83], v[184:199]
    buffer_load_dwordx4 v[12:15], v1, s[12:15], s79 offen offset:0 sc1
    v_mfma_f32_32x32x16_bf16 v[120:135], a[132:135], v[80:83], v[120:135]
    v_mfma_f32_32x32x16_bf16 v[184:199], a[184:187], v[84:87], v[184:199]
    buffer_load_dwordx4 v[16:19], v1, s[12:15], s80 offen offset:0 sc1
    v_mfma_f32_32x32x16_bf16 v[120:135], a[188:191], v[84:87], v[120:135]
    buffer_load_dwordx4 v[20:23], v1, s[12:15], s81 offen offset:0 sc1
    s_waitcnt vmcnt(12)
    v_max3_u32 v247, v88, v92, v96
    v_max_u32 v247, v247, v100
    v_cmp_eq_u32 vcc, -1, v247
    s_cbranch_vccnz L_rs_55
L_rok_56:
    v_mfma_f32_32x32x16_bf16 v[136:151], a[16:19], v[88:91], v[136:151]
    v_mfma_f32_32x32x16_bf16 v[168:183], a[20:23], v[88:91], v[168:183]
    buffer_load_dwordx4 v[24:27], v1, s[12:15], s78 offen offset:1024 sc1
    v_mfma_f32_32x32x16_bf16 v[136:151], a[72:75], v[92:95], v[136:151]
    v_mfma_f32_32x32x16_bf16 v[168:183], a[76:79], v[92:95], v[168:183]
    buffer_load_dwordx4 v[28:31], v1, s[12:15], s79 offen offset:1024 sc1
    v_mfma_f32_32x32x16_bf16 v[136:151], a[128:131], v[96:99], v[136:151]
    v_mfma_f32_32x32x16_bf16 v[168:183], a[132:135], v[96:99], v[168:183]
    buffer_load_dwordx4 v[32:35], v1, s[12:15], s80 offen offset:1024 sc1
    v_mfma_f32_32x32x16_bf16 v[136:151], a[184:187], v[100:103], v[136:151]
    v_mfma_f32_32x32x16_bf16 v[168:183], a[188:191], v[100:103], v[168:183]
    buffer_load_dwordx4 v[36:39], v1, s[12:15], s81 offen offset:1024 sc1
    s_waitcnt vmcnt(12)
    v_max3_u32 v247, v104, v108, v112
    v_max_u32 v247, v247, v116
    v_cmp_eq_u32 vcc, -1, v247
    s_cbranch_vccnz L_rs_57
L_rok_58:
    v_mfma_f32_32x32x16_bf16 v[184:199], a[24:27], v[104:107], v[184:199]
    buffer_load_dwordx4 v[40:43], v1, s[12:15], s78 offen offset:2048 sc1
    v_mfma_f32_32x32x16_bf16 v[120:135], a[28:31], v[104:107], v[120:135]
    v_mfma_f32_32x32x16_bf16 v[184:199], a[80:83], v[108:111], v[184:199]
    buffer_load_dwordx4 v[44:47], v1, s[12:15], s79 offen offset:2048 sc1
    v_mfma_f32_32x32x16_bf16 v[120:135], a[84:87], v[108:111], v[120:135]
    v_mfma_f32_32x32x16_bf16 v[184:199], a[136:139], v[112:115], v[184:199]
    buffer_load_dwordx4 v[48:51], v1, s[12:15], s80 offen offset:2048 sc1
    v_mfma_f32_32x32x16_bf16 v[120:135], a[140:143], v[112:115], v[120:135]
    v_mfma_f32_32x32x16_bf16 v[184:199], a[192:195], v[116:119], v[184:199]
    buffer_load_dwordx4 v[52:55], v1, s[12:15], s81 offen offset:2048 sc1
    v_mfma_f32_32x32x16_bf16 v[120:135], a[196:199], v[116:119], v[120:135]
    s_waitcnt vmcnt(12)
    v_max3_u32 v247, v200, v204, v208
    v_max_u32 v247, v247, v212
    v_cmp_eq_u32 vcc, -1, v247
    s_cbranch_vccnz L_rs_59
L_rok_60:
    v_mfma_f32_32x32x16_bf16 v[136:151], a[24:27], v[200:203], v[136:151]
    buffer_load_dwordx4 v[56:59], v1, s[12:15], s82 offen offset:0 sc1
    v_mfma_f32_32x32x16_bf16 v[168:183], a[28:31], v[200:203], v[168:183]
    buffer_load_dwordx4 v[60:63], v1, s[12:15], s83 offen offset:0 sc1
    v_mfma_f32_32x32x16_bf16 v[136:151], a[80:83], v[204:207], v[136:151]
    v_mfma_f32_32x32x16_bf16 v[168:183], a[84:87], v[204:207], v[168:183]
    buffer_load_dwordx4 v[64:67], v1, s[12:15], s84 offen offset:0 sc1
    v_mfma_f32_32x32x16_bf16 v[136:151], a[136:139], v[208:211], v[136:151]
    v_mfma_f32_32x32x16_bf16 v[168:183], a[140:143], v[208:211], v[168:183]
    buffer_load_dwordx4 v[68:71], v1, s[12:15], s85 offen offset:0 sc1
    v_mfma_f32_32x32x16_bf16 v[136:151], a[192:195], v[212:215], v[136:151]
    v_mfma_f32_32x32x16_bf16 v[168:183], a[196:199], v[212:215], v[168:183]
    buffer_load_dwordx4 v[72:75], v1, s[12:15], s82 offen offset:1024 sc1
    s_waitcnt vmcnt(13)
    v_max3_u32 v247, v8, v12, v16
    v_max_u32 v247, v247, v20
    v_cmp_eq_u32 vcc, -1, v247
    s_cbranch_vccnz L_rs_61
L_rok_62:
    v_mfma_f32_32x32x16_bf16 v[184:199], a[32:35], v[8:11], v[184:199]
    v_mfma_f32_32x32x16_bf16 v[120:135], a[36:39], v[8:11], v[120:135]
    buffer_load_dwordx4 v[76:79], v1, s[12:15], s83 offen offset:1024 sc1
    v_mfma_f32_32x32x16_bf16 v[184:199], a[88:91], v[12:15], v[184:199]
    buffer_load_dwordx4 v[80:83], v1, s[12:15], s84 offen offset:1024 sc1
    v_mfma_f32_32x32x16_bf16 v[120:135], a[92:95], v[12:15], v[120:135]
    v_mfma_f32_32x32x16_bf16 v[184:199], a[144:147], v[16:19], v[184:199]
    buffer_load_dwordx4 v[84:87], v1, s[12:15], s85 offen offset:1024 sc1
    v_mfma_f32_32x32x16_bf16 v[120:135], a[148:151], v[16:19], v[120:135]
    v_mfma_f32_32x32x16_bf16 v[184:199], a[200:203], v[20:23], v[184:199]
    buffer_load_dwordx4 v[88:91], v1, s[12:15], s82 offen offset:2048 sc1
    v_mfma_f32_32x32x16_bf16 v[120:135], a[204:207], v[20:23], v[120:135]
    s_waitcnt vmcnt(13)
    v_max3_u32 v247, v24, v28, v32
    v_max_u32 v247, v247, v36
    v_cmp_eq_u32 vcc, -1, v247
    s_cbranch_vccnz L_rs_63
L_rok_64:
    v_mfma_f32_32x32x16_bf16 v[184:199], a[40:43], v[24:27], v[184:199]
    buffer_load_dwordx4 v[92:95], v1, s[12:15], s83 offen offset:2048 sc1
    v_mfma_f32_32x32x16_bf16 v[120:135], a[44:47], v[24:27], v[120:135]
    v_mfma_f32_32x32x16_bf16 v[184:199], a[96:99], v[28:31], v[184:199]
    buffer_load_dwordx4 v[96:99], v1, s[12:15], s84 offen offset:2048 sc1
    v_mfma_f32_32x32x16_bf16 v[120:135], a[100:103], v[28:31], v[120:135]
    buffer_load_dwordx4 v[100:103], v1, s[12:15], s85 offen offset:2048 sc1
    v_mfma_f32_32x32x16_bf16 v[184:199], a[152:155], v[32:35], v[184:199]
    v_mfma_f32_32x32x16_bf16 v[120:135], a[156:159], v[32:35], v[120:135]
    v_mfma_f32_32x32x16_bf16 v[184:199], a[208:211], v[36:39], v[184:199]
    v_mfma_f32_32x32x16_bf16 v[120:135], a[212:215], v[36:39], v[120:135]
    s_waitcnt vmcnt(12)
    v_max3_u32 v247, v40, v44, v48
    v_max_u32 v247, v247, v52
    v_cmp_eq_u32 vcc, -1, v247
    s_cbranch_vccnz L_rs_65
L_rok_66:
    v_mfma_f32_32x32x16_bf16 v[184:199], a[48:51], v[40:43], v[184:199]
    v_mfma_f32_32x32x16_bf16 v[184:199], a[104:107], v[44:47], v[184:199]
    v_mfma_f32_32x32x16_bf16 v[184:199], a[160:163], v[48:51], v[184:199]
    v_mfma_f32_32x32x16_bf16 v[184:199], a[216:219], v[52:55], v[184:199]
    v_mfma_f32_32x32x16_bf16 v[120:135], a[52:55], v[40:43], v[120:135]
    v_mfma_f32_32x32x16_bf16 v[120:135], a[108:111], v[44:47], v[120:135]
    s_nop 9
    ds_write_b128 v4, v[184:187] offset:0
    v_mfma_f32_32x32x16_bf16 v[120:135], a[164:167], v[48:51], v[120:135]
    ds_write_b128 v4, v[188:191] offset:1024
    v_mfma_f32_32x32x16_bf16 v[120:135], a[220:223], v[52:55], v[120:135]
    ds_write_b128 v4, v[192:195] offset:2048
    s_waitcnt vmcnt(8)
    v_max3_u32 v247, v56, v60, v64
    v_max_u32 v247, v247, v68
    v_cmp_eq_u32 vcc, -1, v247
    s_cbranch_vccnz L_rs_67
L_rok_68:
    v_mfma_f32_32x32x16_bf16 v[136:151], a[32:35], v[56:59], v[136:151]
    ds_write_b128 v4, v[196:199] offset:3072
    v_mfma_f32_32x32x16_bf16 v[136:151], a[88:91], v[60:63], v[136:151]
    s_nop 2
    ds_write_b128 v6, v[120:123] offset:0
    v_mfma_f32_32x32x16_bf16 v[136:151], a[144:147], v[64:67], v[136:151]
    ds_write_b128 v6, v[124:127] offset:1024
    v_mfma_f32_32x32x16_bf16 v[136:151], a[200:203], v[68:71], v[136:151]
    ds_write_b128 v6, v[128:131] offset:2048
    s_waitcnt vmcnt(4)
    v_max3_u32 v247, v72, v76, v80
    v_max_u32 v247, v247, v84
    v_cmp_eq_u32 vcc, -1, v247
    s_cbranch_vccnz L_rs_69
L_rok_70:
    v_mfma_f32_32x32x16_bf16 v[136:151], a[40:43], v[72:75], v[136:151]
    ds_write_b128 v6, v[132:135] offset:3072
    v_mfma_f32_32x32x16_bf16 v[136:151], a[96:99], v[76:79], v[136:151]
    v_mfma_f32_32x32x16_bf16 v[136:151], a[152:155], v[80:83], v[136:151]
    v_mfma_f32_32x32x16_bf16 v[136:151], a[208:211], v[84:87], v[136:151]
    s_waitcnt vmcnt(0)
    v_max3_u32 v247, v88, v92, v96
    v_max_u32 v247, v247, v100
    v_cmp_eq_u32 vcc, -1, v247
    s_cbranch_vccnz L_rs_71
L_rok_72:
    v_mfma_f32_32x32x16_bf16 v[136:151], a[48:51], v[88:91], v[136:151]
    v_mfma_f32_32x32x16_bf16 v[136:151], a[104:107], v[92:95], v[136:151]
    v_mfma_f32_32x32x16_bf16 v[136:151], a[160:163], v[96:99], v[136:151]
    v_mfma_f32_32x32x16_bf16 v[136:151], a[216:219], v[100:103], v[136:151]
    s_waitcnt lgkmcnt(0)
    s_barrier
    ds_read_b128 v[184:187], v7 offset:0
    ds_read_b128 v[120:123], v7 offset:8192
    ds_read_b128 v[188:191], v7 offset:1024
    ds_read_b128 v[124:127], v7 offset:9216
    ds_read_b128 v[192:195], v7 offset:2048
    ds_read_b128 v[128:131], v7 offset:10240
    ds_read_b128 v[196:199], v7 offset:3072
    v_mfma_f32_32x32x16_bf16 v[168:183], a[36:39], v[56:59], v[168:183]
    ds_read_b128 v[132:135], v7 offset:11264
    s_waitcnt lgkmcnt(6)
    v_add_f32 v184, v184, v120
    v_add_f32 v185, v185, v121
    v_add_f32 v186, v186, v122
    v_mfma_f32_32x32x16_bf16 v[168:183], a[92:95], v[60:63], v[168:183]
    ds_write_b128 v5, v[136:139] offset:0
    v_add_f32 v187, v187, v123
    s_waitcnt lgkmcnt(5)
    v_add_f32_e64 v188, v188, v124
    v_mfma_f32_32x32x16_bf16 v[168:183], a[148:151], v[64:67], v[168:183]
    ds_write_b128 v5, v[140:143] offset:1024
    v_add_f32 v189, v189, v125
    v_add_f32 v190, v190, v126
    v_add_f32_e64 v191, v191, v127
    v_mfma_f32_32x32x16_bf16 v[168:183], a[204:207], v[68:71], v[168:183]
    ds_write_b128 v5, v[144:147] offset:2048
    s_waitcnt lgkmcnt(5)
    v_add_f32 v192, v192, v128
    v_add_f32 v193, v193, v129
    v_add_f32 v194, v194, v130
    v_mfma_f32_32x32x16_bf16 v[168:183], a[44:47], v[72:75], v[168:183]
    ds_write_b128 v5, v[148:151] offset:3072
    v_add_f32 v195, v195, v131
    s_waitcnt lgkmcnt(4)
    v_add_f32_e64 v196, v196, v132
    v_mfma_f32_32x32x16_bf16 v[168:183], a[100:103], v[76:79], v[168:183]
    v_add_f32 v197, v197, v133
    v_add_f32 v198, v198, v134
    v_add_f32_e64 v199, v199, v135
    v_mfma_f32_32x32x16_bf16 v[168:183], a[156:159], v[80:83], v[168:183]
    v_mfma_f32_32x32x16_bf16 v[168:183], a[212:215], v[84:87], v[168:183]
    v_mfma_f32_32x32x16_bf16 v[168:183], a[52:55], v[88:91], v[168:183]
    s_waitcnt lgkmcnt(0)
    s_barrier
    ds_read_b128 v[136:139], v7 offset:4096
    ds_read_b128 v[140:143], v7 offset:5120
    ds_read_b128 v[144:147], v7 offset:6144
    ds_read_b128 v[148:151], v7 offset:7168
    s_waitcnt lgkmcnt(3)
    v_add_f32 v184, v184, v136
    v_mfma_f32_32x32x16_bf16 v[168:183], a[108:111], v[92:95], v[168:183]
    v_add_f32 v185, v185, v137
    v_add_f32 v186, v186, v138
    v_add_f32 v187, v187, v139
    s_waitcnt lgkmcnt(2)
    v_add_f32_e64 v188, v188, v140
    v_mfma_f32_32x32x16_bf16 v[168:183], a[164:167], v[96:99], v[168:183]
    v_add_f32 v189, v189, v141
    v_add_f32 v190, v190, v142
    v_add_f32 v191, v191, v143
    s_waitcnt lgkmcnt(1)
    v_add_f32_e64 v192, v192, v144
    v_mfma_f32_32x32x16_bf16 v[168:183], a[220:223], v[100:103], v[168:183]
    v_add_f32 v193, v193, v145
    v_add_f32 v194, v194, v146
    v_add_f32 v195, v195, v147
    s_waitcnt lgkmcnt(0)
    v_add_f32 v196, v196, v148
    v_add_f32 v197, v197, v149
    v_add_f32_e64 v198, v198, v150
    v_add_f32 v199, v199, v151
    s_nop 3
    v_pk_add_f32 v[168:169], v[168:169], v[184:185]
    v_pk_add_f32 v[170:171], v[170:171], v[186:187]
    v_pk_add_f32 v[172:173], v[172:173], v[188:189]
    v_pk_add_f32 v[174:175], v[174:175], v[190:191]
    v_cvt_pk_bf16_f32 v8, v168, v169
    v_cvt_pk_bf16_f32 v9, v170, v171
    v_cvt_pk_bf16_f32 v10, v172, v173
    v_cvt_pk_bf16_f32 v11, v174, v175
    ds_write_b128 v244, v[8:11] offset:0
    v_pk_add_f32 v[176:177], v[176:177], v[192:193]
    v_pk_add_f32 v[178:179], v[178:179], v[194:195]
    v_pk_add_f32 v[180:181], v[180:181], v[196:197]
    v_pk_add_f32 v[182:183], v[182:183], v[198:199]
    v_cvt_pk_bf16_f32 v12, v176, v177
    v_cvt_pk_bf16_f32 v13, v178, v179
    v_cvt_pk_bf16_f32 v14, v180, v181
    v_cvt_pk_bf16_f32 v15, v182, v183
    ds_write_b128 v244, v[12:15] offset:16
    ds_read_b128 v[16:19], v7 offset:0
    ds_read_b128 v[20:23], v7 offset:1040
    s_waitcnt lgkmcnt(1)
    buffer_store_dwordx4 v[16:19], v254, s[16:19], 0 offen offset:0 sc0 sc1
    s_waitcnt lgkmcnt(0)
    buffer_store_dwordx4 v[20:23], v254, s[16:19], 0 offen offset:896 sc0 sc1
    s_branch L_fin
L_tail:
    s_nop 9
    v_pk_mul_f32 v[152:153], v[152:153], v[220:221] op_sel_hi:[1,0]
    v_pk_mul_f32 v[154:155], v[154:155], v[220:221] op_sel_hi:[1,0]
    v_pk_mul_f32 v[156:157], v[156:157], v[220:221] op_sel_hi:[1,0]
    v_pk_mul_f32 v[158:159], v[158:159], v[220:221] op_sel_hi:[1,0]
    v_exp_f32 v152, v152
    v_exp_f32 v153, v153
    v_exp_f32 v154, v154
    v_exp_f32 v155, v155
    v_exp_f32 v156, v156
    v_exp_f32 v157, v157
    v_exp_f32 v158, v158
    v_exp_f32 v159, v159
    v_pk_fma_f32 v[152:153], v[152:153], v[222:223], v[222:223] op_sel_hi:[1,0,0]
    v_pk_fma_f32 v[154:155], v[154:155], v[222:223], v[222:223] op_sel_hi:[1,0,0]
    v_pk_fma_f32 v[156:157], v[156:157], v[222:223], v[222:223] op_sel_hi:[1,0,0]
    v_pk_fma_f32 v[158:159], v[158:159], v[222:223], v[222:223] op_sel_hi:[1,0,0]
    v_rcp_f32 v152, v152
    v_rcp_f32 v153, v153
    v_rcp_f32 v154, v154
    v_rcp_f32 v155, v155
    v_rcp_f32 v156, v156
    v_rcp_f32 v157, v157
    v_rcp_f32 v158, v158
    v_rcp_f32 v159, v159
    v_pk_mul_f32 v[152:153], v[152:153], v[160:161]
    v_pk_mul_f32 v[154:155], v[154:155], v[162:163]
    v_pk_mul_f32 v[156:157], v[156:157], v[164:165]
    v_pk_mul_f32 v[158:159], v[158:159], v[166:167]
    v_cvt_pk_bf16_f32 v232, v152, v153
    v_cvt_pk_bf16_f32 v233, v154, v155
    v_cvt_pk_bf16_f32 v234, v156, v157
    v_cvt_pk_bf16_f32 v235, v158, v159
    buffer_store_dwordx4 v[232:235], v1, s[12:15], s101 offen offset:2048 sc1
    s_waitcnt vmcnt(0)
    s_cmp_lg_u32 s2, 255
    s_cbranch_scc1 L_fin
    s_lshl_b32 s55, s36, 6
    v_add_u32 v2, s55, v0
    v_lshlrev_b32_e64 v2, 7, v2
    s_mov_b32 s60, 25329664
L_poll_73:
    buffer_load_dword v3, v2, s[12:15], s60 offen sc1
    s_waitcnt vmcnt(0)
    v_cmp_ne_u32 vcc, s39, v3
    s_cbranch_vccz L_seen_74
    s_sub_u32 s40, s40, 1
    s_cselect_b32 s40, 0, s40
    s_cbranch_scc0 L_poll_73
L_seen_74:
    s_mov_b32 s50, 0
    v_mov_b32 v8, s39
    v_mov_b32 v9, s39
    v_mov_b32 v10, s39
    v_mov_b32 v11, s39
    s_lshl_b32 s60, s50, 7
    s_add_u32 s60, s60, 25296896
    s_cmp_eq_u32 s36, 0
    s_cselect_b32 s60, s60, 1073741824
    v_lshrrev_b32_e64 v12, 3, v0
    v_lshl_add_u32 v12, v12, 26, v1
    s_waitcnt vmcnt(0)
    s_barrier
    buffer_store_dwordx4 v[8:11], v12, s[12:15], s60 offen sc1
L_fin:
    s_waitcnt vmcnt(0)
L_end:
    s_endpgm
L_fw_1:
    s_mov_b64 exec, 0xff
    buffer_load_dword v209, v207, s[12:15], s60 offen sc1
    s_mov_b64 exec, -1
    s_waitcnt vmcnt(0)
    v_cmp_ne_u32 vcc, s39, v209
    s_bfe_u32 s55, vcc_lo, s51
    s_cmp_eq_u32 s55, 0
    s_cbranch_scc1 L_fok_2
    s_sub_u32 s40, s40, 1
    s_cselect_b32 s40, 0, s40
    s_cbranch_scc0 L_fw_1
    s_branch L_fok_2
L_fw_3:
    s_mov_b32 s60, 27787264
L_poll_75:
    buffer_load_dword v209, v207, s[12:15], s60 offen sc1
    s_waitcnt vmcnt(0)
    v_cmp_ne_u32 vcc, s39, v209
    s_cbranch_vccz L_seen_76
    s_sub_u32 s40, s40, 1
    s_cselect_b32 s40, 0, s40
    s_cbranch_scc0 L_poll_75
L_seen_76:
    s_branch L_fok_4
L_fw_5:
    s_mov_b32 s60, 25329664
L_poll_77:
    buffer_load_dword v209, v3, s[12:15], s60 offen sc1
    s_waitcnt vmcnt(0)
    v_cmp_ne_u32 vcc, s39, v209
    s_cbranch_vccz L_seen_78
    s_sub_u32 s40, s40, 1
    s_cselect_b32 s40, 0, s40
    s_cbranch_scc0 L_poll_77
L_seen_78:
    s_branch L_fok_6
L_fw_7:
    s_mov_b32 s60, 25198592
L_poll_79:
    buffer_load_dword v209, v2, s[12:15], s60 offen sc1
    s_waitcnt vmcnt(0)
    v_cmp_ne_u32 vcc, s39, v209
    s_cbranch_vccz L_seen_80
    s_sub_u32 s40, s40, 1
    s_cselect_b32 s40, 0, s40
    s_cbranch_scc0 L_poll_79
L_seen_80:
    s_branch L_fok_8
L_cidle:
    s_waitcnt vmcnt(0)
    s_branch L_c1
L_rs_9:
    buffer_load_dwordx4 v[136:139], v1, s[12:15], s69 offen offset:0 sc1
    buffer_load_dwordx4 v[140:143], v1, s[12:15], s69 offen offset:1024 sc1
    buffer_load_dwordx4 v[144:147], v1, s[12:15], s69 offen offset:2048 sc1
    buffer_load_dwordx4 v[148:151], v1, s[12:15], s69 offen offset:3072 sc1
    buffer_load_dwordx4 v[152:155], v1, s[12:15], s50 offen offset:0 sc1
    buffer_load_dwordx4 v[156:159], v1, s[12:15], s50 offen offset:1024 sc1
    buffer_load_dwordx4 v[160:163], v1, s[12:15], s50 offen offset:2048 sc1
    buffer_load_dwordx4 v[164:167], v1, s[12:15], s50 offen offset:3072 sc1
    buffer_load_dwordx4 v[168:171], v1, s[12:15], s70 offen offset:0 sc1
    buffer_load_dwordx4 v[172:175], v1, s[12:15], s70 offen offset:1024 sc1
    buffer_load_dwordx4 v[176:179], v1, s[12:15], s70 offen offset:2048 sc1
    buffer_load_dwordx4 v[180:183], v1, s[12:15], s70 offen offset:3072 sc1
    buffer_load_dwordx4 v[184:187], v1, s[12:15], s51 offen offset:0 sc1
    buffer_load_dwordx4 v[188:191], v1, s[12:15], s51 offen offset:1024 sc1
    buffer_load_dwordx4 v[192:195], v1, s[12:15], s51 offen offset:2048 sc1
    buffer_load_dwordx4 v[196:199], v1, s[12:15], s51 offen offset:3072 sc1
    s_waitcnt vmcnt(0)
    v_max_u32 v209, v136, v140
    v_cmp_eq_u32 vcc, -1, v209
    s_cbranch_vccz L_rok_10
    s_sub_u32 s40, s40, 1
    s_cselect_b32 s40, 0, s40
    s_cbranch_scc0 L_rs_9
    s_branch L_rok_10
L_rs_11:
    buffer_load_dwordx4 v[144:147], v1, s[12:15], s69 offen offset:2048 sc1
    buffer_load_dwordx4 v[148:151], v1, s[12:15], s69 offen offset:3072 sc1
    buffer_load_dwordx4 v[152:155], v1, s[12:15], s50 offen offset:0 sc1
    buffer_load_dwordx4 v[156:159], v1, s[12:15], s50 offen offset:1024 sc1
    buffer_load_dwordx4 v[160:163], v1, s[12:15], s50 offen offset:2048 sc1
    buffer_load_dwordx4 v[164:167], v1, s[12:15], s50 offen offset:3072 sc1
    buffer_load_dwordx4 v[168:171], v1, s[12:15], s70 offen offset:0 sc1
    buffer_load_dwordx4 v[172:175], v1, s[12:15], s70 offen offset:1024 sc1
    buffer_load_dwordx4 v[176:179], v1, s[12:15], s70 offen offset:2048 sc1
    buffer_load_dwordx4 v[180:183], v1, s[12:15], s70 offen offset:3072 sc1
    buffer_load_dwordx4 v[184:187], v1, s[12:15], s51 offen offset:0 sc1
    buffer_load_dwordx4 v[188:191], v1, s[12:15], s51 offen offset:1024 sc1
    buffer_load_dwordx4 v[192:195], v1, s[12:15], s51 offen offset:2048 sc1
    buffer_load_dwordx4 v[196:199], v1, s[12:15], s51 offen offset:3072 sc1
    s_waitcnt vmcnt(0)
    v_max_u32 v209, v144, v148
    v_cmp_eq_u32 vcc, -1, v209
    s_cbranch_vccz L_rok_12
    s_sub_u32 s40, s40, 1
    s_cselect_b32 s40, 0, s40
    s_cbranch_scc0 L_rs_11
    s_branch L_rok_12
L_rs_13:
    buffer_load_dwordx4 v[152:155], v1, s[12:15], s50 offen offset:0 sc1
    buffer_load_dwordx4 v[156:159], v1, s[12:15], s50 offen offset:1024 sc1
    buffer_load_dwordx4 v[160:163], v1, s[12:15], s50 offen offset:2048 sc1
    buffer_load_dwordx4 v[164:167], v1, s[12:15], s50 offen offset:3072 sc1
    buffer_load_dwordx4 v[168:171], v1, s[12:15], s70 offen offset:0 sc1
    buffer_load_dwordx4 v[172:175], v1, s[12:15], s70 offen offset:1024 sc1
    buffer_load_dwordx4 v[176:179], v1, s[12:15], s70 offen offset:2048 sc1
    buffer_load_dwordx4 v[180:183], v1, s[12:15], s70 offen offset:3072 sc1
    buffer_load_dwordx4 v[184:187], v1, s[12:15], s51 offen offset:0 sc1
    buffer_load_dwordx4 v[188:191], v1, s[12:15], s51 offen offset:1024 sc1
    buffer_load_dwordx4 v[192:195], v1, s[12:15], s51 offen offset:2048 sc1
    buffer_load_dwordx4 v[196:199], v1, s[12:15], s51 offen offset:3072 sc1
    s_waitcnt vmcnt(0)
    v_max_u32 v209, v152, v156
    v_cmp_eq_u32 vcc, -1, v209
    s_cbranch_vccz L_rok_14
    s_sub_u32 s40, s40, 1
    s_cselect_b32 s40, 0, s40
    s_cbranch_scc0 L_rs_13
    s_branch L_rok_14
L_rs_15:
    buffer_load_dwordx4 v[160:163], v1, s[12:15], s50 offen offset:2048 sc1
    buffer_load_dwordx4 v[164:167], v1, s[12:15], s50 offen offset:3072 sc1
    buffer_load_dwordx4 v[168:171], v1, s[12:15], s70 offen offset:0 sc1
    buffer_load_dwordx4 v[172:175], v1, s[12:15], s70 offen offset:1024 sc1
    buffer_load_dwordx4 v[176:179], v1, s[12:15], s70 offen offset:2048 sc1
    buffer_load_dwordx4 v[180:183], v1, s[12:15], s70 offen offset:3072 sc1
    buffer_load_dwordx4 v[184:187], v1, s[12:15], s51 offen offset:0 sc1
    buffer_load_dwordx4 v[188:191], v1, s[12:15], s51 offen offset:1024 sc1
    buffer_load_dwordx4 v[192:195], v1, s[12:15], s51 offen offset:2048 sc1
    buffer_load_dwordx4 v[196:199], v1, s[12:15], s51 offen offset:3072 sc1
    s_waitcnt vmcnt(0)
    v_max_u32 v209, v160, v164
    v_cmp_eq_u32 vcc, -1, v209
    s_cbranch_vccz L_rok_16
    s_sub_u32 s40, s40, 1
    s_cselect_b32 s40, 0, s40
    s_cbranch_scc0 L_rs_15
    s_branch L_rok_16
L_rs_17:
    buffer_load_dwordx4 v[168:171], v1, s[12:15], s70 offen offset:0 sc1
    buffer_load_dwordx4 v[172:175], v1, s[12:15], s70 offen offset:1024 sc1
    buffer_load_dwordx4 v[176:179], v1, s[12:15], s70 offen offset:2048 sc1
    buffer_load_dwordx4 v[180:183], v1, s[12:15], s70 offen offset:3072 sc1
    buffer_load_dwordx4 v[184:187], v1, s[12:15], s51 offen offset:0 sc1
    buffer_load_dwordx4 v[188:191], v1, s[12:15], s51 offen offset:1024 sc1
    buffer_load_dwordx4 v[192:195], v1, s[12:15], s51 offen offset:2048 sc1
    buffer_load_dwordx4 v[196:199], v1, s[12:15], s51 offen offset:3072 sc1
    s_waitcnt vmcnt(0)
    v_max_u32 v209, v168, v172
    v_cmp_eq_u32 vcc, -1, v209
    s_cbranch_vccz L_rok_18
    s_sub_u32 s40, s40, 1
    s_cselect_b32 s40, 0, s40
    s_cbranch_scc0 L_rs_17
    s_branch L_rok_18
L_rs_19:
    buffer_load_dwordx4 v[176:179], v1, s[12:15], s70 offen offset:2048 sc1
    buffer_load_dwordx4 v[180:183], v1, s[12:15], s70 offen offset:3072 sc1
    buffer_load_dwordx4 v[184:187], v1, s[12:15], s51 offen offset:0 sc1
    buffer_load_dwordx4 v[188:191], v1, s[12:15], s51 offen offset:1024 sc1
    buffer_load_dwordx4 v[192:195], v1, s[12:15], s51 offen offset:2048 sc1
    buffer_load_dwordx4 v[196:199], v1, s[12:15], s51 offen offset:3072 sc1
    s_waitcnt vmcnt(0)
    v_max_u32 v209, v176, v180
    v_cmp_eq_u32 vcc, -1, v209
    s_cbranch_vccz L_rok_20
    s_sub_u32 s40, s40, 1
    s_cselect_b32 s40, 0, s40
    s_cbranch_scc0 L_rs_19
    s_branch L_rok_20
L_rs_21:
    buffer_load_dwordx4 v[184:187], v1, s[12:15], s51 offen offset:0 sc1
    buffer_load_dwordx4 v[188:191], v1, s[12:15], s51 offen offset:1024 sc1
    buffer_load_dwordx4 v[192:195], v1, s[12:15], s51 offen offset:2048 sc1
    buffer_load_dwordx4 v[196:199], v1, s[12:15], s51 offen offset:3072 sc1
    s_waitcnt vmcnt(0)
    v_max_u32 v209, v184, v188
    v_cmp_eq_u32 vcc, -1, v209
    s_cbranch_vccz L_rok_22
    s_sub_u32 s40, s40, 1
    s_cselect_b32 s40, 0, s40
    s_cbranch_scc0 L_rs_21
    s_branch L_rok_22
L_rs_23:
    buffer_load_dwordx4 v[192:195], v1, s[12:15], s51 offen offset:2048 sc1
    buffer_load_dwordx4 v[196:199], v1, s[12:15], s51 offen offset:3072 sc1
    s_waitcnt vmcnt(0)
    v_max_u32 v209, v192, v196
    v_cmp_eq_u32 vcc, -1, v209
    s_cbranch_vccz L_rok_24
    s_sub_u32 s40, s40, 1
    s_cselect_b32 s40, 0, s40
    s_cbranch_scc0 L_rs_23
    s_branch L_rok_24
L_fw_25:
    s_mov_b32 s60, 25231360
L_poll_81:
    buffer_load_dword v248, v249, s[12:15], s60 offen sc1
    s_waitcnt vmcnt(0)
    v_cmp_ne_u32 vcc, s39, v248
    s_cbranch_vccz L_seen_82
    s_sub_u32 s40, s40, 1
    s_cselect_b32 s40, 0, s40
    s_cbranch_scc0 L_poll_81
L_seen_82:
    s_branch L_fok_26
L_rs_27:
    s_add_u32 s60, s72, 0
    buffer_load_dwordx4 v[8:11], v1, s[12:15], s60 offen offset:0 sc1
    buffer_load_dwordx4 v[12:15], v1, s[12:15], s60 offen offset:1024 sc1
    buffer_load_dwordx4 v[16:19], v1, s[12:15], s60 offen offset:2048 sc1
    buffer_load_dwordx4 v[20:23], v1, s[12:15], s60 offen offset:3072 sc1
    s_add_u32 s60, s72, 4096
    buffer_load_dwordx4 v[24:27], v1, s[12:15], s60 offen offset:0 sc1
    buffer_load_dwordx4 v[28:31], v1, s[12:15], s60 offen offset:1024 sc1
    buffer_load_dwordx4 v[32:35], v1, s[12:15], s60 offen offset:2048 sc1
    buffer_load_dwordx4 v[36:39], v1, s[12:15], s60 offen offset:3072 sc1
    s_add_u32 s60, s72, 8192
    buffer_load_dwordx4 v[40:43], v1, s[12:15], s60 offen offset:0 sc1
    buffer_load_dwordx4 v[44:47], v1, s[12:15], s60 offen offset:1024 sc1
    s_waitcnt vmcnt(0)
    v_max_u32 v248, v8, v12
    v_cmp_eq_u32 vcc, -1, v248
    s_cbranch_vccz L_rok_28
    s_sub_u32 s40, s40, 1
    s_cselect_b32 s40, 0, s40
    s_cbranch_scc0 L_rs_27
    s_branch L_rok_28
L_rs_29:
    s_add_u32 s60, s72, 0
    buffer_load_dwordx4 v[16:19], v1, s[12:15], s60 offen offset:2048 sc1
    buffer_load_dwordx4 v[20:23], v1, s[12:15], s60 offen offset:3072 sc1
    s_add_u32 s60, s72, 4096
    buffer_load_dwordx4 v[24:27], v1, s[12:15], s60 offen offset:0 sc1
    buffer_load_dwordx4 v[28:31], v1, s[12:15], s60 offen offset:1024 sc1
    buffer_load_dwordx4 v[32:35], v1, s[12:15], s60 offen offset:2048 sc1
    buffer_load_dwordx4 v[36:39], v1, s[12:15], s60 offen offset:3072 sc1
    s_add_u32 s60, s72, 8192
    buffer_load_dwordx4 v[40:43], v1, s[12:15], s60 offen offset:0 sc1
    buffer_load_dwordx4 v[44:47], v1, s[12:15], s60 offen offset:1024 sc1
    buffer_load_dwordx4 v[48:51], v1, s[12:15], s60 offen offset:2048 sc1
    buffer_load_dwordx4 v[52:55], v1, s[12:15], s60 offen offset:3072 sc1
    s_add_u32 s60, s72, 12288
    buffer_load_dwordx4 v[56:59], v1, s[12:15], s60 offen offset:0 sc1
    s_waitcnt vmcnt(0)
    v_max_u32 v248, v16, v20
    v_cmp_eq_u32 vcc, -1, v248
    s_cbranch_vccz L_rok_30
    s_sub_u32 s40, s40, 1
    s_cselect_b32 s40, 0, s40
    s_cbranch_scc0 L_rs_29
    s_branch L_rok_30
L_rs_31:
    s_add_u32 s60, s72, 4096
    buffer_load_dwordx4 v[24:27], v1, s[12:15], s60 offen offset:0 sc1
    buffer_load_dwordx4 v[28:31], v1, s[12:15], s60 offen offset:1024 sc1
    buffer_load_dwordx4 v[32:35], v1, s[12:15], s60 offen offset:2048 sc1
    buffer_load_dwordx4 v[36:39], v1, s[12:15], s60 offen offset:3072 sc1
    s_add_u32 s60, s72, 8192
    buffer_load_dwordx4 v[40:43], v1, s[12:15], s60 offen offset:0 sc1
    buffer_load_dwordx4 v[44:47], v1, s[12:15], s60 offen offset:1024 sc1
    buffer_load_dwordx4 v[48:51], v1, s[12:15], s60 offen offset:2048 sc1
    buffer_load_dwordx4 v[52:55], v1, s[12:15], s60 offen offset:3072 sc1
    s_add_u32 s60, s72, 12288
    buffer_load_dwordx4 v[56:59], v1, s[12:15], s60 offen offset:0 sc1
    buffer_load_dwordx4 v[60:63], v1, s[12:15], s60 offen offset:1024 sc1
    buffer_load_dwordx4 v[64:67], v1, s[12:15], s60 offen offset:2048 sc1
    buffer_load_dwordx4 v[68:71], v1, s[12:15], s60 offen offset:3072 sc1
    s_waitcnt vmcnt(0)
    v_max3_u32 v248, v24, v28, v32
    v_max_u32 v248, v248, v36
    v_cmp_eq_u32 vcc, -1, v248
    s_cbranch_vccz L_rok_32
    s_sub_u32 s40, s40, 1
    s_cselect_b32 s40, 0, s40
    s_cbranch_scc0 L_rs_31
    s_branch L_rok_32
L_rs_33:
    s_add_u32 s60, s72, 8192
    buffer_load_dwordx4 v[40:43], v1, s[12:15], s60 offen offset:0 sc1
    buffer_load_dwordx4 v[44:47], v1, s[12:15], s60 offen offset:1024 sc1
    buffer_load_dwordx4 v[48:51], v1, s[12:15], s60 offen offset:2048 sc1
    buffer_load_dwordx4 v[52:55], v1, s[12:15], s60 offen offset:3072 sc1
    s_add_u32 s60, s72, 12288
    buffer_load_dwordx4 v[56:59], v1, s[12:15], s60 offen offset:0 sc1
    buffer_load_dwordx4 v[60:63], v1, s[12:15], s60 offen offset:1024 sc1
    buffer_load_dwordx4 v[64:67], v1, s[12:15], s60 offen offset:2048 sc1
    buffer_load_dwordx4 v[68:71], v1, s[12:15], s60 offen offset:3072 sc1
    s_add_u32 s60, s72, 16384
    buffer_load_dwordx4 v[72:75], v1, s[12:15], s60 offen offset:0 sc1
    buffer_load_dwordx4 v[76:79], v1, s[12:15], s60 offen offset:1024 sc1
    buffer_load_dwordx4 v[80:83], v1, s[12:15], s60 offen offset:2048 sc1
    buffer_load_dwordx4 v[84:87], v1, s[12:15], s60 offen offset:3072 sc1
    s_add_u32 s60, s72, 20480
    buffer_load_dwordx4 v[88:91], v1, s[12:15], s60 offen offset:0 sc1
    buffer_load_dwordx4 v[92:95], v1, s[12:15], s60 offen offset:1024 sc1
    s_waitcnt vmcnt(0)
    v_max3_u32 v248, v40, v44, v48
    v_max_u32 v248, v248, v52
    v_cmp_eq_u32 vcc, -1, v248
    s_cbranch_vccz L_rok_34
    s_sub_u32 s40, s40, 1
    s_cselect_b32 s40, 0, s40
    s_cbranch_scc0 L_rs_33
    s_branch L_rok_34
L_rs_35:
    s_add_u32 s60, s72, 12288
    buffer_load_dwordx4 v[56:59], v1, s[12:15], s60 offen offset:0 sc1
    buffer_load_dwordx4 v[60:63], v1, s[12:15], s60 offen offset:1024 sc1
    buffer_load_dwordx4 v[64:67], v1, s[12:15], s60 offen offset:2048 sc1
    buffer_load_dwordx4 v[68:71], v1, s[12:15], s60 offen offset:3072 sc1
    s_add_u32 s60, s72, 16384
    buffer_load_dwordx4 v[72:75], v1, s[12:15], s60 offen offset:0 sc1
    buffer_load_dwordx4 v[76:79], v1, s[12:15], s60 offen offset:1024 sc1
    buffer_load_dwordx4 v[80:83], v1, s[12:15], s60 offen offset:2048 sc1
    buffer_load_dwordx4 v[84:87], v1, s[12:15], s60 offen offset:3072 sc1
    s_add_u32 s60, s72, 20480
    buffer_load_dwordx4 v[88:91], v1, s[12:15], s60 offen offset:0 sc1
    buffer_load_dwordx4 v[92:95], v1, s[12:15], s60 offen offset:1024 sc1
    buffer_load_dwordx4 v[96:99], v1, s[12:15], s60 offen offset:2048 sc1
    buffer_load_dwordx4 v[100:103], v1, s[12:15], s60 offen offset:3072 sc1
    s_add_u32 s60, s72, 24576
    buffer_load_dwordx4 v[104:107], v1, s[12:15], s60 offen offset:0 sc1
    buffer_load_dwordx4 v[108:111], v1, s[12:15], s60 offen offset:1024 sc1
    buffer_load_dwordx4 v[112:115], v1, s[12:15], s60 offen offset:2048 sc1
    buffer_load_dwordx4 v[116:119], v1, s[12:15], s60 offen offset:3072 sc1
    s_waitcnt vmcnt(0)
    v_max3_u32 v248, v56, v60, v64
    v_max_u32 v248, v248, v68
    v_cmp_eq_u32 vcc, -1, v248
    s_cbranch_vccz L_rok_36
    s_sub_u32 s40, s40, 1
    s_cselect_b32 s40, 0, s40
    s_cbranch_scc0 L_rs_35
    s_branch L_rok_36
L_rs_37:
    s_add_u32 s60, s72, 16384
    buffer_load_dwordx4 v[72:75], v1, s[12:15], s60 offen offset:0 sc1
    buffer_load_dwordx4 v[76:79], v1, s[12:15], s60 offen offset:1024 sc1
    buffer_load_dwordx4 v[80:83], v1, s[12:15], s60 offen offset:2048 sc1
    buffer_load_dwordx4 v[84:87], v1, s[12:15], s60 offen offset:3072 sc1
    s_add_u32 s60, s72, 20480
    buffer_load_dwordx4 v[88:91], v1, s[12:15], s60 offen offset:0 sc1
    buffer_load_dwordx4 v[92:95], v1, s[12:15], s60 offen offset:1024 sc1
    buffer_load_dwordx4 v[96:99], v1, s[12:15], s60 offen offset:2048 sc1
    buffer_load_dwordx4 v[100:103], v1, s[12:15], s60 offen offset:3072 sc1
    s_add_u32 s60, s72, 24576
    buffer_load_dwordx4 v[104:107], v1, s[12:15], s60 offen offset:0 sc1
    buffer_load_dwordx4 v[108:111], v1, s[12:15], s60 offen offset:1024 sc1
    buffer_load_dwordx4 v[112:115], v1, s[12:15], s60 offen offset:2048 sc1
    buffer_load_dwordx4 v[116:119], v1, s[12:15], s60 offen offset:3072 sc1
    s_waitcnt vmcnt(0)
    v_max3_u32 v248, v72, v76, v80
    v_max_u32 v248, v248, v84
    v_cmp_eq_u32 vcc, -1, v248
    s_cbranch_vccz L_rok_38
    s_sub_u32 s40, s40, 1
    s_cselect_b32 s40, 0, s40
    s_cbranch_scc0 L_rs_37
    s_branch L_rok_38
L_rs_39:
    s_add_u32 s60, s72, 20480
    buffer_load_dwordx4 v[88:91], v1, s[12:15], s60 offen offset:0 sc1
    buffer_load_dwordx4 v[92:95], v1, s[12:15], s60 offen offset:1024 sc1
    buffer_load_dwordx4 v[96:99], v1, s[12:15], s60 offen offset:2048 sc1
    buffer_load_dwordx4 v[100:103], v1, s[12:15], s60 offen offset:3072 sc1
    s_add_u32 s60, s72, 24576
    buffer_load_dwordx4 v[104:107], v1, s[12:15], s60 offen offset:0 sc1
    buffer_load_dwordx4 v[108:111], v1, s[12:15], s60 offen offset:1024 sc1
    buffer_load_dwordx4 v[112:115], v1, s[12:15], s60 offen offset:2048 sc1
    buffer_load_dwordx4 v[116:119], v1, s[12:15], s60 offen offset:3072 sc1
    s_waitcnt vmcnt(0)
    v_max3_u32 v248, v88, v92, v96
    v_max_u32 v248, v248, v100
    v_cmp_eq_u32 vcc, -1, v248
    s_cbranch_vccz L_rok_40
    s_sub_u32 s40, s40, 1
    s_cselect_b32 s40, 0, s40
    s_cbranch_scc0 L_rs_39
    s_branch L_rok_40
L_rs_41:
    buffer_load_dword v168, v250, s[12:15], s73 offen offset:0 sc1
    buffer_load_dword v169, v250, s[12:15], s73 offen offset:256 sc1
    buffer_load_dword v170, v250, s[12:15], s73 offen offset:512 sc1
    buffer_load_dword v171, v250, s[12:15], s73 offen offset:768 sc1
    buffer_load_dword v172, v250, s[12:15], s73 offen offset:1024 sc1
    buffer_load_dword v173, v250, s[12:15], s73 offen offset:1280 sc1
    buffer_load_dword v174, v250, s[12:15], s73 offen offset:1536 sc1
    buffer_load_dword v175, v250, s[12:15], s73 offen offset:1792 sc1
    buffer_load_dword v176, v250, s[12:15], s73 offen offset:2048 sc1
    buffer_load_dword v177, v250, s[12:15], s73 offen offset:2304 sc1
    buffer_load_dword v178, v250, s[12:15], s73 offen offset:2560 sc1
    buffer_load_dword v179, v250, s[12:15], s73 offen offset:2816 sc1
    buffer_load_dword v180, v250, s[12:15], s73 offen offset:3072 sc1
    buffer_load_dword v181, v250, s[12:15], s73 offen offset:3328 sc1
    s_waitcnt vmcnt(0)
    v_max3_u32 v248, v168, v169, v170
    v_max3_u32 v248, v248, v171, v172
    v_max3_u32 v248, v248, v173, v174
    v_max3_u32 v248, v248, v175, v176
    v_max3_u32 v248, v248, v177, v178
    v_max3_u32 v248, v248, v179, v180
    v_max_u32 v248, v248, v181
    v_cmp_eq_u32 vcc, -1, v248
    s_cbranch_vccz L_rok_42
    s_sub_u32 s40, s40, 1
    s_cselect_b32 s40, 0, s40
    s_cbranch_scc0 L_rs_41
    s_branch L_rok_42
L_rs_43:
    s_add_u32 s60, s72, 24576
    buffer_load_dwordx4 v[104:107], v1, s[12:15], s60 offen offset:0 sc1
    buffer_load_dwordx4 v[108:111], v1, s[12:15], s60 offen offset:1024 sc1
    buffer_load_dwordx4 v[112:115], v1, s[12:15], s60 offen offset:2048 sc1
    buffer_load_dwordx4 v[116:119], v1, s[12:15], s60 offen offset:3072 sc1
    s_waitcnt vmcnt(0)
    v_max3_u32 v248, v104, v108, v112
    v_max_u32 v248, v248, v116
    v_cmp_eq_u32 vcc, -1, v248
    s_cbranch_vccz L_rok_44
    s_sub_u32 s40, s40, 1
    s_cselect_b32 s40, 0, s40
    s_cbranch_scc0 L_rs_43
    s_branch L_rok_44
L_rs_45:
    s_add_u32 s60, s74, 0
    buffer_load_dwordx4 v[8:11], v1, s[12:15], s60 offen sc1
    s_add_u32 s60, s74, 7168
    buffer_load_dwordx4 v[12:15], v1, s[12:15], s60 offen sc1
    s_add_u32 s60, s74, 14336
    buffer_load_dwordx4 v[16:19], v1, s[12:15], s60 offen sc1
    s_add_u32 s60, s74, 21504
    buffer_load_dwordx4 v[20:23], v1, s[12:15], s60 offen sc1
    s_add_u32 s60, s75, 0
    buffer_load_dwordx4 v[24:27], v1, s[12:15], s60 offen sc1
    s_add_u32 s60, s75, 7168
    buffer_load_dwordx4 v[28:31], v1, s[12:15], s60 offen sc1
    s_add_u32 s60, s75, 14336
    buffer_load_dwordx4 v[32:35], v1, s[12:15], s60 offen sc1
    s_add_u32 s60, s75, 21504
    buffer_load_dwordx4 v[36:39], v1, s[12:15], s60 offen sc1
    s_add_u32 s60, s74, 1024
    buffer_load_dwordx4 v[40:43], v1, s[12:15], s60 offen sc1
    s_add_u32 s60, s74, 8192
    buffer_load_dwordx4 v[44:47], v1, s[12:15], s60 offen sc1
    s_add_u32 s60, s74, 15360
    buffer_load_dwordx4 v[48:51], v1, s[12:15], s60 offen sc1
    s_add_u32 s60, s74, 22528
    buffer_load_dwordx4 v[52:55], v1, s[12:15], s60 offen sc1
    s_add_u32 s60, s75, 1024
    buffer_load_dwordx4 v[56:59], v1, s[12:15], s60 offen sc1
    s_waitcnt vmcnt(0)
    v_max3_u32 v247, v8, v12, v16
    v_max_u32 v247, v247, v20
    v_cmp_eq_u32 vcc, -1, v247
    s_cbranch_vccz L_rok_46
    s_sub_u32 s40, s40, 1
    s_cselect_b32 s40, 0, s40
    s_cbranch_scc0 L_rs_45
    s_branch L_rok_46
L_rs_47:
    s_add_u32 s60, s75, 0
    buffer_load_dwordx4 v[24:27], v1, s[12:15], s60 offen sc1
    s_add_u32 s60, s75, 7168
    buffer_load_dwordx4 v[28:31], v1, s[12:15], s60 offen sc1
    s_add_u32 s60, s75, 14336
    buffer_load_dwordx4 v[32:35], v1, s[12:15], s60 offen sc1
    s_add_u32 s60, s75, 21504
    buffer_load_dwordx4 v[36:39], v1, s[12:15], s60 offen sc1
    s_add_u32 s60, s74, 1024
    buffer_load_dwordx4 v[40:43], v1, s[12:15], s60 offen sc1
    s_add_u32 s60, s74, 8192
    buffer_load_dwordx4 v[44:47], v1, s[12:15], s60 offen sc1
    s_add_u32 s60, s74, 15360
    buffer_load_dwordx4 v[48:51], v1, s[12:15], s60 offen sc1
    s_add_u32 s60, s74, 22528
    buffer_load_dwordx4 v[52:55], v1, s[12:15], s60 offen sc1
    s_add_u32 s60, s75, 1024
    buffer_load_dwordx4 v[56:59], v1, s[12:15], s60 offen sc1
    s_add_u32 s60, s75, 8192
    buffer_load_dwordx4 v[60:63], v1, s[12:15], s60 offen sc1
    s_add_u32 s60, s75, 15360
    buffer_load_dwordx4 v[64:67], v1, s[12:15], s60 offen sc1
    s_add_u32 s60, s75, 22528
    buffer_load_dwordx4 v[68:71], v1, s[12:15], s60 offen sc1
    s_add_u32 s60, s74, 2048
    buffer_load_dwordx4 v[72:75], v1, s[12:15], s60 offen sc1
    s_add_u32 s60, s74, 9216
    buffer_load_dwordx4 v[76:79], v1, s[12:15], s60 offen sc1
    s_waitcnt vmcnt(0)
    v_max3_u32 v247, v24, v28, v32
    v_max_u32 v247, v247, v36
    v_cmp_eq_u32 vcc, -1, v247
    s_cbranch_vccz L_rok_48
    s_sub_u32 s40, s40, 1
    s_cselect_b32 s40, 0, s40
    s_cbranch_scc0 L_rs_47
    s_branch L_rok_48
L_rs_49:
    s_add_u32 s60, s74, 1024
    buffer_load_dwordx4 v[40:43], v1, s[12:15], s60 offen sc1
    s_add_u32 s60, s74, 8192
    buffer_load_dwordx4 v[44:47], v1, s[12:15], s60 offen sc1
    s_add_u32 s60, s74, 15360
    buffer_load_dwordx4 v[48:51], v1, s[12:15], s60 offen sc1
    s_add_u32 s60, s74, 22528
    buffer_load_dwordx4 v[52:55], v1, s[12:15], s60 offen sc1
    s_add_u32 s60, s75, 1024
    buffer_load_dwordx4 v[56:59], v1, s[12:15], s60 offen sc1
    s_add_u32 s60, s75, 8192
    buffer_load_dwordx4 v[60:63], v1, s[12:15], s60 offen sc1
    s_add_u32 s60, s75, 15360
    buffer_load_dwordx4 v[64:67], v1, s[12:15], s60 offen sc1
    s_add_u32 s60, s75, 22528
    buffer_load_dwordx4 v[68:71], v1, s[12:15], s60 offen sc1
    s_add_u32 s60, s74, 2048
    buffer_load_dwordx4 v[72:75], v1, s[12:15], s60 offen sc1
    s_add_u32 s60, s74, 9216
    buffer_load_dwordx4 v[76:79], v1, s[12:15], s60 offen sc1
    s_add_u32 s60, s74, 16384
    buffer_load_dwordx4 v[80:83], v1, s[12:15], s60 offen sc1
    s_add_u32 s60, s74, 23552
    buffer_load_dwordx4 v[84:87], v1, s[12:15], s60 offen sc1
    s_add_u32 s60, s75, 2048
    buffer_load_dwordx4 v[88:91], v1, s[12:15], s60 offen sc1
    s_add_u32 s60, s75, 9216
    buffer_load_dwordx4 v[92:95], v1, s[12:15], s60 offen sc1
    s_waitcnt vmcnt(0)
    v_max3_u32 v247, v40, v44, v48
    v_max_u32 v247, v247, v52
    v_cmp_eq_u32 vcc, -1, v247
    s_cbranch_vccz L_rok_50
    s_sub_u32 s40, s40, 1
    s_cselect_b32 s40, 0, s40
    s_cbranch_scc0 L_rs_49
    s_branch L_rok_50
L_rs_51:
    s_add_u32 s60, s75, 1024
    buffer_load_dwordx4 v[56:59], v1, s[12:15], s60 offen sc1
    s_add_u32 s60, s75, 8192
    buffer_load_dwordx4 v[60:63], v1, s[12:15], s60 offen sc1
    s_add_u32 s60, s75, 15360
    buffer_load_dwordx4 v[64:67], v1, s[12:15], s60 offen sc1
    s_add_u32 s60, s75, 22528
    buffer_load_dwordx4 v[68:71], v1, s[12:15], s60 offen sc1
    s_add_u32 s60, s74, 2048
    buffer_load_dwordx4 v[72:75], v1, s[12:15], s60 offen sc1
    s_add_u32 s60, s74, 9216
    buffer_load_dwordx4 v[76:79], v1, s[12:15], s60 offen sc1
    s_add_u32 s60, s74, 16384
    buffer_load_dwordx4 v[80:83], v1, s[12:15], s60 offen sc1
    s_add_u32 s60, s74, 23552
    buffer_load_dwordx4 v[84:87], v1, s[12:15], s60 offen sc1
    s_add_u32 s60, s75, 2048
    buffer_load_dwordx4 v[88:91], v1, s[12:15], s60 offen sc1
    s_add_u32 s60, s75, 9216
    buffer_load_dwordx4 v[92:95], v1, s[12:15], s60 offen sc1
    s_add_u32 s60, s75, 16384
    buffer_load_dwordx4 v[96:99], v1, s[12:15], s60 offen sc1
    s_add_u32 s60, s75, 23552
    buffer_load_dwordx4 v[100:103], v1, s[12:15], s60 offen sc1
    s_add_u32 s60, s74, 3072
    buffer_load_dwordx4 v[104:107], v1, s[12:15], s60 offen sc1
    s_add_u32 s60, s74, 10240
    buffer_load_dwordx4 v[108:111], v1, s[12:15], s60 offen sc1
    s_add_u32 s60, s74, 17408
    buffer_load_dwordx4 v[112:115], v1, s[12:15], s60 offen sc1
    s_waitcnt vmcnt(0)
    v_max3_u32 v247, v56, v60, v64
    v_max_u32 v247, v247, v68
    v_cmp_eq_u32 vcc, -1, v247
    s_cbranch_vccz L_rok_52
    s_sub_u32 s40, s40, 1
    s_cselect_b32 s40, 0, s40
    s_cbranch_scc0 L_rs_51
    s_branch L_rok_52
L_rs_53:
    s_add_u32 s60, s74, 2048
    buffer_load_dwordx4 v[72:75], v1, s[12:15], s60 offen sc1
    s_add_u32 s60, s74, 9216
    buffer_load_dwordx4 v[76:79], v1, s[12:15], s60 offen sc1
    s_add_u32 s60, s74, 16384
    buffer_load_dwordx4 v[80:83], v1, s[12:15], s60 offen sc1
    s_add_u32 s60, s74, 23552
    buffer_load_dwordx4 v[84:87], v1, s[12:15], s60 offen sc1
    s_add_u32 s60, s75, 2048
    buffer_load_dwordx4 v[88:91], v1, s[12:15], s60 offen sc1
    s_add_u32 s60, s75, 9216
    buffer_load_dwordx4 v[92:95], v1, s[12:15], s60 offen sc1
    s_add_u32 s60, s75, 16384
    buffer_load_dwordx4 v[96:99], v1, s[12:15], s60 offen sc1
    s_add_u32 s60, s75, 23552
    buffer_load_dwordx4 v[100:103], v1, s[12:15], s60 offen sc1
    s_add_u32 s60, s74, 3072
    buffer_load_dwordx4 v[104:107], v1, s[12:15], s60 offen sc1
    s_add_u32 s60, s74, 10240
    buffer_load_dwordx4 v[108:111], v1, s[12:15], s60 offen sc1
    s_add_u32 s60, s74, 17408
    buffer_load_dwordx4 v[112:115], v1, s[12:15], s60 offen sc1
    s_add_u32 s60, s74, 24576
    buffer_load_dwordx4 v[116:119], v1, s[12:15], s60 offen sc1
    s_add_u32 s60, s75, 3072
    buffer_load_dwordx4 v[200:203], v1, s[12:15], s60 offen sc1
    s_add_u32 s60, s75, 10240
    buffer_load_dwordx4 v[204:207], v1, s[12:15], s60 offen sc1
    s_add_u32 s60, s75, 17408
    buffer_load_dwordx4 v[208:211], v1, s[12:15], s60 offen sc1
    s_waitcnt vmcnt(0)
    v_max3_u32 v247, v72, v76, v80
    v_max_u32 v247, v247, v84
    v_cmp_eq_u32 vcc, -1, v247
    s_cbranch_vccz L_rok_54
    s_sub_u32 s40, s40, 1
    s_cselect_b32 s40, 0, s40
    s_cbranch_scc0 L_rs_53
    s_branch L_rok_54
L_rs_55:
    s_add_u32 s60, s75, 2048
    buffer_load_dwordx4 v[88:91], v1, s[12:15], s60 offen sc1
    s_add_u32 s60, s75, 9216
    buffer_load_dwordx4 v[92:95], v1, s[12:15], s60 offen sc1
    s_add_u32 s60, s75, 16384
    buffer_load_dwordx4 v[96:99], v1, s[12:15], s60 offen sc1
    s_add_u32 s60, s75, 23552
    buffer_load_dwordx4 v[100:103], v1, s[12:15], s60 offen sc1
    s_add_u32 s60, s74, 3072
    buffer_load_dwordx4 v[104:107], v1, s[12:15], s60 offen sc1
    s_add_u32 s60, s74, 10240
    buffer_load_dwordx4 v[108:111], v1, s[12:15], s60 offen sc1
    s_add_u32 s60, s74, 17408
    buffer_load_dwordx4 v[112:115], v1, s[12:15], s60 offen sc1
    s_add_u32 s60, s74, 24576
    buffer_load_dwordx4 v[116:119], v1, s[12:15], s60 offen sc1
    s_add_u32 s60, s75, 3072
    buffer_load_dwordx4 v[200:203], v1, s[12:15], s60 offen sc1
    s_add_u32 s60, s75, 10240
    buffer_load_dwordx4 v[204:207], v1, s[12:15], s60 offen sc1
    s_add_u32 s60, s75, 17408
    buffer_load_dwordx4 v[208:211], v1, s[12:15], s60 offen sc1
    s_add_u32 s60, s75, 24576
    buffer_load_dwordx4 v[212:215], v1, s[12:15], s60 offen sc1
    s_add_u32 s60, s74, 4096
    buffer_load_dwordx4 v[8:11], v1, s[12:15], s60 offen sc1
    s_add_u32 s60, s74, 11264
    buffer_load_dwordx4 v[12:15], v1, s[12:15], s60 offen sc1
    s_add_u32 s60, s74, 18432
    buffer_load_dwordx4 v[16:19], v1, s[12:15], s60 offen sc1
    s_add_u32 s60, s74, 25600
    buffer_load_dwordx4 v[20:23], v1, s[12:15], s60 offen sc1
    s_waitcnt vmcnt(0)
    v_max3_u32 v247, v88, v92, v96
    v_max_u32 v247, v247, v100
    v_cmp_eq_u32 vcc, -1, v247
    s_cbranch_vccz L_rok_56
    s_sub_u32 s40, s40, 1
    s_cselect_b32 s40, 0, s40
    s_cbranch_scc0 L_rs_55
    s_branch L_rok_56
L_rs_57:
    s_add_u32 s60, s74, 3072
    buffer_load_dwordx4 v[104:107], v1, s[12:15], s60 offen sc1
    s_add_u32 s60, s74, 10240
    buffer_load_dwordx4 v[108:111], v1, s[12:15], s60 offen sc1
    s_add_u32 s60, s74, 17408
    buffer_load_dwordx4 v[112:115], v1, s[12:15], s60 offen sc1
    s_add_u32 s60, s74, 24576
    buffer_load_dwordx4 v[116:119], v1, s[12:15], s60 offen sc1
    s_add_u32 s60, s75, 3072
    buffer_load_dwordx4 v[200:203], v1, s[12:15], s60 offen sc1
    s_add_u32 s60, s75, 10240
    buffer_load_dwordx4 v[204:207], v1, s[12:15], s60 offen sc1
    s_add_u32 s60, s75, 17408
    buffer_load_dwordx4 v[208:211], v1, s[12:15], s60 offen sc1
    s_add_u32 s60, s75, 24576
    buffer_load_dwordx4 v[212:215], v1, s[12:15], s60 offen sc1
    s_add_u32 s60, s74, 4096
    buffer_load_dwordx4 v[8:11], v1, s[12:15], s60 offen sc1
    s_add_u32 s60, s74, 11264
    buffer_load_dwordx4 v[12:15], v1, s[12:15], s60 offen sc1
    s_add_u32 s60, s74, 18432
    buffer_load_dwordx4 v[16:19], v1, s[12:15], s60 offen sc1
    s_add_u32 s60, s74, 25600
    buffer_load_dwordx4 v[20:23], v1, s[12:15], s60 offen sc1
    s_add_u32 s60, s74, 5120
    buffer_load_dwordx4 v[24:27], v1, s[12:15], s60 offen sc1
    s_add_u32 s60, s74, 12288
    buffer_load_dwordx4 v[28:31], v1, s[12:15], s60 offen sc1
    s_add_u32 s60, s74, 19456
    buffer_load_dwordx4 v[32:35], v1, s[12:15], s60 offen sc1
    s_add_u32 s60, s74, 26624
    buffer_load_dwordx4 v[36:39], v1, s[12:15], s60 offen sc1
    s_waitcnt vmcnt(0)
    v_max3_u32 v247, v104, v108, v112
    v_max_u32 v247, v247, v116
    v_cmp_eq_u32 vcc, -1, v247
    s_cbranch_vccz L_rok_58
    s_sub_u32 s40, s40, 1
    s_cselect_b32 s40, 0, s40
    s_cbranch_scc0 L_rs_57
    s_branch L_rok_58
L_rs_59:
    s_add_u32 s60, s75, 3072
    buffer_load_dwordx4 v[200:203], v1, s[12:15], s60 offen sc1
    s_add_u32 s60, s75, 10240
    buffer_load_dwordx4 v[204:207], v1, s[12:15], s60 offen sc1
    s_add_u32 s60, s75, 17408
    buffer_load_dwordx4 v[208:211], v1, s[12:15], s60 offen sc1
    s_add_u32 s60, s75, 24576
    buffer_load_dwordx4 v[212:215], v1, s[12:15], s60 offen sc1
    s_add_u32 s60, s74, 4096
    buffer_load_dwordx4 v[8:11], v1, s[12:15], s60 offen sc1
    s_add_u32 s60, s74, 11264
    buffer_load_dwordx4 v[12:15], v1, s[12:15], s60 offen sc1
    s_add_u32 s60, s74, 18432
    buffer_load_dwordx4 v[16:19], v1, s[12:15], s60 offen sc1
    s_add_u32 s60, s74, 25600
    buffer_load_dwordx4 v[20:23], v1, s[12:15], s60 offen sc1
    s_add_u32 s60, s74, 5120
    buffer_load_dwordx4 v[24:27], v1, s[12:15], s60 offen sc1
    s_add_u32 s60, s74, 12288
    buffer_load_dwordx4 v[28:31], v1, s[12:15], s60 offen sc1
    s_add_u32 s60, s74, 19456
    buffer_load_dwordx4 v[32:35], v1, s[12:15], s60 offen sc1
    s_add_u32 s60, s74, 26624
    buffer_load_dwordx4 v[36:39], v1, s[12:15], s60 offen sc1
    s_add_u32 s60, s74, 6144
    buffer_load_dwordx4 v[40:43], v1, s[12:15], s60 offen sc1
    s_add_u32 s60, s74, 13312
    buffer_load_dwordx4 v[44:47], v1, s[12:15], s60 offen sc1
    s_add_u32 s60, s74, 20480
    buffer_load_dwordx4 v[48:51], v1, s[12:15], s60 offen sc1
    s_add_u32 s60, s74, 27648
    buffer_load_dwordx4 v[52:55], v1, s[12:15], s60 offen sc1
    s_waitcnt vmcnt(0)
    v_max3_u32 v247, v200, v204, v208
    v_max_u32 v247, v247, v212
    v_cmp_eq_u32 vcc, -1, v247
    s_cbranch_vccz L_rok_60
    s_sub_u32 s40, s40, 1
    s_cselect_b32 s40, 0, s40
    s_cbranch_scc0 L_rs_59
    s_branch L_rok_60
L_rs_61:
    s_add_u32 s60, s74, 4096
    buffer_load_dwordx4 v[8:11], v1, s[12:15], s60 offen sc1
    s_add_u32 s60, s74, 11264
    buffer_load_dwordx4 v[12:15], v1, s[12:15], s60 offen sc1
    s_add_u32 s60, s74, 18432
    buffer_load_dwordx4 v[16:19], v1, s[12:15], s60 offen sc1
    s_add_u32 s60, s74, 25600
    buffer_load_dwordx4 v[20:23], v1, s[12:15], s60 offen sc1
    s_add_u32 s60, s74, 5120
    buffer_load_dwordx4 v[24:27], v1, s[12:15], s60 offen sc1
    s_add_u32 s60, s74, 12288
    buffer_load_dwordx4 v[28:31], v1, s[12:15], s60 offen sc1
    s_add_u32 s60, s74, 19456
    buffer_load_dwordx4 v[32:35], v1, s[12:15], s60 offen sc1
    s_add_u32 s60, s74, 26624
    buffer_load_dwordx4 v[36:39], v1, s[12:15], s60 offen sc1
    s_add_u32 s60, s74, 6144
    buffer_load_dwordx4 v[40:43], v1, s[12:15], s60 offen sc1
    s_add_u32 s60, s74, 13312
    buffer_load_dwordx4 v[44:47], v1, s[12:15], s60 offen sc1
    s_add_u32 s60, s74, 20480
    buffer_load_dwordx4 v[48:51], v1, s[12:15], s60 offen sc1
    s_add_u32 s60, s74, 27648
    buffer_load_dwordx4 v[52:55], v1, s[12:15], s60 offen sc1
    s_add_u32 s60, s75, 4096
    buffer_load_dwordx4 v[56:59], v1, s[12:15], s60 offen sc1
    s_add_u32 s60, s75, 11264
    buffer_load_dwordx4 v[60:63], v1, s[12:15], s60 offen sc1
    s_add_u32 s60, s75, 18432
    buffer_load_dwordx4 v[64:67], v1, s[12:15], s60 offen sc1
    s_add_u32 s60, s75, 25600
    buffer_load_dwordx4 v[68:71], v1, s[12:15], s60 offen sc1
    s_add_u32 s60, s75, 5120
    buffer_load_dwordx4 v[72:75], v1, s[12:15], s60 offen sc1
    s_waitcnt vmcnt(0)
    v_max3_u32 v247, v8, v12, v16
    v_max_u32 v247, v247, v20
    v_cmp_eq_u32 vcc, -1, v247
    s_cbranch_vccz L_rok_62
    s_sub_u32 s40, s40, 1
    s_cselect_b32 s40, 0, s40
    s_cbranch_scc0 L_rs_61
    s_branch L_rok_62
L_rs_63:
    s_add_u32 s60, s74, 5120
    buffer_load_dwordx4 v[24:27], v1, s[12:15], s60 offen sc1
    s_add_u32 s60, s74, 12288
    buffer_load_dwordx4 v[28:31], v1, s[12:15], s60 offen sc1
    s_add_u32 s60, s74, 19456
    buffer_load_dwordx4 v[32:35], v1, s[12:15], s60 offen sc1
    s_add_u32 s60, s74, 26624
    buffer_load_dwordx4 v[36:39], v1, s[12:15], s60 offen sc1
    s_add_u32 s60, s74, 6144
    buffer_load_dwordx4 v[40:43], v1, s[12:15], s60 offen sc1
    s_add_u32 s60, s74, 13312
    buffer_load_dwordx4 v[44:47], v1, s[12:15], s60 offen sc1
    s_add_u32 s60, s74, 20480
    buffer_load_dwordx4 v[48:51], v1, s[12:15], s60 offen sc1
    s_add_u32 s60, s74, 27648
    buffer_load_dwordx4 v[52:55], v1, s[12:15], s60 offen sc1
    s_add_u32 s60, s75, 4096
    buffer_load_dwordx4 v[56:59], v1, s[12:15], s60 offen sc1
    s_add_u32 s60, s75, 11264
    buffer_load_dwordx4 v[60:63], v1, s[12:15], s60 offen sc1
    s_add_u32 s60, s75, 18432
    buffer_load_dwordx4 v[64:67], v1, s[12:15], s60 offen sc1
    s_add_u32 s60, s75, 25600
    buffer_load_dwordx4 v[68:71], v1, s[12:15], s60 offen sc1
    s_add_u32 s60, s75, 5120
    buffer_load_dwordx4 v[72:75], v1, s[12:15], s60 offen sc1
    s_add_u32 s60, s75, 12288
    buffer_load_dwordx4 v[76:79], v1, s[12:15], s60 offen sc1
    s_add_u32 s60, s75, 19456
    buffer_load_dwordx4 v[80:83], v1, s[12:15], s60 offen sc1
    s_add_u32 s60, s75, 26624
    buffer_load_dwordx4 v[84:87], v1, s[12:15], s60 offen sc1
    s_add_u32 s60, s75, 6144
    buffer_load_dwordx4 v[88:91], v1, s[12:15], s60 offen sc1
    s_waitcnt vmcnt(0)
    v_max3_u32 v247, v24, v28, v32
    v_max_u32 v247, v247, v36
    v_cmp_eq_u32 vcc, -1, v247
    s_cbranch_vccz L_rok_64
    s_sub_u32 s40, s40, 1
    s_cselect_b32 s40, 0, s40
    s_cbranch_scc0 L_rs_63
    s_branch L_rok_64
L_rs_65:
    s_add_u32 s60, s74, 6144
    buffer_load_dwordx4 v[40:43], v1, s[12:15], s60 offen sc1
    s_add_u32 s60, s74, 13312
    buffer_load_dwordx4 v[44:47], v1, s[12:15], s60 offen sc1
    s_add_u32 s60, s74, 20480
    buffer_load_dwordx4 v[48:51], v1, s[12:15], s60 offen sc1
    s_add_u32 s60, s74, 27648
    buffer_load_dwordx4 v[52:55], v1, s[12:15], s60 offen sc1
    s_add_u32 s60, s75, 4096
    buffer_load_dwordx4 v[56:59], v1, s[12:15], s60 offen sc1
    s_add_u32 s60, s75, 11264
    buffer_load_dwordx4 v[60:63], v1, s[12:15], s60 offen sc1
    s_add_u32 s60, s75, 18432
    buffer_load_dwordx4 v[64:67], v1, s[12:15], s60 offen sc1
    s_add_u32 s60, s75, 25600
    buffer_load_dwordx4 v[68:71], v1, s[12:15], s60 offen sc1
    s_add_u32 s60, s75, 5120
    buffer_load_dwordx4 v[72:75], v1, s[12:15], s60 offen sc1
    s_add_u32 s60, s75, 12288
    buffer_load_dwordx4 v[76:79], v1, s[12:15], s60 offen sc1
    s_add_u32 s60, s75, 19456
    buffer_load_dwordx4 v[80:83], v1, s[12:15], s60 offen sc1
    s_add_u32 s60, s75, 26624
    buffer_load_dwordx4 v[84:87], v1, s[12:15], s60 offen sc1
    s_add_u32 s60, s75, 6144
    buffer_load_dwordx4 v[88:91], v1, s[12:15], s60 offen sc1
    s_add_u32 s60, s75, 13312
    buffer_load_dwordx4 v[92:95], v1, s[12:15], s60 offen sc1
    s_add_u32 s60, s75, 20480
    buffer_load_dwordx4 v[96:99], v1, s[12:15], s60 offen sc1
    s_add_u32 s60, s75, 27648
    buffer_load_dwordx4 v[100:103], v1, s[12:15], s60 offen sc1
    s_waitcnt vmcnt(0)
    v_max3_u32 v247, v40, v44, v48
    v_max_u32 v247, v247, v52
    v_cmp_eq_u32 vcc, -1, v247
    s_cbranch_vccz L_rok_66
    s_sub_u32 s40, s40, 1
    s_cselect_b32 s40, 0, s40
    s_cbranch_scc0 L_rs_65
    s_branch L_rok_66
L_rs_67:
    s_add_u32 s60, s75, 4096
    buffer_load_dwordx4 v[56:59], v1, s[12:15], s60 offen sc1
    s_add_u32 s60, s75, 11264
    buffer_load_dwordx4 v[60:63], v1, s[12:15], s60 offen sc1
    s_add_u32 s60, s75, 18432
    buffer_load_dwordx4 v[64:67], v1, s[12:15], s60 offen sc1
    s_add_u32 s60, s75, 25600
    buffer_load_dwordx4 v[68:71], v1, s[12:15], s60 offen sc1
    s_add_u32 s60, s75, 5120
    buffer_load_dwordx4 v[72:75], v1, s[12:15], s60 offen sc1
    s_add_u32 s60, s75, 12288
    buffer_load_dwordx4 v[76:79], v1, s[12:15], s60 offen sc1
    s_add_u32 s60, s75, 19456
    buffer_load_dwordx4 v[80:83], v1, s[12:15], s60 offen sc1
    s_add_u32 s60, s75, 26624
    buffer_load_dwordx4 v[84:87], v1, s[12:15], s60 offen sc1
    s_add_u32 s60, s75, 6144
    buffer_load_dwordx4 v[88:91], v1, s[12:15], s60 offen sc1
    s_add_u32 s60, s75, 13312
    buffer_load_dwordx4 v[92:95], v1, s[12:15], s60 offen sc1
    s_add_u32 s60, s75, 20480
    buffer_load_dwordx4 v[96:99], v1, s[12:15], s60 offen sc1
    s_add_u32 s60, s75, 27648
    buffer_load_dwordx4 v[100:103], v1, s[12:15], s60 offen sc1
    s_waitcnt vmcnt(0)
    v_max3_u32 v247, v56, v60, v64
    v_max_u32 v247, v247, v68
    v_cmp_eq_u32 vcc, -1, v247
    s_cbranch_vccz L_rok_68
    s_sub_u32 s40, s40, 1
    s_cselect_b32 s40, 0, s40
    s_cbranch_scc0 L_rs_67
    s_branch L_rok_68
L_rs_69:
    s_add_u32 s60, s75, 5120
    buffer_load_dwordx4 v[72:75], v1, s[12:15], s60 offen sc1
    s_add_u32 s60, s75, 12288
    buffer_load_dwordx4 v[76:79], v1, s[12:15], s60 offen sc1
    s_add_u32 s60, s75, 19456
    buffer_load_dwordx4 v[80:83], v1, s[12:15], s60 offen sc1
    s_add_u32 s60, s75, 26624
    buffer_load_dwordx4 v[84:87], v1, s[12:15], s60 offen sc1
    s_add_u32 s60, s75, 6144
    buffer_load_dwordx4 v[88:91], v1, s[12:15], s60 offen sc1
    s_add_u32 s60, s75, 13312
    buffer_load_dwordx4 v[92:95], v1, s[12:15], s60 offen sc1
    s_add_u32 s60, s75, 20480
    buffer_load_dwordx4 v[96:99], v1, s[12:15], s60 offen sc1
    s_add_u32 s60, s75, 27648
    buffer_load_dwordx4 v[100:103], v1, s[12:15], s60 offen sc1
    s_waitcnt vmcnt(0)
    v_max3_u32 v247, v72, v76, v80
    v_max_u32 v247, v247, v84
    v_cmp_eq_u32 vcc, -1, v247
    s_cbranch_vccz L_rok_70
    s_sub_u32 s40, s40, 1
    s_cselect_b32 s40, 0, s40
    s_cbranch_scc0 L_rs_69
    s_branch L_rok_70
L_rs_71:
    s_add_u32 s60, s75, 6144
    buffer_load_dwordx4 v[88:91], v1, s[12:15], s60 offen sc1
    s_add_u32 s60, s75, 13312
    buffer_load_dwordx4 v[92:95], v1, s[12:15], s60 offen sc1
    s_add_u32 s60, s75, 20480
    buffer_load_dwordx4 v[96:99], v1, s[12:15], s60 offen sc1
    s_add_u32 s60, s75, 27648
    buffer_load_dwordx4 v[100:103], v1, s[12:15], s60 offen sc1
    s_waitcnt vmcnt(0)
    v_max3_u32 v247, v88, v92, v96
    v_max_u32 v247, v247, v100
    v_cmp_eq_u32 vcc, -1, v247
    s_cbranch_vccz L_rok_72
    s_sub_u32 s40, s40, 1
    s_cselect_b32 s40, 0, s40
    s_cbranch_scc0 L_rs_71
    s_branch L_rok_72
L_fb:
    s_waitcnt vmcnt(0) lgkmcnt(0)
    s_barrier
    s_mov_b32 s42, -1
    s_mov_b32 s44, 1073741824
    s_mov_b32 s45, 1073741824
    s_mov_b32 s31, 1073741824
    s_mov_b32 s64, 1073741824
    s_mov_b32 s65, 1073741824
    s_mov_b32 s66, 1073741824
    s_lshl_b32 s50, s37, 6
    s_lshl_b32 s55, s36, 4
    s_add_u32 s50, s50, s55
    s_add_u32 s50, s50, 1024
    s_lshl_b32 s50, s50, 11
    s_mov_b32 s51, 16
    v_mov_b32 v228, 0xff800000
    v_mov_b32 v229, 0xff800000
    v_mov_b32 v230, 0xff800000
    v_mov_b32 v231, 0xff800000
L_fbl:
    buffer_load_dwordx4 v[144:147], v1, s[12:15], s50 offen offset:0 sc1
    buffer_load_dwordx4 v[148:151], v1, s[12:15], s50 offen offset:1024 sc1
    s_add_u32 s50, s50, 2048
    s_waitcnt vmcnt(0)
    v_mfma_f32_32x32x16_bf16 v[104:119], v[144:147], v[8:11], 0
    v_mfma_f32_32x32x16_bf16 v[104:119], v[148:151], v[12:15], v[104:119]
    s_nop 11
    v_max3_f32 v228, v228, v104, v105
    v_max3_f32 v228, v228, v106, v107
    v_max3_f32 v228, v228, v108, v109
    v_max3_f32 v228, v228, v110, v111
    v_max3_f32 v228, v228, v112, v113
    v_max3_f32 v228, v228, v114, v115
    v_max3_f32 v228, v228, v116, v117
    v_max3_f32 v228, v228, v118, v119
    v_mfma_f32_32x32x16_bf16 v[104:119], v[144:147], v[16:19], 0
    v_mfma_f32_32x32x16_bf16 v[104:119], v[148:151], v[20:23], v[104:119]
    s_nop 11
    v_max3_f32 v229, v229, v104, v105
    v_max3_f32 v229, v229, v106, v107
    v_max3_f32 v229, v229, v108, v109
    v_max3_f32 v229, v229, v110, v111
    v_max3_f32 v229, v229, v112, v113
    v_max3_f32 v229, v229, v114, v115
    v_max3_f32 v229, v229, v116, v117
    v_max3_f32 v229, v229, v118, v119
    v_mfma_f32_32x32x16_bf16 v[104:119], v[144:147], v[24:27], 0
    v_mfma_f32_32x32x16_bf16 v[104:119], v[148:151], v[28:31], v[104:119]
    s_nop 11
    v_max3_f32 v230, v230, v104, v105
    v_max3_f32 v230, v230, v106, v107
    v_max3_f32 v230, v230, v108, v109
    v_max3_f32 v230, v230, v110, v111
    v_max3_f32 v230, v230, v112, v113
    v_max3_f32 v230, v230, v114, v115
    v_max3_f32 v230, v230, v116, v117
    v_max3_f32 v230, v230, v118, v119
    v_mfma_f32_32x32x16_bf16 v[104:119], v[144:147], v[32:35], 0
    v_mfma_f32_32x32x16_bf16 v[104:119], v[148:151], v[36:39], v[104:119]
    s_nop 11
    v_max3_f32 v231, v231, v104, v105
    v_max3_f32 v231, v231, v106, v107
    v_max3_f32 v231, v231, v108, v109
    v_max3_f32 v231, v231, v110, v111
    v_max3_f32 v231, v231, v112, v113
    v_max3_f32 v231, v231, v114, v115
    v_max3_f32 v231, v231, v116, v117
    v_max3_f32 v231, v231, v118, v119
    s_sub_u32 s51, s51, 1
    s_cmp_lg_u32 s51, 0
    s_cbranch_scc1 L_fbl
    v_lshlrev_b32 v216, 2, v0
    s_lshl_b32 s57, s36, 8
    v_mov_b32 v218, v228
    s_nop 1
    v_permlane32_swap_b32 v218, v228
    v_max_f32_e64 v228, v218, v228
    s_xor_b32 s55, s36, 3
    s_lshl_b32 s55, s55, 10
    s_add_u32 s55, s55, 114688
    v_add_u32 v220, s55, v216
    v_add_u32 v217, s57, v220
    ds_write_b32 v217, v228
    v_mov_b32 v218, v229
    s_nop 1
    v_permlane32_swap_b32 v218, v229
    v_max_f32 v229, v218, v229
    s_xor_b32 s55, s36, 2
    s_lshl_b32 s55, s55, 10
    s_add_u32 s55, s55, 114688
    v_add_u32 v221, s55, v216
    v_add_u32 v217, s57, v221
    ds_write_b32 v217, v229
    v_mov_b32 v218, v230
    s_nop 1
    v_permlane32_swap_b32 v218, v230
    v_max_f32 v230, v218, v230
    s_xor_b32 s55, s36, 1
    s_lshl_b32 s55, s55, 10
    s_add_u32 s55, s55, 114688
    v_add_u32 v222, s55, v216
    v_add_u32 v217, s57, v222
    ds_write_b32 v217, v230
    v_mov_b32 v218, v231
    s_nop 1
    v_permlane32_swap_b32 v218, v231
    v_max_f32 v231, v218, v231
    s_xor_b32 s55, s36, 0
    s_lshl_b32 s55, s55, 10
    s_add_u32 s55, s55, 114688
    v_add_u32 v223, s55, v216
    v_add_u32 v217, s57, v223
    ds_write_b32 v217, v231
    s_waitcnt lgkmcnt(0)
    s_barrier
    ds_read_b32 v224, v220 offset:0
    ds_read_b32 v225, v220 offset:256
    ds_read_b32 v226, v220 offset:512
    ds_read_b32 v227, v220 offset:768
    s_waitcnt lgkmcnt(0)
    v_max3_f32 v224, v224, v225, v226
    v_max_f32 v224, v224, v227
    v_sub_f32_e64 v224, 0, v224
    v_cvt_pk_bf16_f32 v225, v224, v224
    v_and_b32 v225, 0xffff0000, v225
    v_sub_f32_e64 v225, v224, v225
    v_cvt_pk_bf16_f32 v226, v224, v225
    v_and_b32 v227, 0xffff0000, v226
    v_sub_f32_e64 v227, v225, v227
    v_cvt_pk_bf16_f32 v227, v227, 0
    s_mov_b32 exec_lo, 0
    v_mov_b32 v14, v226
    v_mov_b32 v15, v227
    s_mov_b32 exec_lo, -1
    ds_read_b32 v224, v221 offset:0
    ds_read_b32 v225, v221 offset:256
    ds_read_b32 v226, v221 offset:512
    ds_read_b32 v227, v221 offset:768
    s_waitcnt lgkmcnt(0)
    v_max3_f32 v224, v224, v225, v226
    v_max_f32 v224, v224, v227
    v_sub_f32_e64 v224, 0, v224
    v_cvt_pk_bf16_f32 v225, v224, v224
    v_and_b32 v225, 0xffff0000, v225
    v_sub_f32_e64 v225, v224, v225
    v_cvt_pk_bf16_f32 v226, v224, v225
    v_and_b32 v227, 0xffff0000, v226
    v_sub_f32_e64 v227, v225, v227
    v_cvt_pk_bf16_f32 v227, v227, 0
    s_mov_b32 exec_lo, 0
    v_mov_b32 v22, v226
    v_mov_b32 v23, v227
    s_mov_b32 exec_lo, -1
    ds_read_b32 v224, v222 offset:0
    ds_read_b32 v225, v222 offset:256
    ds_read_b32 v226, v222 offset:512
    ds_read_b32 v227, v222 offset:768
    s_waitcnt lgkmcnt(0)
    v_max3_f32 v224, v224, v225, v226
    v_max_f32 v224, v224, v227
    v_sub_f32_e64 v224, 0, v224
    v_cvt_pk_bf16_f32 v225, v224, v224
    v_and_b32 v225, 0xffff0000, v225
    v_sub_f32_e64 v225, v224, v225
    v_cvt_pk_bf16_f32 v226, v224, v225
    v_and_b32 v227, 0xffff0000, v226
    v_sub_f32_e64 v227, v225, v227
    v_cvt_pk_bf16_f32 v227, v227, 0
    s_mov_b32 exec_lo, 0
    v_mov_b32 v30, v226
    v_mov_b32 v31, v227
    s_mov_b32 exec_lo, -1
    ds_read_b32 v224, v223 offset:0
    ds_read_b32 v225, v223 offset:256
    ds_read_b32 v226, v223 offset:512
    ds_read_b32 v227, v223 offset:768
    s_waitcnt lgkmcnt(0)
    v_max3_f32 v224, v224, v225, v226
    v_max_f32 v224, v224, v227
    v_sub_f32_e64 v224, 0, v224
    v_cvt_pk_bf16_f32 v225, v224, v224
    v_and_b32 v225, 0xffff0000, v225
    v_sub_f32_e64 v225, v224, v225
    v_cvt_pk_bf16_f32 v226, v224, v225
    v_and_b32 v227, 0xffff0000, v226
    v_sub_f32_e64 v227, v225, v227
    v_cvt_pk_bf16_f32 v227, v227, 0
    s_mov_b32 exec_lo, 0
    v_mov_b32 v38, v226
    v_mov_b32 v39, v227
    s_mov_b32 exec_lo, -1
    s_lshl_b32 s50, s37, 4
    s_add_u32 s50, s50, s36
    s_add_u32 s50, s50, 256
    s_lshl_b32 s50, s50, 13
    s_mov_b32 s60, 27787264
    v_mov_b32 v207, 0
    buffer_load_dwordx4 v[144:147], v1, s[12:15], s50 offen offset:0 sc1
    buffer_load_dwordx4 v[148:151], v1, s[12:15], s50 offen offset:1024 sc1
    buffer_load_dwordx4 v[152:155], v208, s[12:15], s50 offen offset:0 sc1
    buffer_load_dwordx4 v[156:159], v208, s[12:15], s50 offen offset:1024 sc1
    buffer_load_dwordx4 v[160:163], v1, s[12:15], s50 offen offset:2048 sc1
    buffer_load_dwordx4 v[164:167], v1, s[12:15], s50 offen offset:3072 sc1
    buffer_load_dwordx4 v[168:171], v208, s[12:15], s50 offen offset:2048 sc1
    buffer_load_dwordx4 v[172:175], v208, s[12:15], s50 offen offset:3072 sc1
    s_xor_b32 s50, s50, 4096
    s_waitcnt vmcnt(0)
    s_barrier
    s_branch L_attn
.section .rodata,"a"
.p2align 6
.amdhsa_kernel sequential_preLN__softmax_full_mha__glu_gated_glu__prompt_kernel
  .amdhsa_next_free_vgpr 512
  .amdhsa_next_free_sgpr 102
  .amdhsa_accum_offset 256
  .amdhsa_group_segment_fixed_size 0
  .amdhsa_kernarg_size 80
  .amdhsa_user_sgpr_count 2
  .amdhsa_user_sgpr_kernarg_segment_ptr 1
  .amdhsa_system_sgpr_workgroup_id_x 1
.end_amdhsa_kernel
```
